```python
import torch

def _softmax(x, axis=-1):
    return torch.softmax(x, dim=axis)
def _gelu(x):
    return torch.nn.functional.gelu(x, approximate="tanh")
def _silu(x):
    return torch.nn.functional.silu(x)
def _sigmoid(x):
    return torch.sigmoid(x)
def _layernorm(x, axis=-1, eps=1e-5):
    m = x.mean(dim=axis, keepdim=True)
    v = x.var(dim=axis, keepdim=True, unbiased=False)
    return (x - m) / torch.sqrt(v + eps)
def _scatter_add(tgt, idx, src, axis=0):
    return tgt.clone().index_add_(axis, idx, src)
def _segment_sum(src, seg, n):
    out = torch.zeros((n,) + src.shape[1:], dtype=src.dtype)
    return out.index_add_(0, seg, src)
def _pad(x, pw):
    flat = tuple(v for pair in reversed(pw) for v in pair)
    return torch.nn.functional.pad(x, flat)

kernel_name = 'standalone__detection_seg_fpn_lateral__vision'

def setup_inputs():

    _w = (lambda a: (lambda t: t.to(torch.bfloat16) if t.is_floating_point() else t)(torch.as_tensor(a)))
    H = W = (224 // 2) * 2
    C = 96
    k = 7
    return {
        "c_fine": _w((lambda *s: torch.randn(*s, dtype=torch.bfloat16) * 0.05)(1, H, W, C)),
        "p_coarse": _w((lambda *s: torch.randn(*s, dtype=torch.bfloat16) * 0.05)(1, H // 2, W // 2, C)),
        "w_lat": _w((lambda *s: torch.randn(*s, dtype=torch.bfloat16) * 0.05)(C, C)),
        "w_out": _w((lambda *s: torch.randn(*s, dtype=torch.bfloat16) * 0.05)(k, k, C, C)),
    }

def reference(c_fine, p_coarse, w_lat, w_out):
    B, H, W, C = c_fine.shape
    k = 7
    lat = torch.einsum("bhwc,cd->bhwd", c_fine, w_lat)
    up = (lambda x, n, axis: torch.repeat_interleave(x, n, dim=axis))((lambda x, n, axis: torch.repeat_interleave(x, n, dim=axis))(p_coarse, 2, axis=1), 2, axis=2)
    m = lat + up
    pad = k // 2
    mp = _pad(m, ((0, 0), (pad, pad), (pad, pad), (0, 0)))
    o = None
    for di in range(k):
        for dj in range(k):
            t = torch.einsum("bhwc,cd->bhwd", mp[:, di:di + H, dj:dj + W, :], w_out[di, dj])
            o = t if o is None else o + t
    return o
```

```asm
; @launch grid=(252,1,1) block=(256,1,1) lds=152576
.amdgcn_target "amdgcn-amd-amdhsa--gfx950"
.text
.globl standalone__detection_seg_fpn_lateral__vision_kernel
.p2align 12
.p2align 8
.type standalone__detection_seg_fpn_lateral__vision_kernel,@function
standalone__detection_seg_fpn_lateral__vision_kernel:
    s_cmp_ge_u32 s2, 252
    s_cbranch_scc1 L_end
    s_load_dwordx8 s[36:43], s[0:1], 0
    s_load_dwordx4 s[44:47], s[0:1], 32
    s_load_dwordx2 s[48:49], s[0:1], 48
    s_getpc_b64 s[78:79]
L_pc:
    v_lshrrev_b32 v1, 6, v0
    v_and_b32 v0, 63, v0
    v_readfirstlane_b32 s3, v1
    s_lshr_b32 s4, s2, 3
    s_mul_i32 s4, s4, 12
    v_mad_u32_u24 v6, v1, 3, v0
    v_add_lshl_u32 v6, v6, s4, 7
    v_lshl_add_u32 v7, v0, 2, v1
    v_lshlrev_b32 v7, 12, v7
    v_cmp_gt_u32 vcc, 3, v0
    v_add_u32 v7, L_body-L_pc-49152, v7
    s_nop 0
    v_cndmask_b32 v6, v7, v6, vcc
    v_min_u32 v6, L_codeend-L_pc-4, v6
    s_mov_b64 exec, 63
    global_load_dword v6, v6, s[78:79]
    s_mov_b64 exec, -1
    v_lshlrev_b32 v1, 4, v0
    v_and_b32 v254, 15, v0
    v_lshrrev_b32 v255, 4, v0
    s_cmp_lt_u32 s2, 42
    s_cbranch_scc0 L_conv
    s_cmp_eq_u32 s3, 3
    s_cbranch_scc1 L_end
    s_mul_i32 s4, s2, 43
    s_lshr_b32 s4, s4, 8
    s_mul_i32 s50, s4, 6
    s_sub_u32 s50, s2, s50
    s_lshr_b32 s5, s50, 1
    s_and_b32 s33, s50, 1
    s_mul_i32 s6, s4, 3
    s_add_u32 s6, s6, s5
    s_lshl_b32 s50, s3, 6
    v_add_u32 v2, s50, v0
    v_mul_u32_u24 v3, 171, v2
    v_lshrrev_b32 v3, 10, v3
    v_mul_u32_u24 v4, 6, v3
    v_sub_u32 v2, v2, v4
    s_lshl_b32 s50, s33, 6
    s_lshl_b32 s51, s33, 5
    s_add_u32 s51, s51, 64
    v_mov_b32 v4, s50
    v_mov_b32 v5, s51
    v_cmp_gt_u32 vcc, 4, v2
    v_mul_u32_u24 v3, 192, v3
    v_lshl_add_u32 v2, v2, 4, v3
    v_cndmask_b32 v4, v5, v4, vcc
    v_add_u32 v2, v2, v4
    s_mul_i32 s50, s4, 18432
    s_mul_i32 s51, s5, 6144
    s_add_u32 s50, s50, s51
    s_lshl_b32 s52, s3, 10
    s_waitcnt lgkmcnt(0)
    s_mov_b32 s16, s42
    s_mov_b32 s17, s43
    s_mov_b32 s18, 903168
    s_mov_b32 s19, 0x20000
    s_add_u32 m0, s52, 0
    s_nop 0
    buffer_load_dwordx4 v2, s[16:19], s50 offen lds
    s_add_u32 s50, s50, 129024
    s_add_u32 m0, s52, 3072
    s_nop 0
    buffer_load_dwordx4 v2, s[16:19], s50 offen lds
    s_add_u32 s50, s50, 129024
    s_add_u32 m0, s52, 6144
    s_nop 0
    buffer_load_dwordx4 v2, s[16:19], s50 offen lds
    s_add_u32 s50, s50, 129024
    s_add_u32 m0, s52, 9216
    s_nop 0
    buffer_load_dwordx4 v2, s[16:19], s50 offen lds
    s_add_u32 s50, s50, 129024
    s_add_u32 m0, s52, 12288
    s_nop 0
    buffer_load_dwordx4 v2, s[16:19], s50 offen lds
    s_add_u32 s50, s50, 129024
    s_add_u32 m0, s52, 15360
    s_nop 0
    buffer_load_dwordx4 v2, s[16:19], s50 offen lds
    s_add_u32 s50, s50, 129024
    s_add_u32 m0, s52, 18432
    s_nop 0
    buffer_load_dwordx4 v2, s[16:19], s50 offen lds
    s_branch L_prod
L_conv:
    s_and_b32 s50, s2, 7
    s_lshr_b32 s51, s2, 3
    s_sub_u32 s51, s51, 5
    s_cmp_lt_u32 s50, 2
    s_subb_u32 s51, s51, 0
    s_lshl_b32 s70, s51, 2
    s_sub_i32 s52, s50, 2
    s_max_i32 s52, s52, 0
    s_min_i32 s52, s52, 2
    s_mul_i32 s50, s50, 26
    s_add_u32 s50, s50, s51
    s_add_u32 s50, s50, s52
    s_cmp_ge_u32 s50, 105
    s_cselect_b32 s53, 98, 0
    s_cselect_b32 s51, 105, 0
    s_sub_u32 s51, s50, s51
    s_mul_i32 s51, s51, 147
    s_lshr_b32 s51, s51, 10
    s_mul_i32 s52, s51, 7
    s_sub_u32 s50, s50, s52
    s_sub_u32 s50, s50, s53
    s_lshl_b32 s34, s50, 4
    s_mul_i32 s35, s51, 15
    s_sub_u32 s53, s34, 3
    s_lshr_b32 s54, s34, 1
    s_sub_u32 s54, s54, 2
    s_lshl_b32 s55, s3, 6
    s_lshl_b32 s56, s3, 10
    s_movk_i32 s58, -264
    s_movk_i32 s59, -144
    s_movk_i32 s60, 16128
    s_movk_i32 s61, 1344
    s_mul_i32 s62, s53, 12
    s_mul_i32 s63, s54, 12
    v_mov_b32 v172, 1073741824
    v_add_u32 v168, s55, v0
    v_mul_u32_u24 v169, 497, v168
    v_lshrrev_b32 v169, 17, v169
    v_mul_u32_u24 v171, 683, v168
    v_lshrrev_b32 v171, 14, v171
    v_mad_i32_i24 v168, v169, s58, v168
    v_mul_u32_u24 v170, 171, v168
    v_lshrrev_b32 v170, 11, v170
    v_bitop3_b32 v168, v168, v171, 2 bitop3:0x78
    v_add_u32 v170, s53, v170
    v_cmp_gt_u32 vcc, 224, v170
    v_mad_u32_u24 v168, v169, s60, v168
    v_add_lshl_u32 v168, v168, s62, 4
    v_cndmask_b32 v160, v172, v168, vcc
    s_sub_u32 s50, s35, 3
    s_ashr_i32 s52, s50, 1
    s_mul_i32 s50, s50, 43008
    s_mul_i32 s52, s52, 21504
    s_add_u32 s5, s50, 43008
    s_add_u32 s6, s50, 86016
    s_mov_b32 s10, 9633792
    s_mov_b32 s11, 0x20000
    s_waitcnt lgkmcnt(0)
    s_mov_b32 s8, s36
    s_mov_b32 s9, s37
    s_mov_b32 s16, s40
    s_mov_b32 s17, s41
    s_mov_b32 s18, 18432
    s_mov_b32 s19, 0x20000
    s_mul_i32 s69, s3, 5120
    s_add_u32 m0, s69, 129792
    s_add_u32 s51, s55, 256
    buffer_load_dwordx4 v1, s[16:19], s69 offen offset:0 lds
    buffer_load_dwordx4 v1, s[16:19], s69 offen offset:1024 lds
    buffer_load_dwordx4 v1, s[16:19], s69 offen offset:2048 lds
    buffer_load_dwordx4 v1, s[16:19], s69 offen offset:3072 lds
    s_add_u32 s69, s69, 4096
    s_add_u32 m0, s69, 129792
    s_nop 0
    buffer_load_dwordx4 v1, s[16:19], s69 offen lds
    v_add_u32 v168, s55, v0
    v_mul_u32_u24 v169, 911, v168
    v_lshrrev_b32 v169, 17, v169
    v_mad_i32_i24 v168, v169, s59, v168
    v_mul_u32_u24 v170, 171, v168
    v_lshrrev_b32 v170, 11, v170
    v_add_u32 v171, 2, v170
    v_lshrrev_b32 v171, 2, v171
    v_bitop3_b32 v168, v168, v171, 2 bitop3:0x78
    v_add_u32 v170, s54, v170
    v_cmp_gt_u32 vcc, 112, v170
    v_mad_u32_u24 v168, v169, s61, v168
    v_add_lshl_u32 v168, v168, s63, 4
    v_cndmask_b32 v164, v172, v168, vcc
    s_mov_b32 s12, s38
    s_mov_b32 s13, s39
    s_mov_b32 s14, 2408448
    s_mov_b32 s15, 0x20000
    s_add_u32 s7, s52, 86016
    s_add_u32 s57, s52, 172032
    s_add_u32 s4, s50, 774144
    s_add_u32 m0, s56, 102144
    v_add_u32 v173, s52, v164
    buffer_load_dwordx4 v173, s[12:15], 0 offen lds
    s_add_u32 m0, s56, 111360
    s_nop 0
    buffer_load_dwordx4 v164, s[12:15], s7 offen lds
    s_add_u32 m0, s56, 120576
    s_nop 0
    buffer_load_dwordx4 v164, s[12:15], s57 offen lds
    v_add_u32 v168, s51, v0
    v_mul_u32_u24 v169, 911, v168
    v_lshrrev_b32 v169, 17, v169
    v_mad_i32_i24 v168, v169, s59, v168
    v_mul_u32_u24 v170, 171, v168
    v_lshrrev_b32 v170, 11, v170
    v_add_u32 v171, 2, v170
    v_lshrrev_b32 v171, 2, v171
    v_bitop3_b32 v168, v168, v171, 2 bitop3:0x78
    v_add_u32 v170, s54, v170
    v_cmp_gt_u32 vcc, 112, v170
    v_mad_u32_u24 v168, v169, s61, v168
    v_add_lshl_u32 v168, v168, s63, 4
    v_cndmask_b32 v165, v172, v168, vcc
    s_add_u32 m0, s56, 106240
    v_add_u32 v173, s52, v165
    buffer_load_dwordx4 v173, s[12:15], 0 offen lds
    s_add_u32 m0, s56, 115456
    s_nop 0
    buffer_load_dwordx4 v165, s[12:15], s7 offen lds
    s_add_u32 m0, s56, 124672
    s_nop 0
    buffer_load_dwordx4 v165, s[12:15], s57 offen lds
    s_add_u32 m0, s56, 0
    v_add_u32 v173, s50, v160
    buffer_load_dwordx4 v173, s[8:11], 0 offen lds
    v_add_u32 v168, s51, v0
    v_mul_u32_u24 v169, 497, v168
    v_lshrrev_b32 v169, 17, v169
    v_mul_u32_u24 v171, 683, v168
    v_lshrrev_b32 v171, 14, v171
    v_mad_i32_i24 v168, v169, s58, v168
    v_mul_u32_u24 v170, 171, v168
    v_lshrrev_b32 v170, 11, v170
    v_bitop3_b32 v168, v168, v171, 2 bitop3:0x78
    v_add_u32 v170, s53, v170
    v_cmp_gt_u32 vcc, 224, v170
    v_mad_u32_u24 v168, v169, s60, v168
    v_add_lshl_u32 v168, v168, s62, 4
    v_cndmask_b32 v161, v172, v168, vcc
    s_add_u32 m0, s56, 4096
    v_add_u32 v173, s50, v161
    buffer_load_dwordx4 v173, s[8:11], 0 offen lds
    s_cmp_eq_u32 s3, 0
    s_cbranch_scc1 L_nou
    v_add_u32 v168, 512, v0
    v_mul_u32_u24 v169, 911, v168
    v_lshrrev_b32 v169, 17, v169
    v_mad_i32_i24 v168, v169, s59, v168
    v_mul_u32_u24 v170, 171, v168
    v_lshrrev_b32 v170, 11, v170
    v_add_u32 v171, 2, v170
    v_lshrrev_b32 v171, 2, v171
    v_bitop3_b32 v168, v168, v171, 2 bitop3:0x78
    v_add_u32 v170, s54, v170
    v_cmp_gt_u32 vcc, 112, v170
    v_mad_u32_u24 v168, v169, s61, v168
    v_add_lshl_u32 v168, v168, s63, 4
    v_cndmask_b32 v166, v172, v168, vcc
    s_sub_u32 s69, s3, 1
    s_mul_i32 s75, s69, 86016
    s_mul_i32 s69, s69, 9216
    s_add_u32 s75, s75, s52
    s_add_u32 m0, s69, 110336
    v_add_u32 v173, s75, v166
    buffer_load_dwordx4 v173, s[12:15], 0 offen lds
L_nou:
    v_add_u32 v168, 768, v0
    v_mul_u32_u24 v169, 497, v168
    v_lshrrev_b32 v169, 17, v169
    v_mul_u32_u24 v171, 683, v168
    v_lshrrev_b32 v171, 14, v171
    v_mad_i32_i24 v168, v169, s58, v168
    v_mul_u32_u24 v170, 171, v168
    v_lshrrev_b32 v170, 11, v170
    v_bitop3_b32 v168, v168, v171, 2 bitop3:0x78
    v_add_u32 v170, s53, v170
    v_cmp_gt_u32 vcc, 224, v170
    v_mad_u32_u24 v168, v169, s60, v168
    v_add_lshl_u32 v168, v168, s62, 4
    v_cndmask_b32 v163, v172, v168, vcc
    s_cmp_eq_u32 s3, 0
    s_cbranch_scc0 L_ow1
    s_mov_b32 m0, 12288
    v_add_u32 v173, s50, v163
    s_mov_b64 exec, 0xffffff
    buffer_load_dwordx4 v173, s[8:11], 0 offen lds
    s_mov_b64 exec, -1
L_ow1:
    s_add_u32 s51, s55, 512
    v_add_u32 v168, s51, v0
    v_mul_u32_u24 v169, 497, v168
    v_lshrrev_b32 v169, 17, v169
    v_mul_u32_u24 v171, 683, v168
    v_lshrrev_b32 v171, 14, v171
    v_mad_i32_i24 v168, v169, s58, v168
    v_mul_u32_u24 v170, 171, v168
    v_lshrrev_b32 v170, 11, v170
    v_bitop3_b32 v168, v168, v171, 2 bitop3:0x78
    v_add_u32 v170, s53, v170
    v_cmp_gt_u32 vcc, 224, v170
    v_mad_u32_u24 v168, v169, s60, v168
    v_add_lshl_u32 v168, v168, s62, 4
    v_cndmask_b32 v162, v172, v168, vcc
    s_add_u32 m0, s56, 8192
    v_add_u32 v173, s50, v162
    buffer_load_dwordx4 v173, s[8:11], 0 offen lds
    s_add_u32 m0, s56, 17024
    v_add_u32 v173, s5, v160
    buffer_load_dwordx4 v173, s[8:11], 0 offen lds
    s_add_u32 m0, s56, 21120
    v_add_u32 v173, s5, v161
    buffer_load_dwordx4 v173, s[8:11], 0 offen lds
    s_cmp_eq_u32 s3, 1
    s_cbranch_scc0 L_ow2
    s_mov_b32 m0, 29312
    v_add_u32 v173, s5, v163
    s_mov_b64 exec, 0xffffff
    buffer_load_dwordx4 v173, s[8:11], 0 offen lds
    s_mov_b64 exec, -1
L_ow2:
    s_add_u32 m0, s56, 25216
    v_add_u32 v173, s5, v162
    buffer_load_dwordx4 v173, s[8:11], 0 offen lds
    s_add_u32 m0, s56, 34048
    v_add_u32 v173, s6, v160
    buffer_load_dwordx4 v173, s[8:11], 0 offen lds
    s_add_u32 m0, s56, 38144
    v_add_u32 v173, s6, v161
    buffer_load_dwordx4 v173, s[8:11], 0 offen lds
    s_cmp_eq_u32 s3, 2
    s_cbranch_scc0 L_ow3
    s_mov_b32 m0, 46336
    v_add_u32 v173, s6, v163
    s_mov_b64 exec, 0xffffff
    buffer_load_dwordx4 v173, s[8:11], 0 offen lds
    s_mov_b64 exec, -1
L_ow3:
    s_add_u32 m0, s56, 42240
    v_add_u32 v173, s6, v162
    buffer_load_dwordx4 v173, s[8:11], 0 offen lds
    s_add_u32 s50, s50, 129024
    s_branch L_body
.p2align 12
L_prod:
    s_mov_b32 s20, s48
    s_mov_b32 s21, s49
    s_mov_b32 s22, 1425408
    s_mov_b32 s23, 0x20000
    s_mov_b32 s28, s46
    s_mov_b32 s29, s47
    s_mov_b32 s30, 256
    s_mov_b32 s31, 0x20000
    v_lshrrev_b32 v3, 2, v254
    v_lshl_add_u32 v3, v255, 3, v3
    v_mul_u32_u24 v3, 96, v3
    v_and_b32 v4, 3, v254
    s_cmp_eq_u32 s3, 2
    s_cselect_b32 s50, 3, 4
    s_lshl_b32 s51, s3, 3
    s_cmp_eq_u32 s3, 2
    s_cselect_b32 s51, 64, s51
    v_lshlrev_b32 v4, s50, v4
    v_add3_u32 v3, v3, v4, s51
    s_mov_b32 s58, 0xbed4ad4b
    s_mov_b32 s62, 0x3e3d0bd1
    s_mov_b32 s59, 0xbe8dc8dd
    s_mov_b32 s63, 0x3e8dc8dd
    s_mov_b32 s60, 0xbe3d0bd1
    s_mov_b32 s64, 0x3ed4ad4b
    s_mov_b32 s61, 0xbdfc0fc1
    s_mov_b32 s65, 0x3f1f81f8
    s_cmp_ge_u32 s6, 10
    s_cselect_b32 s66, s61, 0
    s_cselect_b32 s67, s65, 0
    s_cselect_b32 s68, 0, s58
    s_cselect_b32 s69, 0, s62
    s_mul_i32 s50, s33, 348
    s_lshl_b32 s55, s3, 1
    s_add_u32 s50, s50, s55
    s_mul_i32 s51, s5, 14
    s_lshl_b32 s52, s4, 1
    s_add_u32 s51, s51, s52
    s_cmp_lt_u32 s51, 10
    s_cselect_b32 s70, s4, s51
    s_cselect_b32 s75, 5, 1
    s_mul_i32 s75, s75, 6144
    s_mul_i32 s70, s70, 6
    s_add_u32 s70, s70, s50
    s_lshl_b32 s70, s70, 10
    s_add_u32 s71, s70, 712704
    s_sub_u32 s53, 6, s4
    s_mul_i32 s51, s53, 3
    s_add_u32 s52, s51, s5
    s_sub_u32 s53, 11, s5
    s_cmp_eq_u32 s4, 3
    s_cselect_b32 s74, s53, s52
    s_mul_i32 s51, s6, 6
    s_mul_i32 s52, s6, 3
    s_add_u32 s52, s52, 33
    s_sub_u32 s52, s52, s3
    s_cmp_le_u32 s6, 10
    s_cselect_b32 s72, s51, s52
    s_add_u32 s72, s72, s50
    s_add_u32 s72, s72, 252
    s_lshl_b32 s72, s72, 10
    s_mul_i32 s51, s74, 6
    s_mul_i32 s52, s74, 3
    s_add_u32 s52, s52, 33
    s_sub_u32 s52, s52, s3
    s_cmp_le_u32 s74, 10
    s_cselect_b32 s73, s51, s52
    s_add_u32 s73, s73, s50
    s_add_u32 s73, s73, 948
    s_lshl_b32 s73, s73, 10
    s_waitcnt vmcnt(0)
    s_barrier
    ds_read_b64_tr_b16 v[20:21], v3 offset:0
    ds_read_b64_tr_b16 v[22:23], v3 offset:384
    ds_read_b64_tr_b16 v[24:25], v3 offset:3072
    ds_read_b64_tr_b16 v[26:27], v3 offset:3456
    ds_read_b64_tr_b16 v[28:29], v3 offset:6144
    ds_read_b64_tr_b16 v[30:31], v3 offset:6528
    ds_read_b64_tr_b16 v[32:33], v3 offset:9216
    ds_read_b64_tr_b16 v[34:35], v3 offset:9600
    ds_read_b64_tr_b16 v[36:37], v3 offset:12288
    ds_read_b64_tr_b16 v[38:39], v3 offset:12672
    ds_read_b64_tr_b16 v[40:41], v3 offset:15360
    ds_read_b64_tr_b16 v[42:43], v3 offset:15744
    ds_read_b64_tr_b16 v[44:45], v3 offset:18432
    ds_read_b64_tr_b16 v[46:47], v3 offset:18816
    v_mov_b32 v8, 0
    v_mov_b32 v9, 0
    v_mov_b32 v10, 0
    v_mov_b32 v11, 0
    s_waitcnt lgkmcnt(0)
    buffer_store_dwordx4 v[20:23], v1, s[20:23], s72 offen offset:0 sc1
    buffer_store_dwordx4 v[44:47], v1, s[20:23], s73 offen offset:0 sc1
    s_cmp_ge_u32 s6, 10
    s_cbranch_scc1 L_pa
    buffer_store_dwordx4 v[32:35], v1, s[20:23], s72 offen offset:1024 sc1
    s_branch L_pb
L_pa:
    buffer_store_dwordx4 v[32:35], v1, s[20:23], s73 offen offset:1024 sc1
    s_cmp_eq_u32 s6, 10
    s_cbranch_scc0 L_pb
    buffer_store_dwordx4 v[8:11], v1, s[20:23], s72 offen offset:1024 sc1
L_pb:
    v_lshlrev_b32 v48, 16, v20
    v_and_b32 v49, 0xffff0000, v20
    v_lshlrev_b32 v50, 16, v21
    v_and_b32 v51, 0xffff0000, v21
    v_lshlrev_b32 v52, 16, v22
    v_and_b32 v53, 0xffff0000, v22
    v_lshlrev_b32 v54, 16, v23
    v_and_b32 v55, 0xffff0000, v23
    v_lshlrev_b32 v56, 16, v24
    v_and_b32 v57, 0xffff0000, v24
    v_lshlrev_b32 v58, 16, v25
    v_and_b32 v59, 0xffff0000, v25
    v_lshlrev_b32 v60, 16, v26
    v_and_b32 v61, 0xffff0000, v26
    v_lshlrev_b32 v62, 16, v27
    v_and_b32 v63, 0xffff0000, v27
    v_lshlrev_b32 v64, 16, v28
    v_and_b32 v65, 0xffff0000, v28
    v_lshlrev_b32 v66, 16, v29
    v_and_b32 v67, 0xffff0000, v29
    v_lshlrev_b32 v68, 16, v30
    v_and_b32 v69, 0xffff0000, v30
    v_lshlrev_b32 v70, 16, v31
    v_and_b32 v71, 0xffff0000, v31
    v_lshlrev_b32 v72, 16, v32
    v_and_b32 v73, 0xffff0000, v32
    v_lshlrev_b32 v74, 16, v33
    v_and_b32 v75, 0xffff0000, v33
    v_lshlrev_b32 v76, 16, v34
    v_and_b32 v77, 0xffff0000, v34
    v_lshlrev_b32 v78, 16, v35
    v_and_b32 v79, 0xffff0000, v35
    v_lshlrev_b32 v80, 16, v36
    v_and_b32 v81, 0xffff0000, v36
    v_lshlrev_b32 v82, 16, v37
    v_and_b32 v83, 0xffff0000, v37
    v_lshlrev_b32 v84, 16, v38
    v_and_b32 v85, 0xffff0000, v38
    v_lshlrev_b32 v86, 16, v39
    v_and_b32 v87, 0xffff0000, v39
    v_lshlrev_b32 v88, 16, v40
    v_and_b32 v89, 0xffff0000, v40
    v_lshlrev_b32 v90, 16, v41
    v_and_b32 v91, 0xffff0000, v41
    v_lshlrev_b32 v92, 16, v42
    v_and_b32 v93, 0xffff0000, v42
    v_lshlrev_b32 v94, 16, v43
    v_and_b32 v95, 0xffff0000, v43
    v_lshlrev_b32 v96, 16, v44
    v_and_b32 v97, 0xffff0000, v44
    v_lshlrev_b32 v98, 16, v45
    v_and_b32 v99, 0xffff0000, v45
    v_lshlrev_b32 v100, 16, v46
    v_and_b32 v101, 0xffff0000, v46
    v_lshlrev_b32 v102, 16, v47
    v_and_b32 v103, 0xffff0000, v47
    v_pk_mul_f32 v[136:137], v[48:49], s[58:59] op_sel:[0,0] op_sel_hi:[1,0]
    v_pk_mul_f32 v[138:139], v[56:57], s[58:59] op_sel:[0,1] op_sel_hi:[1,1]
    v_pk_fma_f32 v[136:137], v[64:65], s[60:61], v[136:137] op_sel:[0,0,0] op_sel_hi:[1,0,1]
    v_pk_fma_f32 v[138:139], v[72:73], s[66:67], v[138:139] op_sel:[0,0,0] op_sel_hi:[1,0,1]
    v_pk_add_f32 v[140:141], v[136:137], v[138:139]
    v_pk_add_f32 v[142:143], v[136:137], v[138:139] neg_lo:[0,1] neg_hi:[0,1]
    v_cvt_pk_bf16_f32 v104, v140, v141
    v_cvt_pk_bf16_f32 v108, v142, v143
    v_pk_mul_f32 v[144:145], v[50:51], s[58:59] op_sel:[0,0] op_sel_hi:[1,0]
    v_pk_mul_f32 v[146:147], v[58:59], s[58:59] op_sel:[0,1] op_sel_hi:[1,1]
    v_pk_fma_f32 v[144:145], v[66:67], s[60:61], v[144:145] op_sel:[0,0,0] op_sel_hi:[1,0,1]
    v_pk_fma_f32 v[146:147], v[74:75], s[66:67], v[146:147] op_sel:[0,0,0] op_sel_hi:[1,0,1]
    v_pk_add_f32 v[148:149], v[144:145], v[146:147]
    v_pk_add_f32 v[150:151], v[144:145], v[146:147] neg_lo:[0,1] neg_hi:[0,1]
    v_cvt_pk_bf16_f32 v105, v148, v149
    v_cvt_pk_bf16_f32 v109, v150, v151
    v_pk_mul_f32 v[136:137], v[52:53], s[58:59] op_sel:[0,0] op_sel_hi:[1,0]
    v_pk_mul_f32 v[138:139], v[60:61], s[58:59] op_sel:[0,1] op_sel_hi:[1,1]
    v_pk_fma_f32 v[136:137], v[68:69], s[60:61], v[136:137] op_sel:[0,0,0] op_sel_hi:[1,0,1]
    v_pk_fma_f32 v[138:139], v[76:77], s[66:67], v[138:139] op_sel:[0,0,0] op_sel_hi:[1,0,1]
    v_pk_add_f32 v[140:141], v[136:137], v[138:139]
    v_pk_add_f32 v[142:143], v[136:137], v[138:139] neg_lo:[0,1] neg_hi:[0,1]
    v_cvt_pk_bf16_f32 v106, v140, v141
    v_cvt_pk_bf16_f32 v110, v142, v143
    v_pk_mul_f32 v[144:145], v[54:55], s[58:59] op_sel:[0,0] op_sel_hi:[1,0]
    v_pk_mul_f32 v[146:147], v[62:63], s[58:59] op_sel:[0,1] op_sel_hi:[1,1]
    v_pk_fma_f32 v[144:145], v[70:71], s[60:61], v[144:145] op_sel:[0,0,0] op_sel_hi:[1,0,1]
    v_pk_fma_f32 v[146:147], v[78:79], s[66:67], v[146:147] op_sel:[0,0,0] op_sel_hi:[1,0,1]
    v_pk_add_f32 v[148:149], v[144:145], v[146:147]
    v_pk_add_f32 v[150:151], v[144:145], v[146:147] neg_lo:[0,1] neg_hi:[0,1]
    v_cvt_pk_bf16_f32 v107, v148, v149
    v_cvt_pk_bf16_f32 v111, v150, v151
    buffer_store_dwordx4 v[104:107], v1, s[20:23], s70 offen offset:0 sc1
    s_add_u32 s50, s70, s75
    buffer_store_dwordx4 v[108:111], v1, s[20:23], s50 offen offset:0 sc1
    v_pk_mul_f32 v[136:137], v[72:73], s[68:69] op_sel:[0,0] op_sel_hi:[1,0]
    v_pk_mul_f32 v[138:139], v[80:81], s[58:59] op_sel:[0,1] op_sel_hi:[1,1]
    v_pk_fma_f32 v[136:137], v[88:89], s[60:61], v[136:137] op_sel:[0,0,0] op_sel_hi:[1,0,1]
    v_pk_fma_f32 v[138:139], v[96:97], s[60:61], v[138:139] op_sel:[0,1,0] op_sel_hi:[1,1,1]
    v_pk_add_f32 v[140:141], v[136:137], v[138:139]
    v_pk_add_f32 v[142:143], v[136:137], v[138:139] neg_lo:[0,1] neg_hi:[0,1]
    v_cvt_pk_bf16_f32 v112, v140, v141
    v_cvt_pk_bf16_f32 v116, v142, v143
    v_pk_mul_f32 v[144:145], v[74:75], s[68:69] op_sel:[0,0] op_sel_hi:[1,0]
    v_pk_mul_f32 v[146:147], v[82:83], s[58:59] op_sel:[0,1] op_sel_hi:[1,1]
    v_pk_fma_f32 v[144:145], v[90:91], s[60:61], v[144:145] op_sel:[0,0,0] op_sel_hi:[1,0,1]
    v_pk_fma_f32 v[146:147], v[98:99], s[60:61], v[146:147] op_sel:[0,1,0] op_sel_hi:[1,1,1]
    v_pk_add_f32 v[148:149], v[144:145], v[146:147]
    v_pk_add_f32 v[150:151], v[144:145], v[146:147] neg_lo:[0,1] neg_hi:[0,1]
    v_cvt_pk_bf16_f32 v113, v148, v149
    v_cvt_pk_bf16_f32 v117, v150, v151
    v_pk_mul_f32 v[136:137], v[76:77], s[68:69] op_sel:[0,0] op_sel_hi:[1,0]
    v_pk_mul_f32 v[138:139], v[84:85], s[58:59] op_sel:[0,1] op_sel_hi:[1,1]
    v_pk_fma_f32 v[136:137], v[92:93], s[60:61], v[136:137] op_sel:[0,0,0] op_sel_hi:[1,0,1]
    v_pk_fma_f32 v[138:139], v[100:101], s[60:61], v[138:139] op_sel:[0,1,0] op_sel_hi:[1,1,1]
    v_pk_add_f32 v[140:141], v[136:137], v[138:139]
    v_pk_add_f32 v[142:143], v[136:137], v[138:139] neg_lo:[0,1] neg_hi:[0,1]
    v_cvt_pk_bf16_f32 v114, v140, v141
    v_cvt_pk_bf16_f32 v118, v142, v143
    v_pk_mul_f32 v[144:145], v[78:79], s[68:69] op_sel:[0,0] op_sel_hi:[1,0]
    v_pk_mul_f32 v[146:147], v[86:87], s[58:59] op_sel:[0,1] op_sel_hi:[1,1]
    v_pk_fma_f32 v[144:145], v[94:95], s[60:61], v[144:145] op_sel:[0,0,0] op_sel_hi:[1,0,1]
    v_pk_fma_f32 v[146:147], v[102:103], s[60:61], v[146:147] op_sel:[0,1,0] op_sel_hi:[1,1,1]
    v_pk_add_f32 v[148:149], v[144:145], v[146:147]
    v_pk_add_f32 v[150:151], v[144:145], v[146:147] neg_lo:[0,1] neg_hi:[0,1]
    v_cvt_pk_bf16_f32 v115, v148, v149
    v_cvt_pk_bf16_f32 v119, v150, v151
    buffer_store_dwordx4 v[112:115], v1, s[20:23], s70 offen offset:1024 sc1
    s_add_u32 s50, s70, s75
    buffer_store_dwordx4 v[116:119], v1, s[20:23], s50 offen offset:1024 sc1
    v_pk_mul_f32 v[136:137], v[48:49], s[62:63] op_sel:[0,0] op_sel_hi:[1,0]
    v_pk_mul_f32 v[138:139], v[56:57], s[62:63] op_sel:[0,1] op_sel_hi:[1,1]
    v_pk_fma_f32 v[136:137], v[64:65], s[64:65], v[136:137] op_sel:[0,0,0] op_sel_hi:[1,0,1]
    v_pk_fma_f32 v[138:139], v[72:73], s[66:67], v[138:139] op_sel:[0,1,0] op_sel_hi:[1,1,1]
    v_pk_add_f32 v[140:141], v[136:137], v[138:139]
    v_pk_add_f32 v[142:143], v[136:137], v[138:139] neg_lo:[0,1] neg_hi:[0,1]
    v_cvt_pk_bf16_f32 v120, v140, v141
    v_cvt_pk_bf16_f32 v124, v142, v143
    v_pk_mul_f32 v[144:145], v[50:51], s[62:63] op_sel:[0,0] op_sel_hi:[1,0]
    v_pk_mul_f32 v[146:147], v[58:59], s[62:63] op_sel:[0,1] op_sel_hi:[1,1]
    v_pk_fma_f32 v[144:145], v[66:67], s[64:65], v[144:145] op_sel:[0,0,0] op_sel_hi:[1,0,1]
    v_pk_fma_f32 v[146:147], v[74:75], s[66:67], v[146:147] op_sel:[0,1,0] op_sel_hi:[1,1,1]
    v_pk_add_f32 v[148:149], v[144:145], v[146:147]
    v_pk_add_f32 v[150:151], v[144:145], v[146:147] neg_lo:[0,1] neg_hi:[0,1]
    v_cvt_pk_bf16_f32 v121, v148, v149
    v_cvt_pk_bf16_f32 v125, v150, v151
    v_pk_mul_f32 v[136:137], v[52:53], s[62:63] op_sel:[0,0] op_sel_hi:[1,0]
    v_pk_mul_f32 v[138:139], v[60:61], s[62:63] op_sel:[0,1] op_sel_hi:[1,1]
    v_pk_fma_f32 v[136:137], v[68:69], s[64:65], v[136:137] op_sel:[0,0,0] op_sel_hi:[1,0,1]
    v_pk_fma_f32 v[138:139], v[76:77], s[66:67], v[138:139] op_sel:[0,1,0] op_sel_hi:[1,1,1]
    v_pk_add_f32 v[140:141], v[136:137], v[138:139]
    v_pk_add_f32 v[142:143], v[136:137], v[138:139] neg_lo:[0,1] neg_hi:[0,1]
    v_cvt_pk_bf16_f32 v122, v140, v141
    v_cvt_pk_bf16_f32 v126, v142, v143
    v_pk_mul_f32 v[144:145], v[54:55], s[62:63] op_sel:[0,0] op_sel_hi:[1,0]
    v_pk_mul_f32 v[146:147], v[62:63], s[62:63] op_sel:[0,1] op_sel_hi:[1,1]
    v_pk_fma_f32 v[144:145], v[70:71], s[64:65], v[144:145] op_sel:[0,0,0] op_sel_hi:[1,0,1]
    v_pk_fma_f32 v[146:147], v[78:79], s[66:67], v[146:147] op_sel:[0,1,0] op_sel_hi:[1,1,1]
    v_pk_add_f32 v[148:149], v[144:145], v[146:147]
    v_pk_add_f32 v[150:151], v[144:145], v[146:147] neg_lo:[0,1] neg_hi:[0,1]
    v_cvt_pk_bf16_f32 v123, v148, v149
    v_cvt_pk_bf16_f32 v127, v150, v151
    buffer_store_dwordx4 v[120:123], v1, s[20:23], s71 offen offset:1024 sc1
    s_add_u32 s50, s71, s75
    buffer_store_dwordx4 v[124:127], v1, s[20:23], s50 offen offset:1024 sc1
    v_pk_mul_f32 v[136:137], v[72:73], s[68:69] op_sel:[0,1] op_sel_hi:[1,1]
    v_pk_mul_f32 v[138:139], v[80:81], s[62:63] op_sel:[0,1] op_sel_hi:[1,1]
    v_pk_fma_f32 v[136:137], v[88:89], s[64:65], v[136:137] op_sel:[0,0,0] op_sel_hi:[1,0,1]
    v_pk_fma_f32 v[138:139], v[96:97], s[64:65], v[138:139] op_sel:[0,1,0] op_sel_hi:[1,1,1]
    v_pk_add_f32 v[140:141], v[136:137], v[138:139]
    v_pk_add_f32 v[142:143], v[136:137], v[138:139] neg_lo:[0,1] neg_hi:[0,1]
    v_cvt_pk_bf16_f32 v128, v140, v141
    v_cvt_pk_bf16_f32 v132, v142, v143
    v_pk_mul_f32 v[144:145], v[74:75], s[68:69] op_sel:[0,1] op_sel_hi:[1,1]
    v_pk_mul_f32 v[146:147], v[82:83], s[62:63] op_sel:[0,1] op_sel_hi:[1,1]
    v_pk_fma_f32 v[144:145], v[90:91], s[64:65], v[144:145] op_sel:[0,0,0] op_sel_hi:[1,0,1]
    v_pk_fma_f32 v[146:147], v[98:99], s[64:65], v[146:147] op_sel:[0,1,0] op_sel_hi:[1,1,1]
    v_pk_add_f32 v[148:149], v[144:145], v[146:147]
    v_pk_add_f32 v[150:151], v[144:145], v[146:147] neg_lo:[0,1] neg_hi:[0,1]
    v_cvt_pk_bf16_f32 v129, v148, v149
    v_cvt_pk_bf16_f32 v133, v150, v151
    v_pk_mul_f32 v[136:137], v[76:77], s[68:69] op_sel:[0,1] op_sel_hi:[1,1]
    v_pk_mul_f32 v[138:139], v[84:85], s[62:63] op_sel:[0,1] op_sel_hi:[1,1]
    v_pk_fma_f32 v[136:137], v[92:93], s[64:65], v[136:137] op_sel:[0,0,0] op_sel_hi:[1,0,1]
    v_pk_fma_f32 v[138:139], v[100:101], s[64:65], v[138:139] op_sel:[0,1,0] op_sel_hi:[1,1,1]
    v_pk_add_f32 v[140:141], v[136:137], v[138:139]
    v_pk_add_f32 v[142:143], v[136:137], v[138:139] neg_lo:[0,1] neg_hi:[0,1]
    v_cvt_pk_bf16_f32 v130, v140, v141
    v_cvt_pk_bf16_f32 v134, v142, v143
    v_pk_mul_f32 v[144:145], v[78:79], s[68:69] op_sel:[0,1] op_sel_hi:[1,1]
    v_pk_mul_f32 v[146:147], v[86:87], s[62:63] op_sel:[0,1] op_sel_hi:[1,1]
    v_pk_fma_f32 v[144:145], v[94:95], s[64:65], v[144:145] op_sel:[0,0,0] op_sel_hi:[1,0,1]
    v_pk_fma_f32 v[146:147], v[102:103], s[64:65], v[146:147] op_sel:[0,1,0] op_sel_hi:[1,1,1]
    v_pk_add_f32 v[148:149], v[144:145], v[146:147]
    v_pk_add_f32 v[150:151], v[144:145], v[146:147] neg_lo:[0,1] neg_hi:[0,1]
    v_cvt_pk_bf16_f32 v131, v148, v149
    v_cvt_pk_bf16_f32 v135, v150, v151
    buffer_store_dwordx4 v[128:131], v1, s[20:23], s71 offen offset:0 sc1
    s_add_u32 s50, s71, s75
    buffer_store_dwordx4 v[132:135], v1, s[20:23], s50 offen offset:0 sc1
    s_lshl_b32 s50, s4, 1
    s_add_u32 s50, s50, s33
    s_mul_i32 s51, s5, 14
    s_add_u32 s51, s51, s50
    s_sub_u32 s51, s51, 14
    s_add_u32 s50, s50, 28
    s_cmp_eq_u32 s5, 0
    s_cselect_b32 s34, s50, s51
    s_lshl_b32 s34, s34, 2
    s_waitcnt vmcnt(0)
    s_barrier
    s_cmp_eq_u32 s3, 0
    s_cbranch_scc0 L_end
    v_mov_b32 v2, 1
    v_mov_b32 v3, 0
    s_mov_b64 exec, 1
    buffer_store_dword v2, v3, s[28:31], s34 offen offset:16 sc1
L_end:
    s_endpgm
.p2align 12
L_body:
    s_mov_b32 s24, s44
    s_mov_b32 s25, s45
    s_mov_b32 s26, 9633792
    s_mov_b32 s27, 0x20000
    s_mov_b32 s28, s46
    s_mov_b32 s29, s47
    s_mov_b32 s30, 256
    s_mov_b32 s31, 0x20000
    s_mul_i32 s77, s3, 356352
    s_add_u32 s20, s48, s77
    s_addc_u32 s21, s49, 0
    s_mov_b32 s22, 356352
    s_mov_b32 s23, 0x20000
    s_lshr_b32 s32, s3, 1
    s_and_b32 s33, s3, 1
    s_add_u32 s74, s35, 1
    s_and_b32 s74, s74, 1
    s_min_u32 s76, s3, 2
    v_mul_u32_u24 v245, 38144, v255
    v_lshrrev_b32 v240, 2, v254
    v_lshl_add_u32 v240, v255, 3, v240
    v_mul_u32_u24 v240, 192, v240
    v_and_b32 v241, 3, v254
    v_lshl_add_u32 v240, v241, 4, v240
    v_add_u32 v199, 129792, v240
    s_lshl_b32 s77, s76, 6
    v_add_u32 v200, s77, v199
    s_waitcnt vmcnt(15)
    s_barrier
    ds_read_b64_tr_b16 a[0:1], v199 offset:0
    ds_read_b64_tr_b16 a[2:3], v199 offset:768
    ds_read_b64_tr_b16 a[4:5], v199 offset:6144
    ds_read_b64_tr_b16 a[6:7], v199 offset:6912
    ds_read_b64_tr_b16 a[8:9], v199 offset:12288
    ds_read_b64_tr_b16 a[10:11], v199 offset:13056
    ds_read_b64_tr_b16 a[12:13], v199 offset:8
    ds_read_b64_tr_b16 a[14:15], v199 offset:776
    ds_read_b64_tr_b16 a[16:17], v199 offset:6152
    ds_read_b64_tr_b16 a[18:19], v199 offset:6920
    ds_read_b64_tr_b16 a[20:21], v199 offset:12296
    ds_read_b64_tr_b16 a[22:23], v199 offset:13064
    v_lshrrev_b32 v240, 2, v254
    v_cmp_eq_u32 vcc, v240, v255
    v_and_b32 v241, 1, v254
    v_lshlrev_b32 v241, 4, v241
    v_mov_b32 v242, 0x3f80
    v_lshlrev_b32 v241, v241, v242
    v_cndmask_b32 v241, 0, v241, vcc
    v_and_b32 v240, 2, v254
    v_cmp_eq_u32 vcc, 0, v240
    v_accvgpr_write_b32 a240, 0
    v_accvgpr_write_b32 a241, 0
    v_cndmask_b32 v242, 0, v241, vcc
    v_cndmask_b32 v243, v241, 0, vcc
    v_accvgpr_write_b32 a242, v242
    v_accvgpr_write_b32 a243, v243
    v_accvgpr_write_b32 a244, 0
    v_accvgpr_write_b32 a245, 0
    ds_read_b64_tr_b16 a[24:25], v199 offset:64
    ds_read_b64_tr_b16 a[26:27], v199 offset:832
    ds_read_b64_tr_b16 a[28:29], v199 offset:6208
    ds_read_b64_tr_b16 a[30:31], v199 offset:6976
    ds_read_b64_tr_b16 a[32:33], v199 offset:12352
    ds_read_b64_tr_b16 a[34:35], v199 offset:13120
    ds_read_b64_tr_b16 a[36:37], v199 offset:72
    ds_read_b64_tr_b16 a[38:39], v199 offset:840
    ds_read_b64_tr_b16 a[40:41], v199 offset:6216
    ds_read_b64_tr_b16 a[42:43], v199 offset:6984
    ds_read_b64_tr_b16 a[44:45], v199 offset:12360
    ds_read_b64_tr_b16 a[46:47], v199 offset:13128
    s_add_u32 m0, s56, 51072
    v_add_u32 v173, s50, v160
    buffer_load_dwordx4 v173, s[8:11], 0 offen lds
    s_lshl_b32 s77, s3, 4
    v_add_u32 v240, s77, v254
    v_mul_u32_u24 v241, 47, v240
    v_lshrrev_b32 v241, 10, v241
    v_mul_u32_u24 v242, 22, v241
    v_mov_b32 v249, v240
    v_sub_u32 v240, v240, v242
    v_lshrrev_b32 v243, 1, v249
    v_bitop3_b32 v243, v255, v243, 2 bitop3:0x78
    v_mul_u32_u24 v244, 192, v240
    v_lshl_add_u32 v192, v243, 4, v244
    v_mul_u32_u24 v242, 4224, v241
    v_add_u32 v192, v192, v242
    v_add_u32 v201, 51072, v192
    v_mov_b32 v250, v240
    v_add_u32 v251, 4224, v242
    ds_read_b64_tr_b16 a[48:49], v199 offset:128
    ds_read_b64_tr_b16 a[50:51], v199 offset:896
    ds_read_b64_tr_b16 a[52:53], v199 offset:6272
    ds_read_b64_tr_b16 a[54:55], v199 offset:7040
    ds_read_b64_tr_b16 a[56:57], v199 offset:12416
    ds_read_b64_tr_b16 a[58:59], v199 offset:13184
    ds_read_b64_tr_b16 a[60:61], v199 offset:136
    ds_read_b64_tr_b16 a[62:63], v199 offset:904
    ds_read_b64_tr_b16 a[64:65], v199 offset:6280
    ds_read_b64_tr_b16 a[66:67], v199 offset:7048
    ds_read_b64_tr_b16 a[68:69], v199 offset:12424
    ds_read_b64_tr_b16 a[70:71], v199 offset:13192
    s_add_u32 m0, s56, 55168
    v_add_u32 v173, s50, v161
    buffer_load_dwordx4 v173, s[8:11], 0 offen lds
    v_add_u32 v242, 1, v240
    v_lshrrev_b32 v242, 1, v242
    v_add_u32 v243, 2, v242
    v_lshrrev_b32 v243, 2, v243
    v_bitop3_b32 v243, v255, v243, 2 bitop3:0x78
    v_mul_u32_u24 v244, 192, v242
    v_lshl_add_u32 v193, v243, 4, v244
    v_mul_u32_u24 v242, 6912, v241
    v_add_u32 v193, v193, v242
    v_add_u32 v193, 102144, v193
    s_mul_i32 s77, s74, 2304
    v_add_u32 v194, s77, v193
    s_cmp_eq_u32 s3, 3
    s_cbranch_scc0 L_ow7
    s_mov_b32 m0, 63360
    v_add_u32 v173, s50, v163
    s_mov_b64 exec, 0xffffff
    buffer_load_dwordx4 v173, s[8:11], 0 offen lds
    s_mov_b64 exec, -1
L_ow7:
    s_add_u32 m0, s56, 59264
    v_add_u32 v173, s50, v162
    v_lshl_add_u32 v242, v240, 4, v245
    v_mul_u32_u24 v243, 704, v241
    v_add_u32 v2, v242, v243
    v_sub_u32 v3, v242, v243
    v_add_u32 v3, 20416, v3
    buffer_load_dwordx4 v173, s[8:11], 0 offen lds
    s_mov_b64 exec, 0
    s_cmp_eq_u32 s3, 0
    s_cbranch_scc1 L_pg1
    s_cmp_eq_u32 s3, 1
    s_cbranch_scc1 L_pg2
    s_cmp_eq_u32 s3, 2
    s_cbranch_scc1 L_pg3
    s_branch L_pg4
L_warmed:
    s_mov_b64 exec, -1
    s_waitcnt vmcnt(9)
    s_barrier
    ds_read_b128 a[156:159], v193 offset:0
    ds_read_b128 a[144:147], v192 offset:0
    ds_read_b128 a[148:151], v192 offset:64
    ds_read_b128 a[152:155], v192 offset:128
    ds_read_b128 a[160:163], v193 offset:64
    ds_read_b128 a[164:167], v193 offset:128
    s_waitcnt lgkmcnt(4)
    v_mfma_f32_16x16x32_bf16 v[16:19], a[242:245], a[156:159], 0
    s_add_u32 s50, s50, 43008
    v_mfma_f32_16x16x32_bf16 v[16:19], a[0:3], a[144:147], v[16:19]
    s_add_u32 m0, s56, 12672
    s_nop 0
    s_waitcnt lgkmcnt(3)
    v_mfma_f32_16x16x32_bf16 v[16:19], a[4:7], a[148:151], v[16:19]
    buffer_load_dwordx4 v160, s[8:11], s4 offen lds
    s_waitcnt lgkmcnt(2)
    v_mfma_f32_16x16x32_bf16 v[16:19], a[8:11], a[152:155], v[16:19]
    s_cmp_eq_u32 s3, 0
    s_cbranch_scc0 L_ow4
    s_mov_b32 m0, 16768
    s_mov_b64 exec, 0xff
    buffer_load_dwordx4 v161, s[8:11], s4 offen lds
    s_mov_b64 exec, -1
L_ow4:
    v_mfma_f32_16x16x32_bf16 v[20:23], a[240:243], a[156:159], 0
    s_add_u32 s4, s4, 43008
    v_mfma_f32_16x16x32_bf16 v[20:23], a[12:15], a[144:147], v[20:23]
    s_add_u32 m0, s56, 29696
    s_nop 0
    v_mfma_f32_16x16x32_bf16 v[20:23], a[16:19], a[148:151], v[20:23]
    buffer_load_dwordx4 v160, s[8:11], s4 offen lds
    v_mfma_f32_16x16x32_bf16 v[20:23], a[20:23], a[152:155], v[20:23]
    s_cmp_eq_u32 s3, 0
    s_cbranch_scc0 L_ow5
    s_mov_b32 m0, 33792
    s_mov_b64 exec, 0xff
    buffer_load_dwordx4 v161, s[8:11], s4 offen lds
    s_mov_b64 exec, -1
L_ow5:
    s_waitcnt lgkmcnt(0)
    v_mfma_f32_16x16x32_bf16 v[64:67], a[242:245], a[160:163], 0
    s_add_u32 s4, s4, 43008
    v_mfma_f32_16x16x32_bf16 v[64:67], a[24:27], a[144:147], v[64:67]
    s_add_u32 m0, s56, 46720
    s_nop 0
    v_mfma_f32_16x16x32_bf16 v[64:67], a[28:31], a[148:151], v[64:67]
    buffer_load_dwordx4 v160, s[8:11], s4 offen lds
    v_mfma_f32_16x16x32_bf16 v[64:67], a[32:35], a[152:155], v[64:67]
    s_cmp_eq_u32 s3, 0
    s_cbranch_scc0 L_ow6
    s_mov_b32 m0, 50816
    s_mov_b64 exec, 0xff
    buffer_load_dwordx4 v161, s[8:11], s4 offen lds
    s_mov_b64 exec, -1
L_ow6:
    v_mfma_f32_16x16x32_bf16 v[68:71], a[240:243], a[160:163], 0
    s_add_u32 m0, s56, 68096
    v_add_u32 v173, s50, v160
    v_mfma_f32_16x16x32_bf16 v[68:71], a[36:39], a[144:147], v[68:71]
    buffer_load_dwordx4 v173, s[8:11], 0 offen lds
    v_mfma_f32_16x16x32_bf16 v[68:71], a[40:43], a[148:151], v[68:71]
    v_add_u32 v240, 22, v249
    v_mul_u32_u24 v241, 993, v240
    v_mfma_f32_16x16x32_bf16 v[68:71], a[44:47], a[152:155], v[68:71]
    s_waitcnt vmcnt(10)
    s_barrier
    v_mfma_f32_16x16x32_bf16 v[112:115], a[242:245], a[164:167], 0
    ds_read_b128 a[180:183], v194 offset:0
    v_lshrrev_b32 v241, 16, v241
    v_mfma_f32_16x16x32_bf16 v[112:115], a[48:51], a[144:147], v[112:115]
    ds_read_b128 a[168:171], v192 offset:17024
    v_mul_u32_u24 v241, 66, v241
    v_mfma_f32_16x16x32_bf16 v[112:115], a[52:55], a[148:151], v[112:115]
    ds_read_b128 a[172:175], v192 offset:17088
    v_sub_u32 v240, v240, v241
    v_mfma_f32_16x16x32_bf16 v[112:115], a[56:59], a[152:155], v[112:115]
    ds_read_b128 a[176:179], v192 offset:17152
    v_lshrrev_b32 v243, 1, v240
    v_mfma_f32_16x16x32_bf16 v[116:119], a[240:243], a[164:167], 0
    ds_read_b128 a[184:187], v194 offset:64
    v_bitop3_b32 v243, v255, v243, 2 bitop3:0x78
    v_mfma_f32_16x16x32_bf16 v[116:119], a[60:63], a[144:147], v[116:119]
    ds_read_b128 a[188:191], v194 offset:128
    v_mul_u32_u24 v244, 192, v250
    v_mfma_f32_16x16x32_bf16 v[116:119], a[64:67], a[148:151], v[116:119]
    s_add_u32 m0, s56, 72192
    v_add_u32 v173, s50, v161
    v_mfma_f32_16x16x32_bf16 v[116:119], a[68:71], a[152:155], v[116:119]
    buffer_load_dwordx4 v173, s[8:11], 0 offen lds
    s_waitcnt lgkmcnt(4)
    v_mfma_f32_16x16x32_bf16 v[24:27], a[242:245], a[180:183], 0
    s_cmp_eq_u32 s3, 0
    s_cbranch_scc0 L_ow8
    s_mov_b32 m0, 80384
    v_add_u32 v173, s50, v163
    s_mov_b64 exec, 0xffffff
    buffer_load_dwordx4 v173, s[8:11], 0 offen lds
    s_mov_b64 exec, -1
L_ow8:
    v_mfma_f32_16x16x32_bf16 v[24:27], a[0:3], a[168:171], v[24:27]
    s_add_u32 m0, s56, 76288
    v_add_u32 v173, s50, v162
    s_waitcnt lgkmcnt(3)
    v_mfma_f32_16x16x32_bf16 v[24:27], a[4:7], a[172:175], v[24:27]
    buffer_load_dwordx4 v173, s[8:11], 0 offen lds
    s_waitcnt lgkmcnt(2)
    v_mfma_f32_16x16x32_bf16 v[24:27], a[8:11], a[176:179], v[24:27]
    s_add_u32 s50, s50, 43008
    v_mfma_f32_16x16x32_bf16 v[28:31], a[240:243], a[180:183], 0
    s_add_u32 m0, s56, 85120
    v_add_u32 v173, s50, v160
    v_mfma_f32_16x16x32_bf16 v[28:31], a[12:15], a[168:171], v[28:31]
    buffer_load_dwordx4 v173, s[8:11], 0 offen lds
    v_mfma_f32_16x16x32_bf16 v[28:31], a[16:19], a[172:175], v[28:31]
    v_lshl_add_u32 v202, v243, 4, v244
    v_add_u32 v202, v202, v251
    v_mfma_f32_16x16x32_bf16 v[28:31], a[20:23], a[176:179], v[28:31]
    s_add_u32 m0, s56, 89216
    v_add_u32 v173, s50, v161
    s_waitcnt lgkmcnt(0)
    v_mfma_f32_16x16x32_bf16 v[72:75], a[242:245], a[184:187], 0
    buffer_load_dwordx4 v173, s[8:11], 0 offen lds
    v_mfma_f32_16x16x32_bf16 v[72:75], a[24:27], a[168:171], v[72:75]
    s_cmp_eq_u32 s3, 1
    s_cbranch_scc0 L_ow9
    s_mov_b32 m0, 97408
    v_add_u32 v173, s50, v163
    s_mov_b64 exec, 0xffffff
    buffer_load_dwordx4 v173, s[8:11], 0 offen lds
    s_mov_b64 exec, -1
L_ow9:
    v_mfma_f32_16x16x32_bf16 v[72:75], a[28:31], a[172:175], v[72:75]
    s_add_u32 m0, s56, 93312
    v_add_u32 v173, s50, v162
    v_mfma_f32_16x16x32_bf16 v[72:75], a[32:35], a[176:179], v[72:75]
    buffer_load_dwordx4 v173, s[8:11], 0 offen lds
    v_mfma_f32_16x16x32_bf16 v[76:79], a[240:243], a[184:187], 0
    s_add_u32 s50, s50, 43008
    v_mfma_f32_16x16x32_bf16 v[76:79], a[36:39], a[168:171], v[76:79]
    v_and_b32 v240, 1, v254
    v_add_u32 v240, 20, v240
    v_mfma_f32_16x16x32_bf16 v[76:79], a[40:43], a[172:175], v[76:79]
    v_bfe_u32 v241, v254, 1, 1
    v_add_u32 v241, 4, v241
    v_mfma_f32_16x16x32_bf16 v[76:79], a[44:47], a[176:179], v[76:79]
    s_waitcnt vmcnt(12)
    s_barrier
    v_mfma_f32_16x16x32_bf16 v[120:123], a[242:245], a[188:191], 0
    ds_read_b128 a[204:207], v193 offset:2304
    s_mul_i32 s68, s76, 2112
    v_mfma_f32_16x16x32_bf16 v[120:123], a[48:51], a[168:171], v[120:123]
    ds_read_b128 a[192:195], v192 offset:34048
    v_lshl_add_u32 v242, v240, 4, v245
    v_mfma_f32_16x16x32_bf16 v[120:123], a[52:55], a[172:175], v[120:123]
    ds_read_b128 a[196:199], v192 offset:34112
    v_add_u32 v242, s68, v242
    v_mfma_f32_16x16x32_bf16 v[120:123], a[56:59], a[176:179], v[120:123]
    ds_read_b128 a[200:203], v192 offset:34176
    v_mul_u32_u24 v243, 352, v241
    v_mfma_f32_16x16x32_bf16 v[124:127], a[240:243], a[188:191], 0
    ds_read_b128 a[208:211], v193 offset:2368
    v_add_u32 v4, v242, v243
    v_mfma_f32_16x16x32_bf16 v[124:127], a[60:63], a[168:171], v[124:127]
    ds_read_b128 a[212:215], v193 offset:2432
    v_sub_u32 v5, v242, v243
    v_mfma_f32_16x16x32_bf16 v[124:127], a[64:67], a[172:175], v[124:127]
    v_add_u32 v5, 20768, v5
    v_lshrrev_b32 v246, 2, v254
    v_mfma_f32_16x16x32_bf16 v[124:127], a[68:71], a[176:179], v[124:127]
    v_min_u32 v246, 2, v246
    v_lshlrev_b32 v246, 1, v246
    s_waitcnt lgkmcnt(4)
    v_mfma_f32_16x16x32_bf16 v[32:35], a[242:245], a[204:207], 0
    v_mul_u32_u24 v241, 3, v241
    v_add_u32 v246, v246, v241
    v_mfma_f32_16x16x32_bf16 v[32:35], a[0:3], a[192:195], v[32:35]
    v_mul_u32_u24 v247, 192, v240
    v_mov_b32 v250, v240
    s_waitcnt lgkmcnt(3)
    v_mfma_f32_16x16x32_bf16 v[32:35], a[4:7], a[196:199], v[32:35]
    v_add_u32 v242, 1, v240
    v_lshrrev_b32 v242, 1, v242
    s_waitcnt lgkmcnt(2)
    v_mfma_f32_16x16x32_bf16 v[32:35], a[8:11], a[200:203], v[32:35]
    v_add_u32 v243, 2, v242
    v_lshrrev_b32 v243, 2, v243
    v_mfma_f32_16x16x32_bf16 v[36:39], a[240:243], a[204:207], 0
    v_bitop3_b32 v243, v255, v243, 2 bitop3:0x78
    v_mul_u32_u24 v244, 192, v242
    v_mfma_f32_16x16x32_bf16 v[36:39], a[12:15], a[192:195], v[36:39]
    v_lshl_add_u32 v248, v243, 4, v244
    s_lshl_b32 s77, s76, 6
    v_mfma_f32_16x16x32_bf16 v[36:39], a[16:19], a[196:199], v[36:39]
    s_add_u32 s77, s77, 102144
    v_add_u32 v248, s77, v248
    v_mfma_f32_16x16x32_bf16 v[36:39], a[20:23], a[200:203], v[36:39]
    v_add_u32 v247, 8448, v247
    v_add_u32 v242, -12, v246
    s_waitcnt lgkmcnt(0)
    v_mfma_f32_16x16x32_bf16 v[80:83], a[242:245], a[208:211], 0
    v_mul_u32_u24 v243, 43, v242
    v_lshrrev_b32 v243, 8, v243
    v_mfma_f32_16x16x32_bf16 v[80:83], a[24:27], a[192:195], v[80:83]
    v_mul_u32_u24 v242, 17024, v242
    v_lshlrev_b32 v244, 1, v243
    v_mfma_f32_16x16x32_bf16 v[80:83], a[28:31], a[196:199], v[80:83]
    v_xor_b32 v244, v244, v255
    v_lshl_add_u32 v242, v244, 4, v242
    v_mfma_f32_16x16x32_bf16 v[80:83], a[32:35], a[200:203], v[80:83]
    v_mul_u32_u24 v243, 97920, v243
    v_add_u32 v242, v242, v247
    v_mfma_f32_16x16x32_bf16 v[84:87], a[240:243], a[208:211], 0
    v_sub_u32 v195, v242, v243
    v_add_u32 v242, s74, v246
    v_mfma_f32_16x16x32_bf16 v[84:87], a[36:39], a[192:195], v[84:87]
    v_lshrrev_b32 v242, 1, v242
    v_mul_u32_u24 v242, 2304, v242
    v_mfma_f32_16x16x32_bf16 v[84:87], a[40:43], a[196:199], v[84:87]
    v_add_u32 v197, v248, v242
    v_add_u32 v246, 1, v246
    v_mfma_f32_16x16x32_bf16 v[84:87], a[44:47], a[200:203], v[84:87]
    s_waitcnt vmcnt(9)
    s_barrier
    v_mfma_f32_16x16x32_bf16 v[128:131], a[242:245], a[212:215], 0
    ds_read_b128 a[84:87], v194 offset:2304
    v_add_u32 v242, -12, v246
    v_mfma_f32_16x16x32_bf16 v[128:131], a[48:51], a[192:195], v[128:131]
    ds_read_b128 a[72:75], v201 offset:0
    v_mul_u32_u24 v243, 43, v242
    v_mfma_f32_16x16x32_bf16 v[128:131], a[52:55], a[196:199], v[128:131]
    ds_read_b128 a[76:79], v201 offset:64
    v_lshrrev_b32 v243, 8, v243
    v_mfma_f32_16x16x32_bf16 v[128:131], a[56:59], a[200:203], v[128:131]
    ds_read_b128 a[80:83], v201 offset:128
    v_mul_u32_u24 v242, 17024, v242
    v_mfma_f32_16x16x32_bf16 v[132:135], a[240:243], a[212:215], 0
    ds_read_b128 a[88:91], v194 offset:2368
    v_lshlrev_b32 v244, 1, v243
    v_mfma_f32_16x16x32_bf16 v[132:135], a[60:63], a[192:195], v[132:135]
    ds_read_b128 a[92:95], v194 offset:2432
    v_xor_b32 v244, v244, v255
    v_mfma_f32_16x16x32_bf16 v[132:135], a[64:67], a[196:199], v[132:135]
    v_lshl_add_u32 v242, v244, 4, v242
    v_mul_u32_u24 v243, 97920, v243
    v_mfma_f32_16x16x32_bf16 v[132:135], a[68:71], a[200:203], v[132:135]
    v_add_u32 v242, v242, v247
    v_sub_u32 v196, v242, v243
    s_waitcnt lgkmcnt(4)
    v_mfma_f32_16x16x32_bf16 v[40:43], a[242:245], a[84:87], 0
    ds_read_b64_tr_b16 a[216:217], v200 offset:0
    v_add_u32 v242, s74, v246
    v_mfma_f32_16x16x32_bf16 v[40:43], a[0:3], a[72:75], v[40:43]
    ds_read_b64_tr_b16 a[218:219], v200 offset:768
    v_lshrrev_b32 v242, 1, v242
    s_waitcnt lgkmcnt(5)
    v_mfma_f32_16x16x32_bf16 v[40:43], a[4:7], a[76:79], v[40:43]
    ds_read_b64_tr_b16 a[220:221], v200 offset:6144
    v_mul_u32_u24 v242, 2304, v242
    s_waitcnt lgkmcnt(5)
    v_mfma_f32_16x16x32_bf16 v[40:43], a[8:11], a[80:83], v[40:43]
    ds_read_b64_tr_b16 a[222:223], v200 offset:6912
    v_add_u32 v198, v248, v242
    v_mfma_f32_16x16x32_bf16 v[44:47], a[240:243], a[84:87], 0
    ds_read_b64_tr_b16 a[224:225], v200 offset:12288
    s_lshl_b32 s70, s32, 5
    v_mfma_f32_16x16x32_bf16 v[44:47], a[12:15], a[72:75], v[44:47]
    ds_read_b64_tr_b16 a[226:227], v200 offset:13056
    s_sub_u32 s70, 16, s70
    v_mfma_f32_16x16x32_bf16 v[44:47], a[16:19], a[76:79], v[44:47]
    ds_read_b64_tr_b16 a[228:229], v200 offset:8
    s_mul_i32 s71, s32, 14
    v_mfma_f32_16x16x32_bf16 v[44:47], a[20:23], a[80:83], v[44:47]
    ds_read_b64_tr_b16 a[230:231], v200 offset:776
    s_mul_i32 s72, s32, 12
    s_waitcnt lgkmcnt(8)
    v_mfma_f32_16x16x32_bf16 v[88:91], a[242:245], a[88:91], 0
    ds_read_b64_tr_b16 a[232:233], v200 offset:6152
    s_add_u32 s72, s72, 1
    v_mfma_f32_16x16x32_bf16 v[88:91], a[24:27], a[72:75], v[88:91]
    ds_read_b64_tr_b16 a[234:235], v200 offset:6920
    s_mul_i32 s73, s70, 8064
    v_mfma_f32_16x16x32_bf16 v[88:91], a[28:31], a[76:79], v[88:91]
    ds_read_b64_tr_b16 a[236:237], v200 offset:12296
    s_add_u32 s71, s71, s35
    v_mfma_f32_16x16x32_bf16 v[88:91], a[32:35], a[80:83], v[88:91]
    ds_read_b64_tr_b16 a[238:239], v200 offset:13064
    s_mul_i32 s71, s71, 224
    v_mfma_f32_16x16x32_bf16 v[92:95], a[240:243], a[88:91], 0
    s_add_u32 s71, s71, s34
    s_mul_i32 s71, s71, 192
    v_mfma_f32_16x16x32_bf16 v[92:95], a[36:39], a[72:75], v[92:95]
    s_add_u32 s72, s72, s35
    s_mul_i32 s72, s72, 224
    v_mfma_f32_16x16x32_bf16 v[92:95], a[40:43], a[76:79], v[92:95]
    s_add_u32 s72, s72, s34
    s_mul_i32 s72, s72, 192
    v_mfma_f32_16x16x32_bf16 v[92:95], a[44:47], a[80:83], v[92:95]
    s_waitcnt vmcnt(3)
    s_barrier
    v_mfma_f32_16x16x32_bf16 v[136:139], a[242:245], a[92:95], 0
    ds_read_b128 a[108:111], v193 offset:4608
    s_mul_i32 s77, s32, 19008
    v_mfma_f32_16x16x32_bf16 v[136:139], a[48:51], a[72:75], v[136:139]
    ds_read_b128 a[96:99], v201 offset:17024
    v_lshl_add_u32 v254, v254, 4, v245
    v_mfma_f32_16x16x32_bf16 v[136:139], a[52:55], a[76:79], v[136:139]
    ds_read_b128 a[100:103], v201 offset:17088
    v_add_u32 v254, s77, v254
    v_mfma_f32_16x16x32_bf16 v[136:139], a[56:59], a[80:83], v[136:139]
    ds_read_b128 a[104:107], v201 offset:17152
    v_min_u32 v7, 13, v0
    v_mfma_f32_16x16x32_bf16 v[140:143], a[240:243], a[92:95], 0
    ds_read_b128 a[112:115], v193 offset:4672
    v_add_lshl_u32 v7, v7, 28, 2
    v_mfma_f32_16x16x32_bf16 v[140:143], a[60:63], a[72:75], v[140:143]
    ds_read_b128 a[116:119], v193 offset:4736
    s_mov_b32 s58, 0x40100000
    v_mfma_f32_16x16x32_bf16 v[140:143], a[64:67], a[76:79], v[140:143]
    s_mov_b32 s59, 0x40100000
    s_mov_b32 s60, 0x3f2aaaab
    v_mfma_f32_16x16x32_bf16 v[140:143], a[68:71], a[80:83], v[140:143]
    s_mov_b32 s61, 0x3f2aaaab
    s_mov_b32 s62, 0x3ee38e39
    s_waitcnt lgkmcnt(4)
    v_mfma_f32_16x16x32_bf16 v[48:51], a[242:245], a[108:111], 0
    ds_read_b128 a[156:159], v193 offset:6912
    s_mov_b32 s63, 0x3ee38e39
    v_mfma_f32_16x16x32_bf16 v[48:51], a[0:3], a[96:99], v[48:51]
    ds_read_b128 a[144:147], v202 offset:0
    s_mov_b32 s64, 0x3fc00000
    s_waitcnt lgkmcnt(5)
    v_mfma_f32_16x16x32_bf16 v[48:51], a[4:7], a[100:103], v[48:51]
    ds_read_b128 a[148:151], v202 offset:64
    s_mov_b32 s65, 0x3fc00000
    s_waitcnt lgkmcnt(5)
    v_mfma_f32_16x16x32_bf16 v[48:51], a[8:11], a[104:107], v[48:51]
    ds_read_b128 a[152:155], v202 offset:128
    s_mov_b32 s66, 0x402c71c7
    v_mfma_f32_16x16x32_bf16 v[52:55], a[240:243], a[108:111], 0
    ds_read_b128 a[160:163], v193 offset:6976
    s_mov_b32 s67, 0x402c71c7
    v_mfma_f32_16x16x32_bf16 v[52:55], a[12:15], a[96:99], v[52:55]
    ds_read_b128 a[164:167], v193 offset:7040
    v_mfma_f32_16x16x32_bf16 v[52:55], a[16:19], a[100:103], v[52:55]
    ds_read_b128 a[180:183], v194 offset:6912
    v_mfma_f32_16x16x32_bf16 v[52:55], a[20:23], a[104:107], v[52:55]
    ds_read_b128 a[168:171], v202 offset:17024
    s_waitcnt lgkmcnt(8)
    v_mfma_f32_16x16x32_bf16 v[96:99], a[242:245], a[112:115], 0
    ds_read_b128 a[172:175], v202 offset:17088
    v_mfma_f32_16x16x32_bf16 v[96:99], a[24:27], a[96:99], v[96:99]
    ds_read_b128 a[176:179], v202 offset:17152
    v_mfma_f32_16x16x32_bf16 v[96:99], a[28:31], a[100:103], v[96:99]
    ds_read_b128 a[184:187], v194 offset:6976
    v_mfma_f32_16x16x32_bf16 v[96:99], a[32:35], a[104:107], v[96:99]
    ds_read_b128 a[188:191], v194 offset:7040
    v_mfma_f32_16x16x32_bf16 v[100:103], a[240:243], a[112:115], 0
    ds_read_b128 a[204:207], v193 offset:9216
    v_mfma_f32_16x16x32_bf16 v[100:103], a[36:39], a[96:99], v[100:103]
    ds_read_b128 a[192:195], v202 offset:34048
    v_mfma_f32_16x16x32_bf16 v[100:103], a[40:43], a[100:103], v[100:103]
    ds_read_b128 a[196:199], v202 offset:34112
    v_mfma_f32_16x16x32_bf16 v[100:103], a[44:47], a[104:107], v[100:103]
    s_waitcnt vmcnt(0)
    s_barrier
    v_mfma_f32_16x16x32_bf16 v[144:147], a[242:245], a[116:119], 0
    ds_read_b128 a[132:135], v194 offset:4608
    v_mfma_f32_16x16x32_bf16 v[144:147], a[48:51], a[96:99], v[144:147]
    ds_read_b128 a[120:123], v201 offset:34048
    v_mfma_f32_16x16x32_bf16 v[144:147], a[52:55], a[100:103], v[144:147]
    ds_read_b128 a[124:127], v201 offset:34112
    v_mfma_f32_16x16x32_bf16 v[144:147], a[56:59], a[104:107], v[144:147]
    ds_read_b128 a[128:131], v201 offset:34176
    v_mfma_f32_16x16x32_bf16 v[148:151], a[240:243], a[116:119], 0
    ds_read_b128 a[136:139], v194 offset:4672
    v_mfma_f32_16x16x32_bf16 v[148:151], a[60:63], a[96:99], v[148:151]
    ds_read_b128 a[140:143], v194 offset:4736
    v_mfma_f32_16x16x32_bf16 v[148:151], a[64:67], a[100:103], v[148:151]
    v_mfma_f32_16x16x32_bf16 v[148:151], a[68:71], a[104:107], v[148:151]
    s_waitcnt lgkmcnt(4)
    v_mfma_f32_16x16x32_bf16 v[56:59], a[242:245], a[132:135], 0
    ds_read_b128 a[200:203], v202 offset:34176
    v_mfma_f32_16x16x32_bf16 v[56:59], a[0:3], a[120:123], v[56:59]
    ds_read_b128 a[208:211], v193 offset:9280
    s_waitcnt lgkmcnt(5)
    v_mfma_f32_16x16x32_bf16 v[56:59], a[4:7], a[124:127], v[56:59]
    ds_read_b128 a[212:215], v193 offset:9344
    s_waitcnt lgkmcnt(5)
    v_mfma_f32_16x16x32_bf16 v[56:59], a[8:11], a[128:131], v[56:59]
    ds_read_b128 a[248:251], v197
    v_mfma_f32_16x16x32_bf16 v[60:63], a[240:243], a[132:135], 0
    v_mfma_f32_16x16x32_bf16 v[60:63], a[12:15], a[120:123], v[60:63]
    ds_read_b128 a[72:75], v195 offset:0
    v_mfma_f32_16x16x32_bf16 v[60:63], a[16:19], a[124:127], v[60:63]
    v_mfma_f32_16x16x32_bf16 v[60:63], a[20:23], a[128:131], v[60:63]
    ds_read_b128 a[76:79], v195 offset:64
    s_waitcnt lgkmcnt(6)
    v_mfma_f32_16x16x32_bf16 v[104:107], a[242:245], a[136:139], 0
    v_mfma_f32_16x16x32_bf16 v[104:107], a[24:27], a[120:123], v[104:107]
    ds_read_b128 a[80:83], v195 offset:128
    v_mfma_f32_16x16x32_bf16 v[104:107], a[28:31], a[124:127], v[104:107]
    v_mfma_f32_16x16x32_bf16 v[104:107], a[32:35], a[128:131], v[104:107]
    ds_read_b128 a[252:255], v198
    v_mfma_f32_16x16x32_bf16 v[108:111], a[240:243], a[136:139], 0
    v_mfma_f32_16x16x32_bf16 v[108:111], a[36:39], a[120:123], v[108:111]
    ds_read_b128 a[84:87], v196 offset:0
    v_mfma_f32_16x16x32_bf16 v[108:111], a[40:43], a[124:127], v[108:111]
    v_mfma_f32_16x16x32_bf16 v[108:111], a[44:47], a[128:131], v[108:111]
    ds_read_b128 a[88:91], v196 offset:64
    v_fma_f32 v240, v32, -s58, v48
    v_mfma_f32_16x16x32_bf16 v[152:155], a[242:245], a[140:143], 0
    v_fma_f32 v241, v33, -s58, v49
    v_fma_f32 v242, v24, -s58, v40
    v_mfma_f32_16x16x32_bf16 v[152:155], a[48:51], a[120:123], v[152:155]
    ds_read_b128 a[92:95], v196 offset:128
    v_fma_f32 v243, v25, -s58, v41
    v_mfma_f32_16x16x32_bf16 v[152:155], a[52:55], a[124:127], v[152:155]
    v_fma_f32 v244, v32, -s62, v48
    v_fma_f32 v245, v33, -s62, v49
    v_mfma_f32_16x16x32_bf16 v[152:155], a[56:59], a[128:131], v[152:155]
    v_fma_f32 v246, v24, -s62, v40
    v_fma_f32 v247, v25, -s62, v41
    v_mfma_f32_16x16x32_bf16 v[156:159], a[240:243], a[140:143], 0
    v_add_f32 v248, v16, v48
    v_add_f32 v249, v17, v49
    v_mfma_f32_16x16x32_bf16 v[156:159], a[60:63], a[120:123], v[156:159]
    v_add_f32 v250, v24, v56
    v_add_f32 v251, v25, v57
    v_mfma_f32_16x16x32_bf16 v[156:159], a[64:67], a[124:127], v[156:159]
    v_fma_f32 v252, v242, s60, v240
    v_fma_f32 v253, v243, s60, v241
    v_mfma_f32_16x16x32_bf16 v[156:159], a[68:71], a[128:131], v[156:159]
    v_fma_f32 v240, v242, -s60, v240
    v_fma_f32 v241, v243, -s60, v241
    s_waitcnt lgkmcnt(0)
    s_barrier
    v_mfma_f32_16x16x32_bf16 v[160:163], a[242:245], a[248:251], 0
    v_fma_f32 v248, v32, -s66, v248
    v_fma_f32 v249, v33, -s66, v249
    v_mfma_f32_16x16x32_bf16 v[160:163], a[216:219], a[72:75], v[160:163]
    v_fma_f32 v242, v246, s64, v244
    v_fma_f32 v243, v247, s64, v245
    v_mfma_f32_16x16x32_bf16 v[160:163], a[220:223], a[76:79], v[160:163]
    v_fma_f32 v244, v246, -s64, v244
    v_fma_f32 v245, v247, -s64, v245
    v_mfma_f32_16x16x32_bf16 v[160:163], a[224:227], a[80:83], v[160:163]
    v_fma_f32 v250, v40, -s66, v250
    v_fma_f32 v251, v41, -s66, v251
    v_mfma_f32_16x16x32_bf16 v[164:167], a[240:243], a[248:251], 0
    v_cvt_pk_bf16_f32 v192, v252, v253
    v_cvt_pk_bf16_f32 v196, v240, v241
    v_mfma_f32_16x16x32_bf16 v[164:167], a[228:231], a[72:75], v[164:167]
    v_cvt_pk_bf16_f32 v200, v248, v249
    v_cvt_pk_bf16_f32 v204, v242, v243
    v_mfma_f32_16x16x32_bf16 v[164:167], a[232:235], a[76:79], v[164:167]
    v_cvt_pk_bf16_f32 v208, v244, v245
    v_cvt_pk_bf16_f32 v212, v250, v251
    v_mfma_f32_16x16x32_bf16 v[164:167], a[236:239], a[80:83], v[164:167]
    v_fma_f32 v240, v34, -s58, v50
    v_fma_f32 v241, v35, -s58, v51
    v_mfma_f32_16x16x32_bf16 v[168:171], a[242:245], a[252:255], 0
    v_fma_f32 v242, v26, -s58, v42
    v_fma_f32 v243, v27, -s58, v43
    v_mfma_f32_16x16x32_bf16 v[168:171], a[216:219], a[84:87], v[168:171]
    v_fma_f32 v244, v34, -s62, v50
    v_fma_f32 v245, v35, -s62, v51
    v_mfma_f32_16x16x32_bf16 v[168:171], a[220:223], a[88:91], v[168:171]
    v_fma_f32 v246, v26, -s62, v42
    v_fma_f32 v247, v27, -s62, v43
L_pg1:
    s_cbranch_execz L_pg5
    v_mfma_f32_16x16x32_bf16 v[168:171], a[224:227], a[92:95], v[168:171]
    v_add_f32 v248, v18, v50
    v_add_f32 v249, v19, v51
    v_mfma_f32_16x16x32_bf16 v[172:175], a[240:243], a[252:255], 0
    v_add_f32 v250, v26, v58
    v_add_f32 v251, v27, v59
    v_mfma_f32_16x16x32_bf16 v[172:175], a[228:231], a[84:87], v[172:175]
    s_cmp_eq_u32 s3, 3
    s_cbranch_scc0 L_ow10
    buffer_load_dword v6, v7, s[28:31], 0 offen offset:16 sc1
L_ow10:
    v_fma_f32 v252, v242, s60, v240
    v_mfma_f32_16x16x32_bf16 v[172:175], a[232:235], a[88:91], v[172:175]
    v_fma_f32 v253, v243, s60, v241
    v_fma_f32 v240, v242, -s60, v240
    v_mfma_f32_16x16x32_bf16 v[172:175], a[236:239], a[92:95], v[172:175]
    v_fma_f32 v241, v243, -s60, v241
    v_fma_f32 v248, v34, -s66, v248
    v_fma_f32 v249, v35, -s66, v249
    v_fma_f32 v242, v246, s64, v244
    v_fma_f32 v243, v247, s64, v245
    v_fma_f32 v244, v246, -s64, v244
    v_fma_f32 v245, v247, -s64, v245
    v_fma_f32 v250, v42, -s66, v250
    v_fma_f32 v251, v43, -s66, v251
    v_cvt_pk_bf16_f32 v193, v252, v253
    v_cvt_pk_bf16_f32 v197, v240, v241
    v_cvt_pk_bf16_f32 v201, v248, v249
    v_cvt_pk_bf16_f32 v205, v242, v243
    v_cvt_pk_bf16_f32 v209, v244, v245
    v_cvt_pk_bf16_f32 v213, v250, v251
    v_pk_fma_f32 v[240:241], v[36:37], s[58:59], v[52:53] neg_lo:[0,1,0] neg_hi:[0,1,0]
    v_pk_fma_f32 v[242:243], v[28:29], s[58:59], v[44:45] neg_lo:[0,1,0] neg_hi:[0,1,0]
    v_pk_fma_f32 v[244:245], v[36:37], s[62:63], v[52:53] neg_lo:[0,1,0] neg_hi:[0,1,0]
    v_pk_fma_f32 v[246:247], v[28:29], s[62:63], v[44:45] neg_lo:[0,1,0] neg_hi:[0,1,0]
    v_pk_add_f32 v[248:249], v[20:21], v[52:53]
    v_pk_add_f32 v[250:251], v[28:29], v[60:61]
    v_pk_fma_f32 v[252:253], v[242:243], s[60:61], v[240:241]
    v_pk_fma_f32 v[240:241], v[242:243], s[60:61], v[240:241] neg_lo:[0,1,0] neg_hi:[0,1,0]
    v_pk_fma_f32 v[248:249], v[36:37], s[66:67], v[248:249] neg_lo:[0,1,0] neg_hi:[0,1,0]
    v_pk_fma_f32 v[242:243], v[246:247], s[64:65], v[244:245]
    v_pk_fma_f32 v[244:245], v[246:247], s[64:65], v[244:245] neg_lo:[0,1,0] neg_hi:[0,1,0]
    v_pk_fma_f32 v[250:251], v[44:45], s[66:67], v[250:251] neg_lo:[0,1,0] neg_hi:[0,1,0]
    v_cvt_pk_bf16_f32 v194, v252, v253
    v_cvt_pk_bf16_f32 v198, v240, v241
    v_cvt_pk_bf16_f32 v202, v248, v249
    v_cvt_pk_bf16_f32 v206, v242, v243
    v_cvt_pk_bf16_f32 v210, v244, v245
    v_cvt_pk_bf16_f32 v214, v250, v251
    v_pk_fma_f32 v[240:241], v[38:39], s[58:59], v[54:55] neg_lo:[0,1,0] neg_hi:[0,1,0]
    v_pk_fma_f32 v[242:243], v[30:31], s[58:59], v[46:47] neg_lo:[0,1,0] neg_hi:[0,1,0]
    v_pk_fma_f32 v[244:245], v[38:39], s[62:63], v[54:55] neg_lo:[0,1,0] neg_hi:[0,1,0]
    v_pk_fma_f32 v[246:247], v[30:31], s[62:63], v[46:47] neg_lo:[0,1,0] neg_hi:[0,1,0]
    v_pk_add_f32 v[248:249], v[22:23], v[54:55]
    v_pk_add_f32 v[250:251], v[30:31], v[62:63]
    v_pk_fma_f32 v[252:253], v[242:243], s[60:61], v[240:241]
    v_pk_fma_f32 v[240:241], v[242:243], s[60:61], v[240:241] neg_lo:[0,1,0] neg_hi:[0,1,0]
    v_pk_fma_f32 v[248:249], v[38:39], s[66:67], v[248:249] neg_lo:[0,1,0] neg_hi:[0,1,0]
    v_pk_fma_f32 v[242:243], v[246:247], s[64:65], v[244:245]
    v_pk_fma_f32 v[244:245], v[246:247], s[64:65], v[244:245] neg_lo:[0,1,0] neg_hi:[0,1,0]
    v_pk_fma_f32 v[250:251], v[46:47], s[66:67], v[250:251] neg_lo:[0,1,0] neg_hi:[0,1,0]
    v_cvt_pk_bf16_f32 v195, v252, v253
    v_cvt_pk_bf16_f32 v199, v240, v241
    v_cvt_pk_bf16_f32 v203, v248, v249
    v_cvt_pk_bf16_f32 v207, v242, v243
    v_cvt_pk_bf16_f32 v211, v244, v245
    v_cvt_pk_bf16_f32 v215, v250, v251
    s_mov_b32 s68, 0
    s_cmp_eq_u32 s3, 3
    s_cbranch_scc0 L_ready
    s_mov_b32 s69, 0
L_poll:
    s_waitcnt vmcnt(0)
    v_cmp_ne_u32 vcc, 0, v6
    s_add_u32 s69, s69, 1
    s_mov_b32 s68, 0
    s_cmp_eq_u64 vcc, -1
    s_cbranch_scc1 L_ready
    s_sleep 2
    buffer_load_dword v6, v7, s[28:31], 0 offen offset:16 sc1
    s_cmp_lt_u32 s69, 65536
    s_cbranch_scc1 L_poll
L_ready:
    s_barrier
    v_mfma_f32_16x16x32_bf16 v[16:19], a[242:245], a[156:159], 0
    v_mfma_f32_16x16x32_bf16 v[16:19], a[0:3], a[144:147], v[16:19]
    ds_write_b128 v2, v[192:195] offset:0
    v_mfma_f32_16x16x32_bf16 v[16:19], a[4:7], a[148:151], v[16:19]
    v_mfma_f32_16x16x32_bf16 v[16:19], a[8:11], a[152:155], v[16:19]
    buffer_load_dwordx4 a[72:75], v1, s[20:23], s68 offen offset:0 sc1
    v_mfma_f32_16x16x32_bf16 v[20:23], a[240:243], a[156:159], 0
    v_mfma_f32_16x16x32_bf16 v[20:23], a[12:15], a[144:147], v[20:23]
    ds_write_b128 v2, v[196:199] offset:6336
    v_mfma_f32_16x16x32_bf16 v[20:23], a[16:19], a[148:151], v[20:23]
    v_mfma_f32_16x16x32_bf16 v[20:23], a[20:23], a[152:155], v[20:23]
    buffer_load_dwordx4 a[76:79], v1, s[20:23], s68 offen offset:1024 sc1
    v_mfma_f32_16x16x32_bf16 v[24:27], a[242:245], a[180:183], 0
    v_mfma_f32_16x16x32_bf16 v[24:27], a[0:3], a[168:171], v[24:27]
    ds_write_b128 v2, v[200:203] offset:12672
    v_mfma_f32_16x16x32_bf16 v[24:27], a[4:7], a[172:175], v[24:27]
    v_mfma_f32_16x16x32_bf16 v[24:27], a[8:11], a[176:179], v[24:27]
    buffer_load_dwordx4 a[80:83], v1, s[20:23], s68 offen offset:2048 sc1
    v_mfma_f32_16x16x32_bf16 v[28:31], a[240:243], a[180:183], 0
    v_mfma_f32_16x16x32_bf16 v[28:31], a[12:15], a[168:171], v[28:31]
    ds_write_b128 v3, v[204:207] offset:352
    v_mfma_f32_16x16x32_bf16 v[28:31], a[16:19], a[172:175], v[28:31]
    v_mfma_f32_16x16x32_bf16 v[28:31], a[20:23], a[176:179], v[28:31]
    buffer_load_dwordx4 a[84:87], v1, s[20:23], s68 offen offset:3072 sc1
    s_add_u32 s68, s68, 4096
    v_mfma_f32_16x16x32_bf16 v[32:35], a[242:245], a[204:207], 0
    v_mfma_f32_16x16x32_bf16 v[32:35], a[0:3], a[192:195], v[32:35]
    ds_write_b128 v3, v[208:211] offset:6688
    v_mfma_f32_16x16x32_bf16 v[32:35], a[4:7], a[196:199], v[32:35]
    v_mfma_f32_16x16x32_bf16 v[32:35], a[8:11], a[200:203], v[32:35]
    buffer_load_dwordx4 a[88:91], v1, s[20:23], s68 offen offset:0 sc1
    v_mfma_f32_16x16x32_bf16 v[36:39], a[240:243], a[204:207], 0
    v_mfma_f32_16x16x32_bf16 v[36:39], a[12:15], a[192:195], v[36:39]
    ds_write_b128 v3, v[212:215] offset:13024
    v_mfma_f32_16x16x32_bf16 v[36:39], a[16:19], a[196:199], v[36:39]
    v_mfma_f32_16x16x32_bf16 v[36:39], a[20:23], a[200:203], v[36:39]
    buffer_load_dwordx4 a[92:95], v1, s[20:23], s68 offen offset:1024 sc1
    s_mov_b32 s96, 0x000f000f
    s_mov_b32 s97, 0x000f000f
    v_pk_fma_f32 v[240:241], v[56:57], s[58:59], v[24:25] neg_lo:[0,1,0] neg_hi:[0,1,0]
    buffer_load_dwordx4 a[96:99], v1, s[20:23], s68 offen offset:2048 sc1
    v_pk_fma_f32 v[242:243], v[48:49], s[58:59], v[16:17] neg_lo:[0,1,0] neg_hi:[0,1,0]
    v_pk_fma_f32 v[244:245], v[56:57], s[62:63], v[24:25] neg_lo:[0,1,0] neg_hi:[0,1,0]
    v_pk_fma_f32 v[246:247], v[48:49], s[62:63], v[16:17] neg_lo:[0,1,0] neg_hi:[0,1,0]
    v_pk_add_f32 v[248:249], v[40:41], v[24:25]
    v_pk_add_f32 v[250:251], v[48:49], v[32:33]
    v_pk_fma_f32 v[252:253], v[242:243], s[60:61], v[240:241]
    buffer_load_dwordx4 a[100:103], v1, s[20:23], s68 offen offset:3072 sc1
    v_pk_fma_f32 v[240:241], v[242:243], s[60:61], v[240:241] neg_lo:[0,1,0] neg_hi:[0,1,0]
    v_pk_fma_f32 v[248:249], v[56:57], s[66:67], v[248:249] neg_lo:[0,1,0] neg_hi:[0,1,0]
    v_pk_fma_f32 v[242:243], v[246:247], s[64:65], v[244:245]
    v_pk_fma_f32 v[244:245], v[246:247], s[64:65], v[244:245] neg_lo:[0,1,0] neg_hi:[0,1,0]
    v_pk_fma_f32 v[250:251], v[16:17], s[66:67], v[250:251] neg_lo:[0,1,0] neg_hi:[0,1,0]
    s_add_u32 s68, s68, 4096
    v_cvt_pk_bf16_f32 v192, v252, v253
    v_cvt_pk_bf16_f32 v196, v240, v241
    v_cvt_pk_bf16_f32 v200, v248, v249
    v_cvt_pk_bf16_f32 v204, v242, v243
    v_cvt_pk_bf16_f32 v208, v244, v245
    v_cvt_pk_bf16_f32 v212, v250, v251
    buffer_load_dwordx4 a[104:107], v1, s[20:23], s68 offen offset:0 sc1
    v_pk_fma_f32 v[240:241], v[58:59], s[58:59], v[26:27] neg_lo:[0,1,0] neg_hi:[0,1,0]
    v_pk_fma_f32 v[242:243], v[50:51], s[58:59], v[18:19] neg_lo:[0,1,0] neg_hi:[0,1,0]
    v_pk_fma_f32 v[244:245], v[58:59], s[62:63], v[26:27] neg_lo:[0,1,0] neg_hi:[0,1,0]
    v_pk_fma_f32 v[246:247], v[50:51], s[62:63], v[18:19] neg_lo:[0,1,0] neg_hi:[0,1,0]
    v_pk_add_f32 v[248:249], v[42:43], v[26:27]
    buffer_load_dwordx4 a[108:111], v1, s[20:23], s68 offen offset:1024 sc1
    v_pk_add_f32 v[250:251], v[50:51], v[34:35]
    v_pk_fma_f32 v[252:253], v[242:243], s[60:61], v[240:241]
    v_pk_fma_f32 v[240:241], v[242:243], s[60:61], v[240:241] neg_lo:[0,1,0] neg_hi:[0,1,0]
    v_pk_fma_f32 v[248:249], v[58:59], s[66:67], v[248:249] neg_lo:[0,1,0] neg_hi:[0,1,0]
    v_pk_fma_f32 v[242:243], v[246:247], s[64:65], v[244:245]
    v_pk_fma_f32 v[244:245], v[246:247], s[64:65], v[244:245] neg_lo:[0,1,0] neg_hi:[0,1,0]
    buffer_load_dwordx4 a[112:115], v1, s[20:23], s68 offen offset:2048 sc1
    v_pk_fma_f32 v[250:251], v[18:19], s[66:67], v[250:251] neg_lo:[0,1,0] neg_hi:[0,1,0]
    v_cvt_pk_bf16_f32 v193, v252, v253
    v_cvt_pk_bf16_f32 v197, v240, v241
    v_cvt_pk_bf16_f32 v201, v248, v249
    v_cvt_pk_bf16_f32 v205, v242, v243
    buffer_load_dwordx4 a[116:119], v1, s[20:23], s68 offen offset:3072 sc1
    v_cvt_pk_bf16_f32 v209, v244, v245
    v_cvt_pk_bf16_f32 v213, v250, v251
    v_pk_fma_f32 v[240:241], v[60:61], s[58:59], v[28:29] neg_lo:[0,1,0] neg_hi:[0,1,0]
    v_pk_fma_f32 v[242:243], v[52:53], s[58:59], v[20:21] neg_lo:[0,1,0] neg_hi:[0,1,0]
    v_pk_fma_f32 v[244:245], v[60:61], s[62:63], v[28:29] neg_lo:[0,1,0] neg_hi:[0,1,0]
    v_pk_fma_f32 v[246:247], v[52:53], s[62:63], v[20:21] neg_lo:[0,1,0] neg_hi:[0,1,0]
    s_add_u32 s68, s68, 4096
    v_pk_add_f32 v[248:249], v[44:45], v[28:29]
    v_pk_add_f32 v[250:251], v[52:53], v[36:37]
    v_pk_fma_f32 v[252:253], v[242:243], s[60:61], v[240:241]
    v_pk_fma_f32 v[240:241], v[242:243], s[60:61], v[240:241] neg_lo:[0,1,0] neg_hi:[0,1,0]
    v_pk_fma_f32 v[248:249], v[60:61], s[66:67], v[248:249] neg_lo:[0,1,0] neg_hi:[0,1,0]
    buffer_load_dwordx4 a[120:123], v1, s[20:23], s68 offen offset:0 sc1
    v_pk_fma_f32 v[242:243], v[246:247], s[64:65], v[244:245]
    v_pk_fma_f32 v[244:245], v[246:247], s[64:65], v[244:245] neg_lo:[0,1,0] neg_hi:[0,1,0]
    v_pk_fma_f32 v[250:251], v[20:21], s[66:67], v[250:251] neg_lo:[0,1,0] neg_hi:[0,1,0]
    v_cvt_pk_bf16_f32 v194, v252, v253
    v_cvt_pk_bf16_f32 v198, v240, v241
    v_cvt_pk_bf16_f32 v202, v248, v249
    buffer_load_dwordx4 a[124:127], v1, s[20:23], s68 offen offset:1024 sc1
    v_cvt_pk_bf16_f32 v206, v242, v243
    v_cvt_pk_bf16_f32 v210, v244, v245
    v_cvt_pk_bf16_f32 v214, v250, v251
    v_pk_fma_f32 v[240:241], v[62:63], s[58:59], v[30:31] neg_lo:[0,1,0] neg_hi:[0,1,0]
    v_pk_fma_f32 v[242:243], v[54:55], s[58:59], v[22:23] neg_lo:[0,1,0] neg_hi:[0,1,0]
    buffer_load_dwordx4 a[128:131], v1, s[20:23], s68 offen offset:2048 sc1
    v_pk_fma_f32 v[244:245], v[62:63], s[62:63], v[30:31] neg_lo:[0,1,0] neg_hi:[0,1,0]
    v_pk_fma_f32 v[246:247], v[54:55], s[62:63], v[22:23] neg_lo:[0,1,0] neg_hi:[0,1,0]
    v_pk_add_f32 v[248:249], v[46:47], v[30:31]
    v_pk_add_f32 v[250:251], v[54:55], v[38:39]
    v_pk_fma_f32 v[252:253], v[242:243], s[60:61], v[240:241]
    v_pk_fma_f32 v[240:241], v[242:243], s[60:61], v[240:241] neg_lo:[0,1,0] neg_hi:[0,1,0]
    buffer_load_dwordx4 a[132:135], v1, s[20:23], s68 offen offset:3072 sc1
    v_pk_fma_f32 v[248:249], v[62:63], s[66:67], v[248:249] neg_lo:[0,1,0] neg_hi:[0,1,0]
    v_pk_fma_f32 v[242:243], v[246:247], s[64:65], v[244:245]
    v_pk_fma_f32 v[244:245], v[246:247], s[64:65], v[244:245] neg_lo:[0,1,0] neg_hi:[0,1,0]
    v_pk_fma_f32 v[250:251], v[22:23], s[66:67], v[250:251] neg_lo:[0,1,0] neg_hi:[0,1,0]
    v_cvt_pk_bf16_f32 v195, v252, v253
    s_add_u32 s68, s68, 4096
    v_cvt_pk_bf16_f32 v199, v240, v241
    v_cvt_pk_bf16_f32 v203, v248, v249
    v_cvt_pk_bf16_f32 v207, v242, v243
    v_cvt_pk_bf16_f32 v211, v244, v245
    v_cvt_pk_bf16_f32 v215, v250, v251
    ds_write_b128 v2, v[192:195] offset:352
    ds_write_b128 v3, v[204:207] offset:0
    ds_write_b128 v2, v[196:199] offset:6688
    ds_write_b128 v3, v[208:211] offset:6336
    s_waitcnt lgkmcnt(0)
    s_barrier
    ds_read_b128 a[0:3], v254 offset:0
    ds_read_b128 a[4:7], v254 offset:352
    ds_read_b128 a[8:11], v254 offset:704
    ds_read_b128 a[12:15], v254 offset:1056
    ds_read_b128 a[16:19], v254 offset:1408
    ds_read_b128 a[20:23], v254 offset:1760
    s_mul_i32 s50, s32, 96
    s_add_u32 s50, s50, 12672
    s_mul_i32 s51, s32, 4224
    s_sub_u32 s52, 4224, s51
    s_waitcnt vmcnt(14)
    s_waitcnt lgkmcnt(0)
    v_mfma_f32_16x16x32_bf16 v[52:55], a[72:75], a[0:3], 0
    buffer_load_dwordx4 a[136:139], v1, s[20:23], s68 offen offset:0 sc1
    v_mfma_f32_16x16x32_bf16 v[52:55], a[76:79], a[4:7], v[52:55]
    v_mov_b32_dpp v16, v160 row_shl:4 row_mask:0xf bank_mask:0xf bound_ctrl:0
    v_mov_b32_dpp v17, v161 row_shl:4 row_mask:0xf bank_mask:0xf bound_ctrl:0
    v_mfma_f32_16x16x32_bf16 v[56:59], a[72:75], a[4:7], 0
    ds_read_b128 a[216:219], v254 offset:16
    v_mov_b32_dpp v18, v162 row_shl:4 row_mask:0xf bank_mask:0xf bound_ctrl:0
    v_mfma_f32_16x16x32_bf16 v[56:59], a[76:79], a[8:11], v[56:59]
    ds_read_b128 a[220:223], v254 offset:368
    v_mov_b32_dpp v19, v163 row_shl:4 row_mask:0xf bank_mask:0xf bound_ctrl:0
    v_mfma_f32_16x16x32_bf16 v[60:63], a[72:75], a[8:11], 0
    ds_write_b128 v2, v[200:203] offset:13024
    v_mfma_f32_16x16x32_bf16 v[60:63], a[76:79], a[12:15], v[60:63]
    buffer_load_dwordx4 a[140:143], v1, s[20:23], s68 offen offset:1024 sc1
    v_mfma_f32_16x16x32_bf16 v[176:179], a[72:75], a[12:15], 0
    v_mov_b32_dpp v20, v168 row_shl:4 row_mask:0xf bank_mask:0xf bound_ctrl:0
    v_mov_b32_dpp v21, v169 row_shl:4 row_mask:0xf bank_mask:0xf bound_ctrl:0
    v_mfma_f32_16x16x32_bf16 v[176:179], a[76:79], a[16:19], v[176:179]
    ds_read_b128 a[224:227], v254 offset:720
    v_mov_b32_dpp v22, v170 row_shl:4 row_mask:0xf bank_mask:0xf bound_ctrl:0
    v_mfma_f32_16x16x32_bf16 v[180:183], a[72:75], a[16:19], 0
    s_waitcnt vmcnt(14)
    ds_read_b128 a[228:231], v254 offset:1072
    v_mfma_f32_16x16x32_bf16 v[180:183], a[76:79], a[20:23], v[180:183]
    v_mov_b32_dpp v23, v171 row_shl:4 row_mask:0xf bank_mask:0xf bound_ctrl:0
    v_mov_b32_dpp v24, v160 row_shl:8 row_mask:0xf bank_mask:0xf bound_ctrl:0
    v_mfma_f32_16x16x32_bf16 v[200:203], a[84:87], a[20:23], 0
    buffer_load_dwordx4 a[72:75], v1, s[20:23], s68 offen offset:2048 sc1
    v_mfma_f32_16x16x32_bf16 v[200:203], a[80:83], a[16:19], v[200:203]
    v_mov_b32_dpp v25, v161 row_shl:8 row_mask:0xf bank_mask:0xf bound_ctrl:0
    v_mov_b32_dpp v26, v162 row_shl:8 row_mask:0xf bank_mask:0xf bound_ctrl:0
    v_mfma_f32_16x16x32_bf16 v[196:199], a[84:87], a[16:19], 0
    ds_read_b128 a[232:235], v254 offset:1424
    v_mov_b32_dpp v27, v163 row_shl:8 row_mask:0xf bank_mask:0xf bound_ctrl:0
    v_mfma_f32_16x16x32_bf16 v[196:199], a[80:83], a[12:15], v[196:199]
    ds_read_b128 a[236:239], v254 offset:1776
    v_mov_b32_dpp v28, v168 row_shl:8 row_mask:0xf bank_mask:0xf bound_ctrl:0
    v_mfma_f32_16x16x32_bf16 v[192:195], a[84:87], a[12:15], 0
    ds_write_b128 v3, v[212:215] offset:12672
    v_mfma_f32_16x16x32_bf16 v[192:195], a[80:83], a[8:11], v[192:195]
    buffer_load_dwordx4 a[76:79], v1, s[20:23], s68 offen offset:3072 sc1
    v_mfma_f32_16x16x32_bf16 v[188:191], a[84:87], a[8:11], 0
    s_add_u32 s68, s68, 4096
    v_mov_b32_dpp v29, v169 row_shl:8 row_mask:0xf bank_mask:0xf bound_ctrl:0
    v_mfma_f32_16x16x32_bf16 v[188:191], a[80:83], a[4:7], v[188:191]
    v_mov_b32_dpp v30, v170 row_shl:8 row_mask:0xf bank_mask:0xf bound_ctrl:0
    v_mov_b32_dpp v31, v171 row_shl:8 row_mask:0xf bank_mask:0xf bound_ctrl:0
    v_mfma_f32_16x16x32_bf16 v[184:187], a[84:87], a[4:7], 0
    s_waitcnt vmcnt(14)
    v_fma_f32 v240, v16, -s58, v24
    v_mfma_f32_16x16x32_bf16 v[184:187], a[80:83], a[0:3], v[184:187]
    v_fma_f32 v241, v17, -s58, v25
    v_fma_f32 v242, v168, -s58, v20
    v_mfma_f32_16x16x32_bf16 v[204:207], a[88:91], a[0:3], 0
    buffer_load_dwordx4 a[80:83], v1, s[20:23], s68 offen offset:0 sc1
    v_mfma_f32_16x16x32_bf16 v[204:207], a[92:95], a[4:7], v[204:207]
    v_fma_f32 v243, v169, -s58, v21
    v_fma_f32 v244, v16, -s62, v24
    v_mfma_f32_16x16x32_bf16 v[208:211], a[88:91], a[4:7], 0
    v_fma_f32 v245, v17, -s62, v25
    v_fma_f32 v246, v168, -s62, v20
    v_mfma_f32_16x16x32_bf16 v[208:211], a[92:95], a[8:11], v[208:211]
    v_fma_f32 v247, v169, -s62, v21
    v_add_f32 v248, v160, v24
    v_mfma_f32_16x16x32_bf16 v[212:215], a[88:91], a[8:11], 0
    v_add_f32 v249, v161, v25
    v_add_f32 v250, v168, v28
    v_mfma_f32_16x16x32_bf16 v[212:215], a[92:95], a[12:15], v[212:215]
    buffer_load_dwordx4 a[84:87], v1, s[20:23], s68 offen offset:1024 sc1
    v_mfma_f32_16x16x32_bf16 a[248:251], a[88:91], a[12:15], 0
    v_add_f32 v251, v169, v29
    v_fma_f32 v252, v242, s60, v240
    v_mfma_f32_16x16x32_bf16 a[248:251], a[92:95], a[16:19], a[248:251]
    s_waitcnt lgkmcnt(1)
    v_fma_f32 v253, v243, s60, v241
    v_mfma_f32_16x16x32_bf16 a[252:255], a[88:91], a[16:19], 0
    s_waitcnt vmcnt(14)
    v_fma_f32 v240, v242, -s60, v240
    v_mfma_f32_16x16x32_bf16 a[252:255], a[92:95], a[20:23], a[252:255]
    v_fma_f32 v241, v243, -s60, v241
    v_fma_f32 v248, v16, -s66, v248
    v_mfma_f32_16x16x32_bf16 v[52:55], a[96:99], a[216:219], v[52:55]
    buffer_load_dwordx4 a[88:91], v1, s[20:23], s68 offen offset:2048 sc1
    v_mfma_f32_16x16x32_bf16 v[52:55], a[100:103], a[220:223], v[52:55]
    v_fma_f32 v249, v17, -s66, v249
    v_fma_f32 v242, v246, s64, v244
    v_mfma_f32_16x16x32_bf16 v[56:59], a[96:99], a[220:223], v[56:59]
    ds_read_b128 a[0:3], v254 offset:32
    v_fma_f32 v243, v247, s64, v245
    v_mfma_f32_16x16x32_bf16 v[56:59], a[100:103], a[224:227], v[56:59]
    ds_read_b128 a[4:7], v254 offset:384
    v_fma_f32 v244, v246, -s64, v244
    v_mfma_f32_16x16x32_bf16 v[60:63], a[96:99], a[224:227], v[60:63]
    v_fma_f32 v245, v247, -s64, v245
    v_fma_f32 v250, v20, -s66, v250
    v_mfma_f32_16x16x32_bf16 v[60:63], a[100:103], a[228:231], v[60:63]
    buffer_load_dwordx4 a[92:95], v1, s[20:23], s68 offen offset:3072 sc1
    v_mfma_f32_16x16x32_bf16 v[176:179], a[96:99], a[228:231], v[176:179]
    s_add_u32 s68, s68, 4096
    v_fma_f32 v251, v21, -s66, v251
    v_mfma_f32_16x16x32_bf16 v[176:179], a[100:103], a[232:235], v[176:179]
    ds_read_b128 a[8:11], v254 offset:736
    v_cvt_pk_bf16_f32 v216, v252, v253
    v_mfma_f32_16x16x32_bf16 v[180:183], a[96:99], a[232:235], v[180:183]
    s_waitcnt vmcnt(14)
    ds_read_b128 a[12:15], v254 offset:1088
    v_mfma_f32_16x16x32_bf16 v[180:183], a[100:103], a[236:239], v[180:183]
    v_cvt_pk_bf16_f32 v220, v240, v241
    v_cvt_pk_bf16_f32 v224, v248, v249
    v_mfma_f32_16x16x32_bf16 v[200:203], a[108:111], a[236:239], v[200:203]
    buffer_load_dwordx4 a[96:99], v1, s[20:23], s68 offen offset:0 sc1
    v_mfma_f32_16x16x32_bf16 v[200:203], a[104:107], a[232:235], v[200:203]
    v_cvt_pk_bf16_f32 v228, v242, v243
    v_cvt_pk_bf16_f32 v232, v244, v245
    v_mfma_f32_16x16x32_bf16 v[196:199], a[108:111], a[232:235], v[196:199]
    ds_read_b128 a[16:19], v254 offset:1440
    v_cvt_pk_bf16_f32 v236, v250, v251
    v_mfma_f32_16x16x32_bf16 v[196:199], a[104:107], a[228:231], v[196:199]
    ds_read_b128 a[20:23], v254 offset:1792
    v_fma_f32 v240, v18, -s58, v26
    v_mfma_f32_16x16x32_bf16 v[192:195], a[108:111], a[228:231], v[192:195]
    v_fma_f32 v241, v19, -s58, v27
    v_fma_f32 v242, v170, -s58, v22
    v_mfma_f32_16x16x32_bf16 v[192:195], a[104:107], a[224:227], v[192:195]
    buffer_load_dwordx4 a[100:103], v1, s[20:23], s68 offen offset:1024 sc1
    v_mfma_f32_16x16x32_bf16 v[188:191], a[108:111], a[224:227], v[188:191]
    v_fma_f32 v243, v171, -s58, v23
    v_fma_f32 v244, v18, -s62, v26
    v_mfma_f32_16x16x32_bf16 v[188:191], a[104:107], a[220:223], v[188:191]
    v_fma_f32 v245, v19, -s62, v27
    v_fma_f32 v246, v170, -s62, v22
    v_mfma_f32_16x16x32_bf16 v[184:187], a[108:111], a[220:223], v[184:187]
    s_waitcnt vmcnt(14)
    v_fma_f32 v247, v171, -s62, v23
    v_mfma_f32_16x16x32_bf16 v[184:187], a[104:107], a[216:219], v[184:187]
    v_add_f32 v248, v162, v26
    v_add_f32 v249, v163, v27
    v_mfma_f32_16x16x32_bf16 v[204:207], a[112:115], a[216:219], v[204:207]
    buffer_load_dwordx4 a[104:107], v1, s[20:23], s68 offen offset:2048 sc1
    v_mfma_f32_16x16x32_bf16 v[204:207], a[116:119], a[220:223], v[204:207]
    v_add_f32 v250, v170, v30
    v_add_f32 v251, v171, v31
    v_mfma_f32_16x16x32_bf16 v[208:211], a[112:115], a[220:223], v[208:211]
    v_fma_f32 v252, v242, s60, v240
    v_fma_f32 v253, v243, s60, v241
    v_mfma_f32_16x16x32_bf16 v[208:211], a[116:119], a[224:227], v[208:211]
    v_fma_f32 v240, v242, -s60, v240
    v_fma_f32 v241, v243, -s60, v241
    v_mfma_f32_16x16x32_bf16 v[212:215], a[112:115], a[224:227], v[212:215]
    v_fma_f32 v248, v18, -s66, v248
    v_fma_f32 v249, v19, -s66, v249
    v_mfma_f32_16x16x32_bf16 v[212:215], a[116:119], a[228:231], v[212:215]
    buffer_load_dwordx4 a[108:111], v1, s[20:23], s68 offen offset:3072 sc1
    v_mfma_f32_16x16x32_bf16 a[248:251], a[112:115], a[228:231], a[248:251]
    s_add_u32 s68, s68, 4096
    v_fma_f32 v242, v246, s64, v244
    v_mfma_f32_16x16x32_bf16 a[248:251], a[116:119], a[232:235], a[248:251]
    s_waitcnt lgkmcnt(0)
    v_fma_f32 v243, v247, s64, v245
    v_mfma_f32_16x16x32_bf16 a[252:255], a[112:115], a[232:235], a[252:255]
    s_waitcnt vmcnt(14)
    v_fma_f32 v244, v246, -s64, v244
    v_mfma_f32_16x16x32_bf16 a[252:255], a[116:119], a[236:239], a[252:255]
    v_fma_f32 v245, v247, -s64, v245
    v_fma_f32 v250, v22, -s66, v250
    v_mfma_f32_16x16x32_bf16 v[52:55], a[120:123], a[0:3], v[52:55]
    buffer_load_dwordx4 a[112:115], v1, s[20:23], s68 offen offset:0 sc1
    v_mfma_f32_16x16x32_bf16 v[52:55], a[124:127], a[4:7], v[52:55]
    v_fma_f32 v251, v23, -s66, v251
    v_cvt_pk_bf16_f32 v217, v252, v253
    v_mfma_f32_16x16x32_bf16 v[56:59], a[120:123], a[4:7], v[56:59]
    ds_read_b128 a[216:219], v254 offset:48
    v_cvt_pk_bf16_f32 v221, v240, v241
    v_mfma_f32_16x16x32_bf16 v[56:59], a[124:127], a[8:11], v[56:59]
    ds_read_b128 a[220:223], v254 offset:400
    v_cvt_pk_bf16_f32 v225, v248, v249
    v_mfma_f32_16x16x32_bf16 v[60:63], a[120:123], a[8:11], v[60:63]
    v_cvt_pk_bf16_f32 v229, v242, v243
    v_cvt_pk_bf16_f32 v233, v244, v245
    v_mfma_f32_16x16x32_bf16 v[60:63], a[124:127], a[12:15], v[60:63]
    buffer_load_dwordx4 a[116:119], v1, s[20:23], s68 offen offset:1024 sc1
    v_mfma_f32_16x16x32_bf16 v[176:179], a[120:123], a[12:15], v[176:179]
    v_cvt_pk_bf16_f32 v237, v250, v251
    v_mov_b32_dpp v16, v164 row_shl:4 row_mask:0xf bank_mask:0xf bound_ctrl:0
    v_mfma_f32_16x16x32_bf16 v[176:179], a[124:127], a[16:19], v[176:179]
    ds_read_b128 a[224:227], v254 offset:752
    v_mov_b32_dpp v17, v165 row_shl:4 row_mask:0xf bank_mask:0xf bound_ctrl:0
    v_mfma_f32_16x16x32_bf16 v[180:183], a[120:123], a[16:19], v[180:183]
    s_waitcnt vmcnt(14)
    ds_read_b128 a[228:231], v254 offset:1104
    v_mfma_f32_16x16x32_bf16 v[180:183], a[124:127], a[20:23], v[180:183]
    v_mov_b32_dpp v18, v166 row_shl:4 row_mask:0xf bank_mask:0xf bound_ctrl:0
    v_mov_b32_dpp v19, v167 row_shl:4 row_mask:0xf bank_mask:0xf bound_ctrl:0
    v_mfma_f32_16x16x32_bf16 v[200:203], a[132:135], a[20:23], v[200:203]
    buffer_load_dwordx4 a[120:123], v1, s[20:23], s68 offen offset:2048 sc1
    v_mfma_f32_16x16x32_bf16 v[200:203], a[128:131], a[16:19], v[200:203]
    v_mov_b32_dpp v20, v172 row_shl:4 row_mask:0xf bank_mask:0xf bound_ctrl:0
    v_mov_b32_dpp v21, v173 row_shl:4 row_mask:0xf bank_mask:0xf bound_ctrl:0
    v_mfma_f32_16x16x32_bf16 v[196:199], a[132:135], a[16:19], v[196:199]
    ds_read_b128 a[232:235], v254 offset:1456
    v_mov_b32_dpp v22, v174 row_shl:4 row_mask:0xf bank_mask:0xf bound_ctrl:0
    v_mfma_f32_16x16x32_bf16 v[196:199], a[128:131], a[12:15], v[196:199]
    ds_read_b128 a[236:239], v254 offset:1808
    v_mov_b32_dpp v23, v175 row_shl:4 row_mask:0xf bank_mask:0xf bound_ctrl:0
    v_mfma_f32_16x16x32_bf16 v[192:195], a[132:135], a[12:15], v[192:195]
    v_mov_b32_dpp v24, v164 row_shl:8 row_mask:0xf bank_mask:0xf bound_ctrl:0
    v_mov_b32_dpp v25, v165 row_shl:8 row_mask:0xf bank_mask:0xf bound_ctrl:0
    v_mfma_f32_16x16x32_bf16 v[192:195], a[128:131], a[8:11], v[192:195]
    buffer_load_dwordx4 a[124:127], v1, s[20:23], s68 offen offset:3072 sc1
    v_mfma_f32_16x16x32_bf16 v[188:191], a[132:135], a[8:11], v[188:191]
    s_add_u32 s68, s68, 4096
    v_mov_b32_dpp v26, v166 row_shl:8 row_mask:0xf bank_mask:0xf bound_ctrl:0
    v_mfma_f32_16x16x32_bf16 v[188:191], a[128:131], a[4:7], v[188:191]
    v_mov_b32_dpp v27, v167 row_shl:8 row_mask:0xf bank_mask:0xf bound_ctrl:0
    v_mov_b32_dpp v28, v172 row_shl:8 row_mask:0xf bank_mask:0xf bound_ctrl:0
    v_mfma_f32_16x16x32_bf16 v[184:187], a[132:135], a[4:7], v[184:187]
    s_waitcnt vmcnt(14)
    v_mov_b32_dpp v29, v173 row_shl:8 row_mask:0xf bank_mask:0xf bound_ctrl:0
    v_mfma_f32_16x16x32_bf16 v[184:187], a[128:131], a[0:3], v[184:187]
    v_mov_b32_dpp v30, v174 row_shl:8 row_mask:0xf bank_mask:0xf bound_ctrl:0
    v_mov_b32_dpp v31, v175 row_shl:8 row_mask:0xf bank_mask:0xf bound_ctrl:0
    v_mfma_f32_16x16x32_bf16 v[204:207], a[136:139], a[0:3], v[204:207]
    buffer_load_dwordx4 a[128:131], v1, s[20:23], s68 offen offset:0 sc1
    v_mfma_f32_16x16x32_bf16 v[204:207], a[140:143], a[4:7], v[204:207]
    v_fma_f32 v240, v16, -s58, v24
    v_fma_f32 v241, v17, -s58, v25
    v_mfma_f32_16x16x32_bf16 v[208:211], a[136:139], a[4:7], v[208:211]
    v_fma_f32 v242, v172, -s58, v20
    v_fma_f32 v243, v173, -s58, v21
    v_mfma_f32_16x16x32_bf16 v[208:211], a[140:143], a[8:11], v[208:211]
    v_fma_f32 v244, v16, -s62, v24
    v_fma_f32 v245, v17, -s62, v25
    v_mfma_f32_16x16x32_bf16 v[212:215], a[136:139], a[8:11], v[212:215]
    v_fma_f32 v246, v172, -s62, v20
    v_fma_f32 v247, v173, -s62, v21
    v_mfma_f32_16x16x32_bf16 v[212:215], a[140:143], a[12:15], v[212:215]
    buffer_load_dwordx4 a[132:135], v1, s[20:23], s68 offen offset:1024 sc1
    v_mfma_f32_16x16x32_bf16 a[248:251], a[136:139], a[12:15], a[248:251]
    v_add_f32 v248, v164, v24
    v_add_f32 v249, v165, v25
    v_mfma_f32_16x16x32_bf16 a[248:251], a[140:143], a[16:19], a[248:251]
    s_waitcnt lgkmcnt(0)
    v_add_f32 v250, v172, v28
    v_mfma_f32_16x16x32_bf16 a[252:255], a[136:139], a[16:19], a[252:255]
    s_waitcnt vmcnt(14)
    v_add_f32 v251, v173, v29
    v_mfma_f32_16x16x32_bf16 a[252:255], a[140:143], a[20:23], a[252:255]
    v_fma_f32 v252, v242, s60, v240
    v_fma_f32 v253, v243, s60, v241
    v_mfma_f32_16x16x32_bf16 v[52:55], a[72:75], a[216:219], v[52:55]
    buffer_load_dwordx4 a[136:139], v1, s[20:23], s68 offen offset:2048 sc1
    v_mfma_f32_16x16x32_bf16 v[52:55], a[76:79], a[220:223], v[52:55]
    v_fma_f32 v240, v242, -s60, v240
    v_fma_f32 v241, v243, -s60, v241
    v_mfma_f32_16x16x32_bf16 v[56:59], a[72:75], a[220:223], v[56:59]
    ds_read_b128 a[0:3], v254 offset:64
    v_fma_f32 v248, v16, -s66, v248
    v_mfma_f32_16x16x32_bf16 v[56:59], a[76:79], a[224:227], v[56:59]
    ds_read_b128 a[4:7], v254 offset:416
    v_fma_f32 v249, v17, -s66, v249
    v_mfma_f32_16x16x32_bf16 v[60:63], a[72:75], a[224:227], v[60:63]
    v_fma_f32 v242, v246, s64, v244
    v_fma_f32 v243, v247, s64, v245
    v_mfma_f32_16x16x32_bf16 v[60:63], a[76:79], a[228:231], v[60:63]
    buffer_load_dwordx4 a[140:143], v1, s[20:23], s68 offen offset:3072 sc1
    v_mfma_f32_16x16x32_bf16 v[176:179], a[72:75], a[228:231], v[176:179]
    s_add_u32 s68, s68, 4096
    v_fma_f32 v244, v246, -s64, v244
    v_mfma_f32_16x16x32_bf16 v[176:179], a[76:79], a[232:235], v[176:179]
    ds_read_b128 a[8:11], v254 offset:768
    v_fma_f32 v245, v247, -s64, v245
    v_mfma_f32_16x16x32_bf16 v[180:183], a[72:75], a[232:235], v[180:183]
    s_waitcnt vmcnt(14)
    ds_read_b128 a[12:15], v254 offset:1120
    v_mfma_f32_16x16x32_bf16 v[180:183], a[76:79], a[236:239], v[180:183]
    v_fma_f32 v250, v20, -s66, v250
    v_fma_f32 v251, v21, -s66, v251
    v_mfma_f32_16x16x32_bf16 v[200:203], a[84:87], a[236:239], v[200:203]
    buffer_load_dwordx4 a[72:75], v1, s[20:23], s68 offen offset:0 sc1
    v_mfma_f32_16x16x32_bf16 v[200:203], a[80:83], a[232:235], v[200:203]
    v_cvt_pk_bf16_f32 v218, v252, v253
    v_cvt_pk_bf16_f32 v222, v240, v241
    v_mfma_f32_16x16x32_bf16 v[196:199], a[84:87], a[232:235], v[196:199]
    ds_read_b128 a[16:19], v254 offset:1472
    v_cvt_pk_bf16_f32 v226, v248, v249
    v_mfma_f32_16x16x32_bf16 v[196:199], a[80:83], a[228:231], v[196:199]
    ds_read_b128 a[20:23], v254 offset:1824
    v_cvt_pk_bf16_f32 v230, v242, v243
    v_mfma_f32_16x16x32_bf16 v[192:195], a[84:87], a[228:231], v[192:195]
    v_cvt_pk_bf16_f32 v234, v244, v245
    v_cvt_pk_bf16_f32 v238, v250, v251
    v_mfma_f32_16x16x32_bf16 v[192:195], a[80:83], a[224:227], v[192:195]
    buffer_load_dwordx4 a[76:79], v1, s[20:23], s68 offen offset:1024 sc1
    v_mfma_f32_16x16x32_bf16 v[188:191], a[84:87], a[224:227], v[188:191]
    v_fma_f32 v240, v18, -s58, v26
    v_fma_f32 v241, v19, -s58, v27
    v_mfma_f32_16x16x32_bf16 v[188:191], a[80:83], a[220:223], v[188:191]
    v_fma_f32 v242, v174, -s58, v22
    v_fma_f32 v243, v175, -s58, v23
    v_mfma_f32_16x16x32_bf16 v[184:187], a[84:87], a[220:223], v[184:187]
    s_waitcnt vmcnt(14)
    v_fma_f32 v244, v18, -s62, v26
    v_mfma_f32_16x16x32_bf16 v[184:187], a[80:83], a[216:219], v[184:187]
    v_fma_f32 v245, v19, -s62, v27
    v_fma_f32 v246, v174, -s62, v22
    v_mfma_f32_16x16x32_bf16 v[204:207], a[88:91], a[216:219], v[204:207]
    buffer_load_dwordx4 a[80:83], v1, s[20:23], s68 offen offset:2048 sc1
    v_mfma_f32_16x16x32_bf16 v[204:207], a[92:95], a[220:223], v[204:207]
    v_fma_f32 v247, v175, -s62, v23
    v_add_f32 v248, v166, v26
L_pg2:
    s_cbranch_execz L_pg6
    v_mfma_f32_16x16x32_bf16 v[208:211], a[88:91], a[220:223], v[208:211]
    v_add_f32 v249, v167, v27
    v_add_f32 v250, v174, v30
    v_mfma_f32_16x16x32_bf16 v[208:211], a[92:95], a[224:227], v[208:211]
    v_add_f32 v251, v175, v31
    v_fma_f32 v252, v242, s60, v240
    v_mfma_f32_16x16x32_bf16 v[212:215], a[88:91], a[224:227], v[212:215]
    v_fma_f32 v253, v243, s60, v241
    v_fma_f32 v240, v242, -s60, v240
    v_mfma_f32_16x16x32_bf16 v[212:215], a[92:95], a[228:231], v[212:215]
    buffer_load_dwordx4 a[84:87], v1, s[20:23], s68 offen offset:3072 sc1
    v_mfma_f32_16x16x32_bf16 a[248:251], a[88:91], a[228:231], a[248:251]
    s_add_u32 s68, s68, 4096
    v_fma_f32 v241, v243, -s60, v241
    v_mfma_f32_16x16x32_bf16 a[248:251], a[92:95], a[232:235], a[248:251]
    s_waitcnt lgkmcnt(0)
    v_fma_f32 v248, v18, -s66, v248
    v_mfma_f32_16x16x32_bf16 a[252:255], a[88:91], a[232:235], a[252:255]
    s_waitcnt vmcnt(14)
    v_fma_f32 v249, v19, -s66, v249
    v_mfma_f32_16x16x32_bf16 a[252:255], a[92:95], a[236:239], a[252:255]
    v_fma_f32 v242, v246, s64, v244
    v_fma_f32 v243, v247, s64, v245
    v_mfma_f32_16x16x32_bf16 v[52:55], a[96:99], a[0:3], v[52:55]
    buffer_load_dwordx4 a[88:91], v1, s[20:23], s68 offen offset:0 sc1
    v_mfma_f32_16x16x32_bf16 v[52:55], a[100:103], a[4:7], v[52:55]
    v_fma_f32 v244, v246, -s64, v244
    v_fma_f32 v245, v247, -s64, v245
    v_mfma_f32_16x16x32_bf16 v[56:59], a[96:99], a[4:7], v[56:59]
    ds_read_b128 a[216:219], v254 offset:6336
    v_fma_f32 v250, v22, -s66, v250
    v_mfma_f32_16x16x32_bf16 v[56:59], a[100:103], a[8:11], v[56:59]
    ds_read_b128 a[220:223], v254 offset:6688
    v_fma_f32 v251, v23, -s66, v251
    v_mfma_f32_16x16x32_bf16 v[60:63], a[96:99], a[8:11], v[60:63]
    v_cvt_pk_bf16_f32 v219, v252, v253
    v_cvt_pk_bf16_f32 v223, v240, v241
    v_mfma_f32_16x16x32_bf16 v[60:63], a[100:103], a[12:15], v[60:63]
    buffer_load_dwordx4 a[92:95], v1, s[20:23], s68 offen offset:1024 sc1
    v_mfma_f32_16x16x32_bf16 v[176:179], a[96:99], a[12:15], v[176:179]
    v_cvt_pk_bf16_f32 v227, v248, v249
    v_cvt_pk_bf16_f32 v231, v242, v243
    v_mfma_f32_16x16x32_bf16 v[176:179], a[100:103], a[16:19], v[176:179]
    ds_read_b128 a[224:227], v254 offset:7040
    v_cvt_pk_bf16_f32 v235, v244, v245
    v_mfma_f32_16x16x32_bf16 v[180:183], a[96:99], a[16:19], v[180:183]
    s_waitcnt vmcnt(14)
    ds_read_b128 a[228:231], v254 offset:7392
    v_mfma_f32_16x16x32_bf16 v[180:183], a[100:103], a[20:23], v[180:183]
    v_cvt_pk_bf16_f32 v239, v250, v251
    v_mfma_f32_16x16x32_bf16 v[200:203], a[108:111], a[20:23], v[200:203]
    buffer_load_dwordx4 a[96:99], v1, s[20:23], s68 offen offset:2048 sc1
    v_mfma_f32_16x16x32_bf16 v[200:203], a[104:107], a[16:19], v[200:203]
    s_mov_b64 exec, s[96:97]
    ds_write_b128 v4, v[216:219] offset:0
    s_mov_b64 exec, -1
    v_mfma_f32_16x16x32_bf16 v[196:199], a[108:111], a[16:19], v[196:199]
    ds_read_b128 a[232:235], v254 offset:7744
    v_fma_f32 v240, v80, -s58, v96
    v_mfma_f32_16x16x32_bf16 v[196:199], a[104:107], a[12:15], v[196:199]
    ds_read_b128 a[236:239], v254 offset:8096
    v_fma_f32 v241, v81, -s58, v97
    v_mfma_f32_16x16x32_bf16 v[192:195], a[108:111], a[12:15], v[192:195]
    s_mov_b64 exec, s[96:97]
    ds_write_b128 v4, v[220:223] offset:6336
    s_mov_b64 exec, -1
    v_mfma_f32_16x16x32_bf16 v[192:195], a[104:107], a[8:11], v[192:195]
    buffer_load_dwordx4 a[100:103], v1, s[20:23], s68 offen offset:3072 sc1
    v_mfma_f32_16x16x32_bf16 v[188:191], a[108:111], a[8:11], v[188:191]
    s_add_u32 s68, s68, 4096
    v_fma_f32 v242, v72, -s58, v88
    v_mfma_f32_16x16x32_bf16 v[188:191], a[104:107], a[4:7], v[188:191]
    s_mov_b64 exec, s[96:97]
    ds_write_b128 v4, v[224:227] offset:12672
    s_mov_b64 exec, -1
    v_mfma_f32_16x16x32_bf16 v[184:187], a[108:111], a[4:7], v[184:187]
    s_waitcnt vmcnt(14)
    v_fma_f32 v243, v73, -s58, v89
    v_mfma_f32_16x16x32_bf16 v[184:187], a[104:107], a[0:3], v[184:187]
    v_fma_f32 v244, v80, -s62, v96
    v_fma_f32 v245, v81, -s62, v97
    v_mfma_f32_16x16x32_bf16 v[204:207], a[112:115], a[0:3], v[204:207]
    buffer_load_dwordx4 a[104:107], v1, s[20:23], s68 offen offset:0 sc1
    v_mfma_f32_16x16x32_bf16 v[204:207], a[116:119], a[4:7], v[204:207]
    s_mov_b64 exec, s[96:97]
    ds_write_b128 v5, v[228:231] offset:0
    s_mov_b64 exec, -1
    v_mfma_f32_16x16x32_bf16 v[208:211], a[112:115], a[4:7], v[208:211]
    v_fma_f32 v246, v72, -s62, v88
    v_fma_f32 v247, v73, -s62, v89
    v_mfma_f32_16x16x32_bf16 v[208:211], a[116:119], a[8:11], v[208:211]
    v_add_f32 v248, v64, v96
    v_add_f32 v249, v65, v97
    v_mfma_f32_16x16x32_bf16 v[212:215], a[112:115], a[8:11], v[212:215]
    s_mov_b64 exec, s[96:97]
    ds_write_b128 v5, v[232:235] offset:6336
    s_mov_b64 exec, -1
    v_mfma_f32_16x16x32_bf16 v[212:215], a[116:119], a[12:15], v[212:215]
    buffer_load_dwordx4 a[108:111], v1, s[20:23], s68 offen offset:1024 sc1
    v_mfma_f32_16x16x32_bf16 a[248:251], a[112:115], a[12:15], a[248:251]
    v_add_f32 v250, v72, v104
    v_add_f32 v251, v73, v105
    v_mfma_f32_16x16x32_bf16 a[248:251], a[116:119], a[16:19], a[248:251]
    s_waitcnt lgkmcnt(4)
    v_fma_f32 v252, v242, s60, v240
    v_mfma_f32_16x16x32_bf16 a[252:255], a[112:115], a[16:19], a[252:255]
    s_waitcnt vmcnt(14)
    v_fma_f32 v253, v243, s60, v241
    v_mfma_f32_16x16x32_bf16 a[252:255], a[116:119], a[20:23], a[252:255]
    s_mov_b64 exec, s[96:97]
    ds_write_b128 v5, v[236:239] offset:12672
    s_mov_b64 exec, -1
    v_mfma_f32_16x16x32_bf16 v[8:11], a[120:123], a[216:219], 0
    buffer_load_dwordx4 a[112:115], v1, s[20:23], s68 offen offset:2048 sc1
    v_mfma_f32_16x16x32_bf16 v[8:11], a[124:127], a[220:223], v[8:11]
    v_fma_f32 v240, v242, -s60, v240
    v_fma_f32 v241, v243, -s60, v241
    v_mfma_f32_16x16x32_bf16 v[12:15], a[120:123], a[220:223], 0
    ds_read_b128 a[0:3], v254 offset:6352
    v_fma_f32 v248, v80, -s66, v248
    v_mfma_f32_16x16x32_bf16 v[12:15], a[124:127], a[224:227], v[12:15]
    ds_read_b128 a[4:7], v254 offset:6704
    v_fma_f32 v249, v81, -s66, v249
    v_mfma_f32_16x16x32_bf16 v[160:163], a[120:123], a[224:227], 0
    v_fma_f32 v242, v246, s64, v244
    v_fma_f32 v243, v247, s64, v245
    v_mfma_f32_16x16x32_bf16 v[160:163], a[124:127], a[228:231], v[160:163]
    buffer_load_dwordx4 a[116:119], v1, s[20:23], s68 offen offset:3072 sc1
    v_mfma_f32_16x16x32_bf16 v[164:167], a[120:123], a[228:231], 0
    s_add_u32 s68, s68, 4096
    v_fma_f32 v244, v246, -s64, v244
    v_mfma_f32_16x16x32_bf16 v[164:167], a[124:127], a[232:235], v[164:167]
    ds_read_b128 a[8:11], v254 offset:7056
    v_fma_f32 v245, v247, -s64, v245
    v_mfma_f32_16x16x32_bf16 v[168:171], a[120:123], a[232:235], 0
    s_waitcnt vmcnt(14)
    ds_read_b128 a[12:15], v254 offset:7408
    v_mfma_f32_16x16x32_bf16 v[168:171], a[124:127], a[236:239], v[168:171]
    v_fma_f32 v250, v88, -s66, v250
    v_fma_f32 v251, v89, -s66, v251
    v_mfma_f32_16x16x32_bf16 v[28:31], a[132:135], a[236:239], 0
    buffer_load_dwordx4 a[120:123], v1, s[20:23], s68 offen offset:0 sc1
    v_mfma_f32_16x16x32_bf16 v[28:31], a[128:131], a[232:235], v[28:31]
    v_cvt_pk_bf16_f32 v216, v252, v253
    v_cvt_pk_bf16_f32 v220, v240, v241
    v_mfma_f32_16x16x32_bf16 v[24:27], a[132:135], a[232:235], 0
    ds_read_b128 a[16:19], v254 offset:7760
    v_cvt_pk_bf16_f32 v224, v248, v249
    v_mfma_f32_16x16x32_bf16 v[24:27], a[128:131], a[228:231], v[24:27]
    ds_read_b128 a[20:23], v254 offset:8112
    v_cvt_pk_bf16_f32 v228, v242, v243
    v_mfma_f32_16x16x32_bf16 v[20:23], a[132:135], a[228:231], 0
    v_cvt_pk_bf16_f32 v232, v244, v245
    v_cvt_pk_bf16_f32 v236, v250, v251
    v_mfma_f32_16x16x32_bf16 v[20:23], a[128:131], a[224:227], v[20:23]
    buffer_load_dwordx4 a[124:127], v1, s[20:23], s68 offen offset:1024 sc1
    v_mfma_f32_16x16x32_bf16 v[16:19], a[132:135], a[224:227], 0
    v_fma_f32 v240, v82, -s58, v98
    v_fma_f32 v241, v83, -s58, v99
    v_mfma_f32_16x16x32_bf16 v[16:19], a[128:131], a[220:223], v[16:19]
    v_fma_f32 v242, v74, -s58, v90
    v_fma_f32 v243, v75, -s58, v91
    v_mfma_f32_16x16x32_bf16 v[172:175], a[132:135], a[220:223], 0
    s_waitcnt vmcnt(14)
    v_fma_f32 v244, v82, -s62, v98
    v_mfma_f32_16x16x32_bf16 v[172:175], a[128:131], a[216:219], v[172:175]
    v_fma_f32 v245, v83, -s62, v99
    v_fma_f32 v246, v74, -s62, v90
    v_mfma_f32_16x16x32_bf16 v[32:35], a[136:139], a[216:219], 0
    buffer_load_dwordx4 a[128:131], v1, s[20:23], s68 offen offset:2048 sc1
    v_mfma_f32_16x16x32_bf16 v[32:35], a[140:143], a[220:223], v[32:35]
    v_fma_f32 v247, v75, -s62, v91
    v_add_f32 v248, v66, v98
    v_mfma_f32_16x16x32_bf16 v[36:39], a[136:139], a[220:223], 0
    v_add_f32 v249, v67, v99
    v_add_f32 v250, v74, v106
    v_mfma_f32_16x16x32_bf16 v[36:39], a[140:143], a[224:227], v[36:39]
    v_add_f32 v251, v75, v107
    v_fma_f32 v252, v242, s60, v240
    v_mfma_f32_16x16x32_bf16 v[40:43], a[136:139], a[224:227], 0
    v_fma_f32 v253, v243, s60, v241
    v_fma_f32 v240, v242, -s60, v240
    v_mfma_f32_16x16x32_bf16 v[40:43], a[140:143], a[228:231], v[40:43]
    buffer_load_dwordx4 a[132:135], v1, s[20:23], s68 offen offset:3072 sc1
    v_mfma_f32_16x16x32_bf16 v[44:47], a[136:139], a[228:231], 0
    s_add_u32 s68, s68, 4096
    v_fma_f32 v241, v243, -s60, v241
    v_mfma_f32_16x16x32_bf16 v[44:47], a[140:143], a[232:235], v[44:47]
    s_waitcnt lgkmcnt(0)
    v_fma_f32 v248, v82, -s66, v248
    v_mfma_f32_16x16x32_bf16 v[48:51], a[136:139], a[232:235], 0
    s_waitcnt vmcnt(14)
    v_fma_f32 v249, v83, -s66, v249
    v_mfma_f32_16x16x32_bf16 v[48:51], a[140:143], a[236:239], v[48:51]
    v_fma_f32 v242, v246, s64, v244
    v_fma_f32 v243, v247, s64, v245
    v_mfma_f32_16x16x32_bf16 v[8:11], a[72:75], a[0:3], v[8:11]
    buffer_load_dwordx4 a[136:139], v1, s[20:23], s68 offen offset:0 sc1
    v_mfma_f32_16x16x32_bf16 v[8:11], a[76:79], a[4:7], v[8:11]
    v_fma_f32 v244, v246, -s64, v244
    v_fma_f32 v245, v247, -s64, v245
    v_mfma_f32_16x16x32_bf16 v[12:15], a[72:75], a[4:7], v[12:15]
    ds_read_b128 a[216:219], v254 offset:6368
    v_fma_f32 v250, v90, -s66, v250
    v_mfma_f32_16x16x32_bf16 v[12:15], a[76:79], a[8:11], v[12:15]
    ds_read_b128 a[220:223], v254 offset:6720
    v_fma_f32 v251, v91, -s66, v251
    v_mfma_f32_16x16x32_bf16 v[160:163], a[72:75], a[8:11], v[160:163]
    v_cvt_pk_bf16_f32 v217, v252, v253
    v_cvt_pk_bf16_f32 v221, v240, v241
    v_mfma_f32_16x16x32_bf16 v[160:163], a[76:79], a[12:15], v[160:163]
    buffer_load_dwordx4 a[140:143], v1, s[20:23], s68 offen offset:1024 sc1
    v_mfma_f32_16x16x32_bf16 v[164:167], a[72:75], a[12:15], v[164:167]
    v_cvt_pk_bf16_f32 v225, v248, v249
    v_cvt_pk_bf16_f32 v229, v242, v243
    v_mfma_f32_16x16x32_bf16 v[164:167], a[76:79], a[16:19], v[164:167]
    ds_read_b128 a[224:227], v254 offset:7072
    v_cvt_pk_bf16_f32 v233, v244, v245
    v_mfma_f32_16x16x32_bf16 v[168:171], a[72:75], a[16:19], v[168:171]
    s_waitcnt vmcnt(14)
    ds_read_b128 a[228:231], v254 offset:7424
    v_mfma_f32_16x16x32_bf16 v[168:171], a[76:79], a[20:23], v[168:171]
    v_cvt_pk_bf16_f32 v237, v250, v251
    v_fma_f32 v240, v84, -s58, v100
    v_mfma_f32_16x16x32_bf16 v[28:31], a[84:87], a[20:23], v[28:31]
    buffer_load_dwordx4 a[72:75], v1, s[20:23], s68 offen offset:2048 sc1
    v_mfma_f32_16x16x32_bf16 v[28:31], a[80:83], a[16:19], v[28:31]
    v_fma_f32 v241, v85, -s58, v101
    v_fma_f32 v242, v76, -s58, v92
    v_mfma_f32_16x16x32_bf16 v[24:27], a[84:87], a[16:19], v[24:27]
    ds_read_b128 a[232:235], v254 offset:7776
    v_fma_f32 v243, v77, -s58, v93
    v_mfma_f32_16x16x32_bf16 v[24:27], a[80:83], a[12:15], v[24:27]
    ds_read_b128 a[236:239], v254 offset:8128
    v_fma_f32 v244, v84, -s62, v100
    v_mfma_f32_16x16x32_bf16 v[20:23], a[84:87], a[12:15], v[20:23]
    v_fma_f32 v245, v85, -s62, v101
    v_fma_f32 v246, v76, -s62, v92
    v_mfma_f32_16x16x32_bf16 v[20:23], a[80:83], a[8:11], v[20:23]
    buffer_load_dwordx4 a[76:79], v1, s[20:23], s68 offen offset:3072 sc1
    v_mfma_f32_16x16x32_bf16 v[16:19], a[84:87], a[8:11], v[16:19]
    s_add_u32 s68, s68, 4096
    v_fma_f32 v247, v77, -s62, v93
    v_mfma_f32_16x16x32_bf16 v[16:19], a[80:83], a[4:7], v[16:19]
    v_add_f32 v248, v68, v100
    v_add_f32 v249, v69, v101
    v_mfma_f32_16x16x32_bf16 v[172:175], a[84:87], a[4:7], v[172:175]
    s_waitcnt vmcnt(14)
    v_add_f32 v250, v76, v108
    v_mfma_f32_16x16x32_bf16 v[172:175], a[80:83], a[0:3], v[172:175]
    v_add_f32 v251, v77, v109
    v_fma_f32 v252, v242, s60, v240
    v_mfma_f32_16x16x32_bf16 v[32:35], a[88:91], a[0:3], v[32:35]
    buffer_load_dwordx4 a[80:83], v1, s[20:23], s68 offen offset:0 sc1
    v_mfma_f32_16x16x32_bf16 v[32:35], a[92:95], a[4:7], v[32:35]
    v_fma_f32 v253, v243, s60, v241
    v_fma_f32 v240, v242, -s60, v240
    v_mfma_f32_16x16x32_bf16 v[36:39], a[88:91], a[4:7], v[36:39]
    v_fma_f32 v241, v243, -s60, v241
    v_fma_f32 v248, v84, -s66, v248
    v_mfma_f32_16x16x32_bf16 v[36:39], a[92:95], a[8:11], v[36:39]
    v_fma_f32 v249, v85, -s66, v249
    v_fma_f32 v242, v246, s64, v244
    v_mfma_f32_16x16x32_bf16 v[40:43], a[88:91], a[8:11], v[40:43]
    v_fma_f32 v243, v247, s64, v245
    v_fma_f32 v244, v246, -s64, v244
    v_mfma_f32_16x16x32_bf16 v[40:43], a[92:95], a[12:15], v[40:43]
    buffer_load_dwordx4 a[84:87], v1, s[20:23], s68 offen offset:1024 sc1
    v_mfma_f32_16x16x32_bf16 v[44:47], a[88:91], a[12:15], v[44:47]
    v_fma_f32 v245, v247, -s64, v245
    v_fma_f32 v250, v92, -s66, v250
    v_mfma_f32_16x16x32_bf16 v[44:47], a[92:95], a[16:19], v[44:47]
    s_waitcnt lgkmcnt(0)
    v_fma_f32 v251, v93, -s66, v251
    v_mfma_f32_16x16x32_bf16 v[48:51], a[88:91], a[16:19], v[48:51]
    s_waitcnt vmcnt(14)
    v_cvt_pk_bf16_f32 v218, v252, v253
    v_mfma_f32_16x16x32_bf16 v[48:51], a[92:95], a[20:23], v[48:51]
    v_cvt_pk_bf16_f32 v222, v240, v241
    v_cvt_pk_bf16_f32 v226, v248, v249
    v_mfma_f32_16x16x32_bf16 v[8:11], a[96:99], a[216:219], v[8:11]
    buffer_load_dwordx4 a[88:91], v1, s[20:23], s68 offen offset:2048 sc1
    v_mfma_f32_16x16x32_bf16 v[8:11], a[100:103], a[220:223], v[8:11]
    v_cvt_pk_bf16_f32 v230, v242, v243
    v_cvt_pk_bf16_f32 v234, v244, v245
    v_mfma_f32_16x16x32_bf16 v[12:15], a[96:99], a[220:223], v[12:15]
    ds_read_b128 a[0:3], v254 offset:6384
    v_cvt_pk_bf16_f32 v238, v250, v251
    v_mfma_f32_16x16x32_bf16 v[12:15], a[100:103], a[224:227], v[12:15]
    ds_read_b128 a[4:7], v254 offset:6736
    v_fma_f32 v240, v86, -s58, v102
    v_mfma_f32_16x16x32_bf16 v[160:163], a[96:99], a[224:227], v[160:163]
    v_fma_f32 v241, v87, -s58, v103
    v_fma_f32 v242, v78, -s58, v94
    v_mfma_f32_16x16x32_bf16 v[160:163], a[100:103], a[228:231], v[160:163]
    buffer_load_dwordx4 a[92:95], v1, s[20:23], s68 offen offset:3072 sc1
    v_mfma_f32_16x16x32_bf16 v[164:167], a[96:99], a[228:231], v[164:167]
    s_add_u32 s68, s68, 4096
    v_fma_f32 v243, v79, -s58, v95
    v_mfma_f32_16x16x32_bf16 v[164:167], a[100:103], a[232:235], v[164:167]
    ds_read_b128 a[8:11], v254 offset:7088
    v_fma_f32 v244, v86, -s62, v102
    v_mfma_f32_16x16x32_bf16 v[168:171], a[96:99], a[232:235], v[168:171]
    s_waitcnt vmcnt(14)
    ds_read_b128 a[12:15], v254 offset:7440
    v_mfma_f32_16x16x32_bf16 v[168:171], a[100:103], a[236:239], v[168:171]
    v_fma_f32 v245, v87, -s62, v103
    v_fma_f32 v246, v78, -s62, v94
    v_mfma_f32_16x16x32_bf16 v[28:31], a[108:111], a[236:239], v[28:31]
    buffer_load_dwordx4 a[96:99], v1, s[20:23], s68 offen offset:0 sc1
    v_mfma_f32_16x16x32_bf16 v[28:31], a[104:107], a[232:235], v[28:31]
    v_fma_f32 v247, v79, -s62, v95
    v_add_f32 v248, v70, v102
    v_mfma_f32_16x16x32_bf16 v[24:27], a[108:111], a[232:235], v[24:27]
    ds_read_b128 a[16:19], v254 offset:7792
    v_add_f32 v249, v71, v103
    v_mfma_f32_16x16x32_bf16 v[24:27], a[104:107], a[228:231], v[24:27]
    ds_read_b128 a[20:23], v254 offset:8144
    v_add_f32 v250, v78, v110
    v_mfma_f32_16x16x32_bf16 v[20:23], a[108:111], a[228:231], v[20:23]
    v_add_f32 v251, v79, v111
    v_fma_f32 v252, v242, s60, v240
    v_mfma_f32_16x16x32_bf16 v[20:23], a[104:107], a[224:227], v[20:23]
    buffer_load_dwordx4 a[100:103], v1, s[20:23], s68 offen offset:1024 sc1
    v_mfma_f32_16x16x32_bf16 v[16:19], a[108:111], a[224:227], v[16:19]
    v_fma_f32 v253, v243, s60, v241
    v_fma_f32 v240, v242, -s60, v240
    v_mfma_f32_16x16x32_bf16 v[16:19], a[104:107], a[220:223], v[16:19]
    v_fma_f32 v241, v243, -s60, v241
    v_fma_f32 v248, v86, -s66, v248
    v_mfma_f32_16x16x32_bf16 v[172:175], a[108:111], a[220:223], v[172:175]
    s_waitcnt vmcnt(14)
    v_fma_f32 v249, v87, -s66, v249
    v_mfma_f32_16x16x32_bf16 v[172:175], a[104:107], a[216:219], v[172:175]
    v_fma_f32 v242, v246, s64, v244
    v_fma_f32 v243, v247, s64, v245
    v_mfma_f32_16x16x32_bf16 v[32:35], a[112:115], a[216:219], v[32:35]
    buffer_load_dwordx4 a[104:107], v1, s[20:23], s68 offen offset:2048 sc1
    v_mfma_f32_16x16x32_bf16 v[32:35], a[116:119], a[220:223], v[32:35]
    v_fma_f32 v244, v246, -s64, v244
    v_fma_f32 v245, v247, -s64, v245
    v_mfma_f32_16x16x32_bf16 v[36:39], a[112:115], a[220:223], v[36:39]
    v_fma_f32 v250, v94, -s66, v250
    v_fma_f32 v251, v95, -s66, v251
    v_mfma_f32_16x16x32_bf16 v[36:39], a[116:119], a[224:227], v[36:39]
    v_cvt_pk_bf16_f32 v219, v252, v253
    v_cvt_pk_bf16_f32 v223, v240, v241
    v_mfma_f32_16x16x32_bf16 v[40:43], a[112:115], a[224:227], v[40:43]
    v_cvt_pk_bf16_f32 v227, v248, v249
    v_cvt_pk_bf16_f32 v231, v242, v243
    v_mfma_f32_16x16x32_bf16 v[40:43], a[116:119], a[228:231], v[40:43]
    buffer_load_dwordx4 a[108:111], v1, s[20:23], s68 offen offset:3072 sc1
    v_mfma_f32_16x16x32_bf16 v[44:47], a[112:115], a[228:231], v[44:47]
    s_add_u32 s68, s68, 4096
    v_cvt_pk_bf16_f32 v235, v244, v245
    v_mfma_f32_16x16x32_bf16 v[44:47], a[116:119], a[232:235], v[44:47]
    s_waitcnt lgkmcnt(0)
    v_cvt_pk_bf16_f32 v239, v250, v251
    v_mfma_f32_16x16x32_bf16 v[48:51], a[112:115], a[232:235], v[48:51]
    s_waitcnt vmcnt(14)
    v_mfma_f32_16x16x32_bf16 v[48:51], a[116:119], a[236:239], v[48:51]
    v_mfma_f32_16x16x32_bf16 v[64:67], a[242:245], a[160:163], 0
    v_mfma_f32_16x16x32_bf16 v[64:67], a[24:27], a[144:147], v[64:67]
    ds_write_b128 v2, v[216:219] offset:2112
    v_mfma_f32_16x16x32_bf16 v[64:67], a[28:31], a[148:151], v[64:67]
    v_mfma_f32_16x16x32_bf16 v[64:67], a[32:35], a[152:155], v[64:67]
    v_mfma_f32_16x16x32_bf16 v[68:71], a[240:243], a[160:163], 0
    v_mfma_f32_16x16x32_bf16 v[68:71], a[36:39], a[144:147], v[68:71]
    ds_write_b128 v2, v[220:223] offset:8448
    v_mfma_f32_16x16x32_bf16 v[68:71], a[40:43], a[148:151], v[68:71]
    v_mfma_f32_16x16x32_bf16 v[68:71], a[44:47], a[152:155], v[68:71]
    v_mfma_f32_16x16x32_bf16 v[72:75], a[242:245], a[184:187], 0
    v_mfma_f32_16x16x32_bf16 v[72:75], a[24:27], a[168:171], v[72:75]
    ds_write_b128 v2, v[224:227] offset:14784
    v_mfma_f32_16x16x32_bf16 v[72:75], a[28:31], a[172:175], v[72:75]
    v_mfma_f32_16x16x32_bf16 v[72:75], a[32:35], a[176:179], v[72:75]
    v_mfma_f32_16x16x32_bf16 v[76:79], a[240:243], a[184:187], 0
    v_mfma_f32_16x16x32_bf16 v[76:79], a[36:39], a[168:171], v[76:79]
    ds_write_b128 v3, v[228:231] offset:2464
    v_mfma_f32_16x16x32_bf16 v[76:79], a[40:43], a[172:175], v[76:79]
    v_mfma_f32_16x16x32_bf16 v[76:79], a[44:47], a[176:179], v[76:79]
    v_mfma_f32_16x16x32_bf16 v[80:83], a[242:245], a[208:211], 0
    v_mfma_f32_16x16x32_bf16 v[80:83], a[24:27], a[192:195], v[80:83]
    ds_write_b128 v3, v[232:235] offset:8800
    v_mfma_f32_16x16x32_bf16 v[80:83], a[28:31], a[196:199], v[80:83]
    v_mfma_f32_16x16x32_bf16 v[80:83], a[32:35], a[200:203], v[80:83]
    v_mfma_f32_16x16x32_bf16 v[84:87], a[240:243], a[208:211], 0
    v_mfma_f32_16x16x32_bf16 v[84:87], a[36:39], a[192:195], v[84:87]
    ds_write_b128 v3, v[236:239] offset:15136
    v_mfma_f32_16x16x32_bf16 v[84:87], a[40:43], a[196:199], v[84:87]
    v_mfma_f32_16x16x32_bf16 v[84:87], a[44:47], a[200:203], v[84:87]
    v_mfma_f32_16x16x32_bf16 v[8:11], a[120:123], a[0:3], v[8:11]
    buffer_load_dwordx4 a[112:115], v1, s[20:23], s68 offen offset:0 sc1
    v_mfma_f32_16x16x32_bf16 v[8:11], a[124:127], a[4:7], v[8:11]
    v_mfma_f32_16x16x32_bf16 v[12:15], a[120:123], a[4:7], v[12:15]
    ds_read_b128 a[216:219], v254 offset:6400
    v_mfma_f32_16x16x32_bf16 v[12:15], a[124:127], a[8:11], v[12:15]
    ds_read_b128 a[220:223], v254 offset:6752
    v_mfma_f32_16x16x32_bf16 v[160:163], a[120:123], a[8:11], v[160:163]
    s_cmp_eq_u32 s3, 3
    s_cbranch_scc0 L_ow11
    v_min_u32 v7, 27, v0
    v_lshlrev_b32 v7, 2, v7
    buffer_load_dword v6, v7, s[28:31], 0 offen offset:16 sc1
L_ow11:
    v_mfma_f32_16x16x32_bf16 v[160:163], a[124:127], a[12:15], v[160:163]
    buffer_load_dwordx4 a[116:119], v1, s[20:23], s68 offen offset:1024 sc1
    v_mfma_f32_16x16x32_bf16 v[164:167], a[120:123], a[12:15], v[164:167]
    v_mfma_f32_16x16x32_bf16 v[164:167], a[124:127], a[16:19], v[164:167]
    ds_read_b128 a[224:227], v254 offset:7104
    v_mfma_f32_16x16x32_bf16 v[168:171], a[120:123], a[16:19], v[168:171]
    s_waitcnt vmcnt(14)
    ds_read_b128 a[228:231], v254 offset:7456
    v_mfma_f32_16x16x32_bf16 v[168:171], a[124:127], a[20:23], v[168:171]
    v_fma_f32 v240, v104, -s58, v72
    v_fma_f32 v241, v105, -s58, v73
    v_mfma_f32_16x16x32_bf16 v[28:31], a[132:135], a[20:23], v[28:31]
    buffer_load_dwordx4 a[120:123], v1, s[20:23], s68 offen offset:2048 sc1
    v_mfma_f32_16x16x32_bf16 v[28:31], a[128:131], a[16:19], v[28:31]
    v_fma_f32 v242, v96, -s58, v64
    v_fma_f32 v243, v97, -s58, v65
    v_mfma_f32_16x16x32_bf16 v[24:27], a[132:135], a[16:19], v[24:27]
    ds_read_b128 a[232:235], v254 offset:7808
    v_fma_f32 v244, v104, -s62, v72
    v_mfma_f32_16x16x32_bf16 v[24:27], a[128:131], a[12:15], v[24:27]
    ds_read_b128 a[236:239], v254 offset:8160
    v_fma_f32 v245, v105, -s62, v73
    v_mfma_f32_16x16x32_bf16 v[20:23], a[132:135], a[12:15], v[20:23]
    v_fma_f32 v246, v96, -s62, v64
    v_fma_f32 v247, v97, -s62, v65
    v_mfma_f32_16x16x32_bf16 v[20:23], a[128:131], a[8:11], v[20:23]
    buffer_load_dwordx4 a[124:127], v1, s[20:23], s68 offen offset:3072 sc1
    v_mfma_f32_16x16x32_bf16 v[16:19], a[132:135], a[8:11], v[16:19]
    s_add_u32 s68, s68, 4096
    v_add_f32 v248, v88, v72
    v_mfma_f32_16x16x32_bf16 v[16:19], a[128:131], a[4:7], v[16:19]
    v_add_f32 v249, v89, v73
    v_add_f32 v250, v96, v80
    v_mfma_f32_16x16x32_bf16 v[172:175], a[132:135], a[4:7], v[172:175]
    s_waitcnt vmcnt(14)
    v_add_f32 v251, v97, v81
    v_mfma_f32_16x16x32_bf16 v[172:175], a[128:131], a[0:3], v[172:175]
    v_fma_f32 v252, v242, s60, v240
    v_fma_f32 v253, v243, s60, v241
    v_mfma_f32_16x16x32_bf16 v[32:35], a[136:139], a[0:3], v[32:35]
    buffer_load_dwordx4 a[128:131], v1, s[20:23], s68 offen offset:0 sc1
    v_mfma_f32_16x16x32_bf16 v[32:35], a[140:143], a[4:7], v[32:35]
    v_fma_f32 v240, v242, -s60, v240
    v_fma_f32 v241, v243, -s60, v241
    v_mfma_f32_16x16x32_bf16 v[36:39], a[136:139], a[4:7], v[36:39]
    v_fma_f32 v248, v104, -s66, v248
    v_fma_f32 v249, v105, -s66, v249
    v_mfma_f32_16x16x32_bf16 v[36:39], a[140:143], a[8:11], v[36:39]
    v_fma_f32 v242, v246, s64, v244
    v_fma_f32 v243, v247, s64, v245
    v_mfma_f32_16x16x32_bf16 v[40:43], a[136:139], a[8:11], v[40:43]
    v_fma_f32 v244, v246, -s64, v244
    v_fma_f32 v245, v247, -s64, v245
    v_mfma_f32_16x16x32_bf16 v[40:43], a[140:143], a[12:15], v[40:43]
    buffer_load_dwordx4 a[132:135], v1, s[20:23], s68 offen offset:1024 sc1
    v_mfma_f32_16x16x32_bf16 v[44:47], a[136:139], a[12:15], v[44:47]
    v_fma_f32 v250, v64, -s66, v250
    v_fma_f32 v251, v65, -s66, v251
    v_mfma_f32_16x16x32_bf16 v[44:47], a[140:143], a[16:19], v[44:47]
    s_waitcnt lgkmcnt(0)
    v_cvt_pk_bf16_f32 v216, v252, v253
    v_mfma_f32_16x16x32_bf16 v[48:51], a[136:139], a[16:19], v[48:51]
    s_waitcnt vmcnt(14)
    v_cvt_pk_bf16_f32 v220, v240, v241
    v_mfma_f32_16x16x32_bf16 v[48:51], a[140:143], a[20:23], v[48:51]
    v_cvt_pk_bf16_f32 v224, v248, v249
    v_cvt_pk_bf16_f32 v228, v242, v243
    v_mfma_f32_16x16x32_bf16 v[8:11], a[72:75], a[216:219], v[8:11]
    buffer_load_dwordx4 a[136:139], v1, s[20:23], s68 offen offset:2048 sc1
    v_mfma_f32_16x16x32_bf16 v[8:11], a[76:79], a[220:223], v[8:11]
    v_cvt_pk_bf16_f32 v232, v244, v245
    v_cvt_pk_bf16_f32 v236, v250, v251
    v_mfma_f32_16x16x32_bf16 v[12:15], a[72:75], a[220:223], v[12:15]
    v_fma_f32 v240, v106, -s58, v74
    v_fma_f32 v241, v107, -s58, v75
    v_mfma_f32_16x16x32_bf16 v[12:15], a[76:79], a[224:227], v[12:15]
    v_fma_f32 v242, v98, -s58, v66
    v_fma_f32 v243, v99, -s58, v67
    v_mfma_f32_16x16x32_bf16 v[160:163], a[72:75], a[224:227], v[160:163]
    v_fma_f32 v244, v106, -s62, v74
    v_fma_f32 v245, v107, -s62, v75
    v_mfma_f32_16x16x32_bf16 v[160:163], a[76:79], a[228:231], v[160:163]
    buffer_load_dwordx4 a[140:143], v1, s[20:23], s68 offen offset:3072 sc1
    v_mfma_f32_16x16x32_bf16 v[164:167], a[72:75], a[228:231], v[164:167]
    s_add_u32 s68, s68, 4096
    s_cmp_eq_u32 s3, 3
    s_cbranch_scc0 L_ready2
    s_mov_b32 s69, 0
    s_waitcnt vmcnt(7)
L_poll2:
    v_cmp_ne_u32 vcc, 0, v6
    s_add_u32 s69, s69, 1
    s_nop 0
    s_cmp_eq_u64 vcc, -1
    s_cbranch_scc1 L_ready2
    s_sleep 2
    buffer_load_dword v6, v7, s[28:31], 0 offen offset:16 sc1
    s_cmp_lt_u32 s69, 65536
    s_waitcnt vmcnt(0)
    s_cbranch_scc1 L_poll2
L_ready2:
    s_barrier
    v_mfma_f32_16x16x32_bf16 v[164:167], a[76:79], a[232:235], v[164:167]
    ds_read_b128 a[0:3], v254 offset:80
    v_fma_f32 v246, v98, -s62, v66
    v_mfma_f32_16x16x32_bf16 v[168:171], a[72:75], a[232:235], v[168:171]
    s_waitcnt vmcnt(14)
    ds_read_b128 a[4:7], v254 offset:432
    v_mfma_f32_16x16x32_bf16 v[168:171], a[76:79], a[236:239], v[168:171]
    v_fma_f32 v247, v99, -s62, v67
    v_add_f32 v248, v90, v74
    v_mfma_f32_16x16x32_bf16 v[28:31], a[84:87], a[236:239], v[28:31]
    buffer_load_dwordx4 a[72:75], v1, s[20:23], s68 offen offset:0 sc1
    v_mfma_f32_16x16x32_bf16 v[28:31], a[80:83], a[232:235], v[28:31]
    v_add_f32 v249, v91, v75
    v_add_f32 v250, v98, v82
    v_mfma_f32_16x16x32_bf16 v[24:27], a[84:87], a[232:235], v[24:27]
    ds_read_b128 a[8:11], v254 offset:784
    v_add_f32 v251, v99, v83
    v_mfma_f32_16x16x32_bf16 v[24:27], a[80:83], a[228:231], v[24:27]
    ds_read_b128 a[12:15], v254 offset:1136
    v_fma_f32 v252, v242, s60, v240
    v_mfma_f32_16x16x32_bf16 v[20:23], a[84:87], a[228:231], v[20:23]
    v_fma_f32 v253, v243, s60, v241
    v_fma_f32 v240, v242, -s60, v240
    v_mfma_f32_16x16x32_bf16 v[20:23], a[80:83], a[224:227], v[20:23]
    buffer_load_dwordx4 a[76:79], v1, s[20:23], s68 offen offset:1024 sc1
    v_mfma_f32_16x16x32_bf16 v[16:19], a[84:87], a[224:227], v[16:19]
    v_fma_f32 v241, v243, -s60, v241
    v_fma_f32 v248, v106, -s66, v248
    v_mfma_f32_16x16x32_bf16 v[16:19], a[80:83], a[220:223], v[16:19]
    ds_read_b128 a[16:19], v254 offset:1488
    v_fma_f32 v249, v107, -s66, v249
    v_mfma_f32_16x16x32_bf16 v[172:175], a[84:87], a[220:223], v[172:175]
    s_waitcnt vmcnt(14)
    ds_read_b128 a[20:23], v254 offset:1840
    v_mfma_f32_16x16x32_bf16 v[172:175], a[80:83], a[216:219], v[172:175]
    v_fma_f32 v242, v246, s64, v244
    v_fma_f32 v243, v247, s64, v245
    v_mfma_f32_16x16x32_bf16 v[32:35], a[88:91], a[216:219], v[32:35]
    buffer_load_dwordx4 a[80:83], v1, s[20:23], s68 offen offset:2048 sc1
    v_mfma_f32_16x16x32_bf16 v[32:35], a[92:95], a[220:223], v[32:35]
    v_fma_f32 v244, v246, -s64, v244
    v_fma_f32 v245, v247, -s64, v245
    v_mfma_f32_16x16x32_bf16 v[36:39], a[88:91], a[220:223], v[36:39]
    v_fma_f32 v250, v66, -s66, v250
    v_fma_f32 v251, v67, -s66, v251
    v_mfma_f32_16x16x32_bf16 v[36:39], a[92:95], a[224:227], v[36:39]
    v_cvt_pk_bf16_f32 v217, v252, v253
    v_cvt_pk_bf16_f32 v221, v240, v241
L_pg3:
    s_cbranch_execz L_pg7
    v_mfma_f32_16x16x32_bf16 v[40:43], a[88:91], a[224:227], v[40:43]
    v_cvt_pk_bf16_f32 v225, v248, v249
    v_cvt_pk_bf16_f32 v229, v242, v243
    v_mfma_f32_16x16x32_bf16 v[40:43], a[92:95], a[228:231], v[40:43]
    buffer_load_dwordx4 a[84:87], v1, s[20:23], s68 offen offset:3072 sc1
    v_mfma_f32_16x16x32_bf16 v[44:47], a[88:91], a[228:231], v[44:47]
    s_add_u32 s68, s68, 4096
    v_cvt_pk_bf16_f32 v233, v244, v245
    v_mfma_f32_16x16x32_bf16 v[44:47], a[92:95], a[232:235], v[44:47]
    s_waitcnt lgkmcnt(0)
    v_cvt_pk_bf16_f32 v237, v250, v251
    v_mfma_f32_16x16x32_bf16 v[48:51], a[88:91], a[232:235], v[48:51]
    s_waitcnt vmcnt(14)
    v_fma_f32 v240, v108, -s58, v76
    v_mfma_f32_16x16x32_bf16 v[48:51], a[92:95], a[236:239], v[48:51]
    v_fma_f32 v241, v109, -s58, v77
    v_fma_f32 v242, v100, -s58, v68
    v_mfma_f32_16x16x32_bf16 v[52:55], a[96:99], a[0:3], v[52:55]
    buffer_load_dwordx4 a[88:91], v1, s[20:23], s68 offen offset:0 sc1
    v_mfma_f32_16x16x32_bf16 v[52:55], a[100:103], a[4:7], v[52:55]
    v_fma_f32 v243, v101, -s58, v69
    v_fma_f32 v244, v108, -s62, v76
    v_mfma_f32_16x16x32_bf16 v[56:59], a[96:99], a[4:7], v[56:59]
    ds_read_b128 a[216:219], v254 offset:6416
    v_fma_f32 v245, v109, -s62, v77
    v_mfma_f32_16x16x32_bf16 v[56:59], a[100:103], a[8:11], v[56:59]
    ds_read_b128 a[220:223], v254 offset:6768
    v_fma_f32 v246, v100, -s62, v68
    v_mfma_f32_16x16x32_bf16 v[60:63], a[96:99], a[8:11], v[60:63]
    v_fma_f32 v247, v101, -s62, v69
    v_add_f32 v248, v92, v76
    v_mfma_f32_16x16x32_bf16 v[60:63], a[100:103], a[12:15], v[60:63]
    buffer_load_dwordx4 a[92:95], v1, s[20:23], s68 offen offset:1024 sc1
    v_mfma_f32_16x16x32_bf16 v[176:179], a[96:99], a[12:15], v[176:179]
    v_add_f32 v249, v93, v77
    v_add_f32 v250, v100, v84
    v_mfma_f32_16x16x32_bf16 v[176:179], a[100:103], a[16:19], v[176:179]
    ds_read_b128 a[224:227], v254 offset:7120
    v_add_f32 v251, v101, v85
    v_mfma_f32_16x16x32_bf16 v[180:183], a[96:99], a[16:19], v[180:183]
    s_waitcnt vmcnt(14)
    ds_read_b128 a[228:231], v254 offset:7472
    v_mfma_f32_16x16x32_bf16 v[180:183], a[100:103], a[20:23], v[180:183]
    v_fma_f32 v252, v242, s60, v240
    v_fma_f32 v253, v243, s60, v241
    v_mfma_f32_16x16x32_bf16 v[200:203], a[108:111], a[20:23], v[200:203]
    buffer_load_dwordx4 a[96:99], v1, s[20:23], s68 offen offset:2048 sc1
    v_mfma_f32_16x16x32_bf16 v[200:203], a[104:107], a[16:19], v[200:203]
    v_fma_f32 v240, v242, -s60, v240
    v_fma_f32 v241, v243, -s60, v241
    v_mfma_f32_16x16x32_bf16 v[196:199], a[108:111], a[16:19], v[196:199]
    ds_read_b128 a[232:235], v254 offset:7824
    v_fma_f32 v248, v108, -s66, v248
    v_mfma_f32_16x16x32_bf16 v[196:199], a[104:107], a[12:15], v[196:199]
    ds_read_b128 a[236:239], v254 offset:8176
    v_fma_f32 v249, v109, -s66, v249
    v_mfma_f32_16x16x32_bf16 v[192:195], a[108:111], a[12:15], v[192:195]
    v_fma_f32 v242, v246, s64, v244
    v_fma_f32 v243, v247, s64, v245
    v_mfma_f32_16x16x32_bf16 v[192:195], a[104:107], a[8:11], v[192:195]
    buffer_load_dwordx4 a[100:103], v1, s[20:23], s68 offen offset:3072 sc1
    v_mfma_f32_16x16x32_bf16 v[188:191], a[108:111], a[8:11], v[188:191]
    s_add_u32 s68, s68, 4096
    v_fma_f32 v244, v246, -s64, v244
    v_mfma_f32_16x16x32_bf16 v[188:191], a[104:107], a[4:7], v[188:191]
    v_fma_f32 v245, v247, -s64, v245
    v_fma_f32 v250, v68, -s66, v250
    v_mfma_f32_16x16x32_bf16 v[184:187], a[108:111], a[4:7], v[184:187]
    s_waitcnt vmcnt(14)
    v_fma_f32 v251, v69, -s66, v251
    v_mfma_f32_16x16x32_bf16 v[184:187], a[104:107], a[0:3], v[184:187]
    v_cvt_pk_bf16_f32 v218, v252, v253
    v_cvt_pk_bf16_f32 v222, v240, v241
    v_mfma_f32_16x16x32_bf16 v[204:207], a[112:115], a[0:3], v[204:207]
    buffer_load_dwordx4 a[104:107], v1, s[20:23], s68 offen offset:0 sc1
    v_mfma_f32_16x16x32_bf16 v[204:207], a[116:119], a[4:7], v[204:207]
    v_cvt_pk_bf16_f32 v226, v248, v249
    v_cvt_pk_bf16_f32 v230, v242, v243
    v_mfma_f32_16x16x32_bf16 v[208:211], a[112:115], a[4:7], v[208:211]
    v_cvt_pk_bf16_f32 v234, v244, v245
    v_cvt_pk_bf16_f32 v238, v250, v251
    v_mfma_f32_16x16x32_bf16 v[208:211], a[116:119], a[8:11], v[208:211]
    v_fma_f32 v240, v110, -s58, v78
    v_fma_f32 v241, v111, -s58, v79
    v_mfma_f32_16x16x32_bf16 v[212:215], a[112:115], a[8:11], v[212:215]
    v_fma_f32 v242, v102, -s58, v70
    v_fma_f32 v243, v103, -s58, v71
    v_mfma_f32_16x16x32_bf16 v[212:215], a[116:119], a[12:15], v[212:215]
    buffer_load_dwordx4 a[108:111], v1, s[20:23], s68 offen offset:1024 sc1
    v_mfma_f32_16x16x32_bf16 a[248:251], a[112:115], a[12:15], a[248:251]
    v_fma_f32 v244, v110, -s62, v78
    v_fma_f32 v245, v111, -s62, v79
    v_mfma_f32_16x16x32_bf16 a[248:251], a[116:119], a[16:19], a[248:251]
    s_waitcnt lgkmcnt(0)
    v_fma_f32 v246, v102, -s62, v70
    v_mfma_f32_16x16x32_bf16 a[252:255], a[112:115], a[16:19], a[252:255]
    s_waitcnt vmcnt(14)
    v_fma_f32 v247, v103, -s62, v71
    v_mfma_f32_16x16x32_bf16 a[252:255], a[116:119], a[20:23], a[252:255]
    v_add_f32 v248, v94, v78
    v_add_f32 v249, v95, v79
    v_mfma_f32_16x16x32_bf16 v[8:11], a[120:123], a[216:219], v[8:11]
    buffer_load_dwordx4 a[112:115], v1, s[20:23], s68 offen offset:2048 sc1
    v_mfma_f32_16x16x32_bf16 v[8:11], a[124:127], a[220:223], v[8:11]
    v_add_f32 v250, v102, v86
    v_add_f32 v251, v103, v87
    v_mfma_f32_16x16x32_bf16 v[12:15], a[120:123], a[220:223], v[12:15]
    ds_read_b128 a[0:3], v254 offset:96
    v_fma_f32 v252, v242, s60, v240
    v_mfma_f32_16x16x32_bf16 v[12:15], a[124:127], a[224:227], v[12:15]
    ds_read_b128 a[4:7], v254 offset:448
    v_fma_f32 v253, v243, s60, v241
    v_mfma_f32_16x16x32_bf16 v[160:163], a[120:123], a[224:227], v[160:163]
    v_fma_f32 v240, v242, -s60, v240
    v_fma_f32 v241, v243, -s60, v241
    v_mfma_f32_16x16x32_bf16 v[160:163], a[124:127], a[228:231], v[160:163]
    buffer_load_dwordx4 a[116:119], v1, s[20:23], s68 offen offset:3072 sc1
    v_mfma_f32_16x16x32_bf16 v[164:167], a[120:123], a[228:231], v[164:167]
    s_add_u32 s68, s68, 4096
    v_fma_f32 v248, v110, -s66, v248
    v_mfma_f32_16x16x32_bf16 v[164:167], a[124:127], a[232:235], v[164:167]
    ds_read_b128 a[8:11], v254 offset:800
    v_fma_f32 v249, v111, -s66, v249
    v_mfma_f32_16x16x32_bf16 v[168:171], a[120:123], a[232:235], v[168:171]
    s_waitcnt vmcnt(14)
    ds_read_b128 a[12:15], v254 offset:1152
    v_mfma_f32_16x16x32_bf16 v[168:171], a[124:127], a[236:239], v[168:171]
    v_fma_f32 v242, v246, s64, v244
    v_fma_f32 v243, v247, s64, v245
    v_mfma_f32_16x16x32_bf16 v[28:31], a[132:135], a[236:239], v[28:31]
    buffer_load_dwordx4 a[120:123], v1, s[20:23], s68 offen offset:0 sc1
    v_mfma_f32_16x16x32_bf16 v[28:31], a[128:131], a[232:235], v[28:31]
    v_fma_f32 v244, v246, -s64, v244
    v_fma_f32 v245, v247, -s64, v245
    v_mfma_f32_16x16x32_bf16 v[24:27], a[132:135], a[232:235], v[24:27]
    ds_read_b128 a[16:19], v254 offset:1504
    v_fma_f32 v250, v70, -s66, v250
    v_mfma_f32_16x16x32_bf16 v[24:27], a[128:131], a[228:231], v[24:27]
    ds_read_b128 a[20:23], v254 offset:1856
    v_fma_f32 v251, v71, -s66, v251
    v_mfma_f32_16x16x32_bf16 v[20:23], a[132:135], a[228:231], v[20:23]
    v_cvt_pk_bf16_f32 v219, v252, v253
    v_cvt_pk_bf16_f32 v223, v240, v241
    v_mfma_f32_16x16x32_bf16 v[20:23], a[128:131], a[224:227], v[20:23]
    buffer_load_dwordx4 a[124:127], v1, s[20:23], s68 offen offset:1024 sc1
    v_mfma_f32_16x16x32_bf16 v[16:19], a[132:135], a[224:227], v[16:19]
    v_cvt_pk_bf16_f32 v227, v248, v249
    v_cvt_pk_bf16_f32 v231, v242, v243
    v_mfma_f32_16x16x32_bf16 v[16:19], a[128:131], a[220:223], v[16:19]
    v_cvt_pk_bf16_f32 v235, v244, v245
    v_cvt_pk_bf16_f32 v239, v250, v251
    v_mfma_f32_16x16x32_bf16 v[172:175], a[132:135], a[220:223], v[172:175]
    s_waitcnt vmcnt(14)
    v_mfma_f32_16x16x32_bf16 v[172:175], a[128:131], a[216:219], v[172:175]
    ds_write_b128 v2, v[216:219] offset:2464
    v_mfma_f32_16x16x32_bf16 v[32:35], a[136:139], a[216:219], v[32:35]
    buffer_load_dwordx4 a[128:131], v1, s[20:23], s68 offen offset:2048 sc1
    v_mfma_f32_16x16x32_bf16 v[32:35], a[140:143], a[220:223], v[32:35]
    v_mfma_f32_16x16x32_bf16 v[36:39], a[136:139], a[220:223], v[36:39]
    ds_write_b128 v2, v[220:223] offset:8800
    v_mfma_f32_16x16x32_bf16 v[36:39], a[140:143], a[224:227], v[36:39]
    v_mfma_f32_16x16x32_bf16 v[40:43], a[136:139], a[224:227], v[40:43]
    v_mfma_f32_16x16x32_bf16 v[40:43], a[140:143], a[228:231], v[40:43]
    buffer_load_dwordx4 a[132:135], v1, s[20:23], s68 offen offset:3072 sc1
    v_mfma_f32_16x16x32_bf16 v[44:47], a[136:139], a[228:231], v[44:47]
    s_add_u32 s68, s68, 4096
    v_mfma_f32_16x16x32_bf16 v[44:47], a[140:143], a[232:235], v[44:47]
    s_waitcnt lgkmcnt(2)
    v_mfma_f32_16x16x32_bf16 v[48:51], a[136:139], a[232:235], v[48:51]
    s_waitcnt vmcnt(14)
    v_mfma_f32_16x16x32_bf16 v[48:51], a[140:143], a[236:239], v[48:51]
    ds_write_b128 v2, v[224:227] offset:15136
    v_mfma_f32_16x16x32_bf16 v[52:55], a[72:75], a[0:3], v[52:55]
    buffer_load_dwordx4 a[136:139], v1, s[20:23], s68 offen offset:0 sc1
    v_mfma_f32_16x16x32_bf16 v[52:55], a[76:79], a[4:7], v[52:55]
    v_mfma_f32_16x16x32_bf16 v[56:59], a[72:75], a[4:7], v[56:59]
    ds_read_b128 a[216:219], v254 offset:6432
    v_mfma_f32_16x16x32_bf16 v[56:59], a[76:79], a[8:11], v[56:59]
    ds_read_b128 a[220:223], v254 offset:6784
    v_mfma_f32_16x16x32_bf16 v[60:63], a[72:75], a[8:11], v[60:63]
    ds_write_b128 v3, v[228:231] offset:2112
    v_mfma_f32_16x16x32_bf16 v[60:63], a[76:79], a[12:15], v[60:63]
    buffer_load_dwordx4 a[140:143], v1, s[20:23], s68 offen offset:1024 sc1
    v_mfma_f32_16x16x32_bf16 v[176:179], a[72:75], a[12:15], v[176:179]
    v_mfma_f32_16x16x32_bf16 v[176:179], a[76:79], a[16:19], v[176:179]
    ds_read_b128 a[224:227], v254 offset:7136
    v_mfma_f32_16x16x32_bf16 v[180:183], a[72:75], a[16:19], v[180:183]
    s_waitcnt vmcnt(14)
    ds_read_b128 a[228:231], v254 offset:7488
    v_mfma_f32_16x16x32_bf16 v[180:183], a[76:79], a[20:23], v[180:183]
    ds_write_b128 v3, v[232:235] offset:8448
    v_mfma_f32_16x16x32_bf16 v[200:203], a[84:87], a[20:23], v[200:203]
    buffer_load_dwordx4 a[72:75], v1, s[20:23], s68 offen offset:2048 sc1
    v_mfma_f32_16x16x32_bf16 v[200:203], a[80:83], a[16:19], v[200:203]
    v_mfma_f32_16x16x32_bf16 v[196:199], a[84:87], a[16:19], v[196:199]
    ds_read_b128 a[232:235], v254 offset:7840
    v_mfma_f32_16x16x32_bf16 v[196:199], a[80:83], a[12:15], v[196:199]
    ds_read_b128 a[236:239], v254 offset:8192
    v_mfma_f32_16x16x32_bf16 v[192:195], a[84:87], a[12:15], v[192:195]
    ds_write_b128 v3, v[236:239] offset:14784
    v_mfma_f32_16x16x32_bf16 v[192:195], a[80:83], a[8:11], v[192:195]
    buffer_load_dwordx4 a[76:79], v1, s[20:23], s68 offen offset:3072 sc1
    v_mfma_f32_16x16x32_bf16 v[188:191], a[84:87], a[8:11], v[188:191]
    s_add_u32 s68, s68, 4096
    v_fma_f32 v240, v128, -s58, v144
    v_mfma_f32_16x16x32_bf16 v[188:191], a[80:83], a[4:7], v[188:191]
    v_fma_f32 v241, v129, -s58, v145
    v_fma_f32 v242, v120, -s58, v136
    v_mfma_f32_16x16x32_bf16 v[184:187], a[84:87], a[4:7], v[184:187]
    s_waitcnt vmcnt(14)
    v_fma_f32 v243, v121, -s58, v137
    v_mfma_f32_16x16x32_bf16 v[184:187], a[80:83], a[0:3], v[184:187]
    v_fma_f32 v244, v128, -s62, v144
    v_fma_f32 v245, v129, -s62, v145
    v_mfma_f32_16x16x32_bf16 v[204:207], a[88:91], a[0:3], v[204:207]
    buffer_load_dwordx4 a[80:83], v1, s[20:23], s68 offen offset:0 sc1
    v_mfma_f32_16x16x32_bf16 v[204:207], a[92:95], a[4:7], v[204:207]
    v_fma_f32 v246, v120, -s62, v136
    v_fma_f32 v247, v121, -s62, v137
    v_mfma_f32_16x16x32_bf16 v[208:211], a[88:91], a[4:7], v[208:211]
    v_add_f32 v248, v112, v144
    v_add_f32 v249, v113, v145
    v_mfma_f32_16x16x32_bf16 v[208:211], a[92:95], a[8:11], v[208:211]
    v_add_f32 v250, v120, v152
    v_add_f32 v251, v121, v153
    v_mfma_f32_16x16x32_bf16 v[212:215], a[88:91], a[8:11], v[212:215]
    v_fma_f32 v252, v242, s60, v240
    v_fma_f32 v253, v243, s60, v241
    v_mfma_f32_16x16x32_bf16 v[212:215], a[92:95], a[12:15], v[212:215]
    buffer_load_dwordx4 a[84:87], v1, s[20:23], s68 offen offset:1024 sc1
    v_mfma_f32_16x16x32_bf16 a[248:251], a[88:91], a[12:15], a[248:251]
    v_fma_f32 v240, v242, -s60, v240
    v_fma_f32 v241, v243, -s60, v241
    v_mfma_f32_16x16x32_bf16 a[248:251], a[92:95], a[16:19], a[248:251]
    s_waitcnt lgkmcnt(1)
    v_fma_f32 v248, v128, -s66, v248
    v_mfma_f32_16x16x32_bf16 a[252:255], a[88:91], a[16:19], a[252:255]
    s_waitcnt vmcnt(14)
    v_fma_f32 v249, v129, -s66, v249
    v_mfma_f32_16x16x32_bf16 a[252:255], a[92:95], a[20:23], a[252:255]
    v_fma_f32 v242, v246, s64, v244
    v_fma_f32 v243, v247, s64, v245
    v_mfma_f32_16x16x32_bf16 v[8:11], a[96:99], a[216:219], v[8:11]
    buffer_load_dwordx4 a[88:91], v1, s[20:23], s68 offen offset:2048 sc1
    v_mfma_f32_16x16x32_bf16 v[8:11], a[100:103], a[220:223], v[8:11]
    v_fma_f32 v244, v246, -s64, v244
    v_fma_f32 v245, v247, -s64, v245
    v_mfma_f32_16x16x32_bf16 v[12:15], a[96:99], a[220:223], v[12:15]
    v_fma_f32 v250, v136, -s66, v250
    v_fma_f32 v251, v137, -s66, v251
    v_mfma_f32_16x16x32_bf16 v[12:15], a[100:103], a[224:227], v[12:15]
    v_cvt_pk_bf16_f32 v216, v252, v253
    v_cvt_pk_bf16_f32 v220, v240, v241
    v_mfma_f32_16x16x32_bf16 v[160:163], a[96:99], a[224:227], v[160:163]
    v_cvt_pk_bf16_f32 v224, v248, v249
    v_cvt_pk_bf16_f32 v228, v242, v243
    v_mfma_f32_16x16x32_bf16 v[160:163], a[100:103], a[228:231], v[160:163]
    buffer_load_dwordx4 a[92:95], v1, s[20:23], s68 offen offset:3072 sc1
    v_mfma_f32_16x16x32_bf16 v[164:167], a[96:99], a[228:231], v[164:167]
    s_add_u32 s68, s68, 4096
    s_waitcnt lgkmcnt(0)
    s_barrier
    v_mfma_f32_16x16x32_bf16 v[164:167], a[100:103], a[232:235], v[164:167]
    ds_read_b128 a[0:3], v254 offset:2112
    v_cvt_pk_bf16_f32 v232, v244, v245
    v_mfma_f32_16x16x32_bf16 v[168:171], a[96:99], a[232:235], v[168:171]
    s_waitcnt vmcnt(14)
    ds_read_b128 a[4:7], v254 offset:2464
    v_mfma_f32_16x16x32_bf16 v[168:171], a[100:103], a[236:239], v[168:171]
    v_cvt_pk_bf16_f32 v236, v250, v251
    v_fma_f32 v240, v130, -s58, v146
    v_mfma_f32_16x16x32_bf16 v[28:31], a[108:111], a[236:239], v[28:31]
    buffer_load_dwordx4 a[96:99], v1, s[20:23], s68 offen offset:0 sc1
    v_mfma_f32_16x16x32_bf16 v[28:31], a[104:107], a[232:235], v[28:31]
    v_fma_f32 v241, v131, -s58, v147
    v_fma_f32 v242, v122, -s58, v138
    v_mfma_f32_16x16x32_bf16 v[24:27], a[108:111], a[232:235], v[24:27]
    ds_read_b128 a[8:11], v254 offset:2816
    v_fma_f32 v243, v123, -s58, v139
    v_mfma_f32_16x16x32_bf16 v[24:27], a[104:107], a[228:231], v[24:27]
    ds_read_b128 a[12:15], v254 offset:3168
    v_fma_f32 v244, v130, -s62, v146
    v_mfma_f32_16x16x32_bf16 v[20:23], a[108:111], a[228:231], v[20:23]
    v_fma_f32 v245, v131, -s62, v147
    v_fma_f32 v246, v122, -s62, v138
    v_mfma_f32_16x16x32_bf16 v[20:23], a[104:107], a[224:227], v[20:23]
    buffer_load_dwordx4 a[100:103], v1, s[20:23], s68 offen offset:1024 sc1
    v_mfma_f32_16x16x32_bf16 v[16:19], a[108:111], a[224:227], v[16:19]
    v_fma_f32 v247, v123, -s62, v139
    v_add_f32 v248, v114, v146
    v_mfma_f32_16x16x32_bf16 v[16:19], a[104:107], a[220:223], v[16:19]
    ds_read_b128 a[16:19], v254 offset:3520
    v_add_f32 v249, v115, v147
    v_mfma_f32_16x16x32_bf16 v[172:175], a[108:111], a[220:223], v[172:175]
    s_waitcnt vmcnt(14)
    ds_read_b128 a[20:23], v254 offset:3872
    v_mfma_f32_16x16x32_bf16 v[172:175], a[104:107], a[216:219], v[172:175]
    v_add_f32 v250, v122, v154
    v_add_f32 v251, v123, v155
    v_mfma_f32_16x16x32_bf16 v[32:35], a[112:115], a[216:219], v[32:35]
    buffer_load_dwordx4 a[104:107], v1, s[20:23], s68 offen offset:2048 sc1
    v_mfma_f32_16x16x32_bf16 v[32:35], a[116:119], a[220:223], v[32:35]
    v_fma_f32 v252, v242, s60, v240
    v_fma_f32 v253, v243, s60, v241
    v_mfma_f32_16x16x32_bf16 v[36:39], a[112:115], a[220:223], v[36:39]
    v_fma_f32 v240, v242, -s60, v240
    v_fma_f32 v241, v243, -s60, v241
    v_mfma_f32_16x16x32_bf16 v[36:39], a[116:119], a[224:227], v[36:39]
    v_fma_f32 v248, v130, -s66, v248
    v_fma_f32 v249, v131, -s66, v249
    v_mfma_f32_16x16x32_bf16 v[40:43], a[112:115], a[224:227], v[40:43]
    v_fma_f32 v242, v246, s64, v244
    v_fma_f32 v243, v247, s64, v245
    v_mfma_f32_16x16x32_bf16 v[40:43], a[116:119], a[228:231], v[40:43]
    buffer_load_dwordx4 a[108:111], v1, s[20:23], s68 offen offset:3072 sc1
    v_mfma_f32_16x16x32_bf16 v[44:47], a[112:115], a[228:231], v[44:47]
    s_add_u32 s68, s68, 4096
    v_fma_f32 v244, v246, -s64, v244
    v_mfma_f32_16x16x32_bf16 v[44:47], a[116:119], a[232:235], v[44:47]
    s_waitcnt lgkmcnt(0)
    v_fma_f32 v245, v247, -s64, v245
    v_mfma_f32_16x16x32_bf16 v[48:51], a[112:115], a[232:235], v[48:51]
    s_waitcnt vmcnt(14)
    v_fma_f32 v250, v138, -s66, v250
    v_mfma_f32_16x16x32_bf16 v[48:51], a[116:119], a[236:239], v[48:51]
    v_fma_f32 v251, v139, -s66, v251
    v_cvt_pk_bf16_f32 v217, v252, v253
    v_mfma_f32_16x16x32_bf16 v[52:55], a[120:123], a[0:3], v[52:55]
    buffer_load_dwordx4 a[112:115], v1, s[20:23], s68 offen offset:0 sc1
    v_mfma_f32_16x16x32_bf16 v[52:55], a[124:127], a[4:7], v[52:55]
    v_cvt_pk_bf16_f32 v221, v240, v241
    v_cvt_pk_bf16_f32 v225, v248, v249
    v_mfma_f32_16x16x32_bf16 v[56:59], a[120:123], a[4:7], v[56:59]
    ds_read_b128 a[216:219], v254 offset:8448
    v_cvt_pk_bf16_f32 v229, v242, v243
    v_mfma_f32_16x16x32_bf16 v[56:59], a[124:127], a[8:11], v[56:59]
    ds_read_b128 a[220:223], v254 offset:8800
    v_cvt_pk_bf16_f32 v233, v244, v245
    v_mfma_f32_16x16x32_bf16 v[60:63], a[120:123], a[8:11], v[60:63]
    v_cvt_pk_bf16_f32 v237, v250, v251
    v_fma_f32 v240, v132, -s58, v148
    v_mfma_f32_16x16x32_bf16 v[60:63], a[124:127], a[12:15], v[60:63]
    buffer_load_dwordx4 a[116:119], v1, s[20:23], s68 offen offset:1024 sc1
    v_mfma_f32_16x16x32_bf16 v[176:179], a[120:123], a[12:15], v[176:179]
    v_fma_f32 v241, v133, -s58, v149
    v_fma_f32 v242, v124, -s58, v140
    v_mfma_f32_16x16x32_bf16 v[176:179], a[124:127], a[16:19], v[176:179]
    ds_read_b128 a[224:227], v254 offset:9152
    v_fma_f32 v243, v125, -s58, v141
    v_mfma_f32_16x16x32_bf16 v[180:183], a[120:123], a[16:19], v[180:183]
    s_waitcnt vmcnt(14)
    ds_read_b128 a[228:231], v254 offset:9504
    v_mfma_f32_16x16x32_bf16 v[180:183], a[124:127], a[20:23], v[180:183]
    v_fma_f32 v244, v132, -s62, v148
    v_fma_f32 v245, v133, -s62, v149
    v_mfma_f32_16x16x32_bf16 v[200:203], a[132:135], a[20:23], v[200:203]
    buffer_load_dwordx4 a[120:123], v1, s[20:23], s68 offen offset:2048 sc1
    v_mfma_f32_16x16x32_bf16 v[200:203], a[128:131], a[16:19], v[200:203]
    v_fma_f32 v246, v124, -s62, v140
    v_fma_f32 v247, v125, -s62, v141
    v_mfma_f32_16x16x32_bf16 v[196:199], a[132:135], a[16:19], v[196:199]
    ds_read_b128 a[232:235], v254 offset:9856
    v_add_f32 v248, v116, v148
    v_mfma_f32_16x16x32_bf16 v[196:199], a[128:131], a[12:15], v[196:199]
    ds_read_b128 a[236:239], v254 offset:10208
    v_add_f32 v249, v117, v149
    v_mfma_f32_16x16x32_bf16 v[192:195], a[132:135], a[12:15], v[192:195]
    v_add_f32 v250, v124, v156
    v_add_f32 v251, v125, v157
    v_mfma_f32_16x16x32_bf16 v[192:195], a[128:131], a[8:11], v[192:195]
    buffer_load_dwordx4 a[124:127], v1, s[20:23], s68 offen offset:3072 sc1
    v_mfma_f32_16x16x32_bf16 v[188:191], a[132:135], a[8:11], v[188:191]
    s_add_u32 s68, s68, 4096
    v_fma_f32 v252, v242, s60, v240
    v_mfma_f32_16x16x32_bf16 v[188:191], a[128:131], a[4:7], v[188:191]
    v_fma_f32 v253, v243, s60, v241
    v_fma_f32 v240, v242, -s60, v240
    v_mfma_f32_16x16x32_bf16 v[184:187], a[132:135], a[4:7], v[184:187]
    s_waitcnt vmcnt(14)
    v_fma_f32 v241, v243, -s60, v241
    v_mfma_f32_16x16x32_bf16 v[184:187], a[128:131], a[0:3], v[184:187]
    v_fma_f32 v248, v132, -s66, v248
    v_fma_f32 v249, v133, -s66, v249
    v_mfma_f32_16x16x32_bf16 v[204:207], a[136:139], a[0:3], v[204:207]
    buffer_load_dwordx4 a[128:131], v1, s[20:23], s68 offen offset:0 sc1
    v_mfma_f32_16x16x32_bf16 v[204:207], a[140:143], a[4:7], v[204:207]
    v_fma_f32 v242, v246, s64, v244
    v_fma_f32 v243, v247, s64, v245
    v_mfma_f32_16x16x32_bf16 v[208:211], a[136:139], a[4:7], v[208:211]
    v_fma_f32 v244, v246, -s64, v244
    v_fma_f32 v245, v247, -s64, v245
    v_mfma_f32_16x16x32_bf16 v[208:211], a[140:143], a[8:11], v[208:211]
    v_fma_f32 v250, v140, -s66, v250
    v_fma_f32 v251, v141, -s66, v251
    v_mfma_f32_16x16x32_bf16 v[212:215], a[136:139], a[8:11], v[212:215]
    v_cvt_pk_bf16_f32 v218, v252, v253
    v_cvt_pk_bf16_f32 v222, v240, v241
    v_mfma_f32_16x16x32_bf16 v[212:215], a[140:143], a[12:15], v[212:215]
    buffer_load_dwordx4 a[132:135], v1, s[20:23], s68 offen offset:1024 sc1
    v_mfma_f32_16x16x32_bf16 a[248:251], a[136:139], a[12:15], a[248:251]
    v_cvt_pk_bf16_f32 v226, v248, v249
    v_cvt_pk_bf16_f32 v230, v242, v243
    v_mfma_f32_16x16x32_bf16 a[248:251], a[140:143], a[16:19], a[248:251]
    s_waitcnt lgkmcnt(0)
    v_cvt_pk_bf16_f32 v234, v244, v245
    v_mfma_f32_16x16x32_bf16 a[252:255], a[136:139], a[16:19], a[252:255]
    s_waitcnt vmcnt(14)
    v_cvt_pk_bf16_f32 v238, v250, v251
    v_mfma_f32_16x16x32_bf16 a[252:255], a[140:143], a[20:23], a[252:255]
    v_fma_f32 v240, v134, -s58, v150
    v_fma_f32 v241, v135, -s58, v151
    v_mfma_f32_16x16x32_bf16 v[8:11], a[72:75], a[216:219], v[8:11]
    buffer_load_dwordx4 a[136:139], v1, s[20:23], s68 offen offset:2048 sc1
    v_mfma_f32_16x16x32_bf16 v[8:11], a[76:79], a[220:223], v[8:11]
    v_fma_f32 v242, v126, -s58, v142
    v_fma_f32 v243, v127, -s58, v143
    v_mfma_f32_16x16x32_bf16 v[12:15], a[72:75], a[220:223], v[12:15]
    ds_read_b128 a[0:3], v254 offset:2128
    v_fma_f32 v244, v134, -s62, v150
    v_mfma_f32_16x16x32_bf16 v[12:15], a[76:79], a[224:227], v[12:15]
    ds_read_b128 a[4:7], v254 offset:2480
    v_fma_f32 v245, v135, -s62, v151
    v_mfma_f32_16x16x32_bf16 v[160:163], a[72:75], a[224:227], v[160:163]
    v_fma_f32 v246, v126, -s62, v142
    v_fma_f32 v247, v127, -s62, v143
    v_mfma_f32_16x16x32_bf16 v[160:163], a[76:79], a[228:231], v[160:163]
    buffer_load_dwordx4 a[140:143], v1, s[20:23], s68 offen offset:3072 sc1
    v_mfma_f32_16x16x32_bf16 v[164:167], a[72:75], a[228:231], v[164:167]
    s_add_u32 s68, s68, 4096
    v_add_f32 v248, v118, v150
    v_mfma_f32_16x16x32_bf16 v[164:167], a[76:79], a[232:235], v[164:167]
    ds_read_b128 a[8:11], v254 offset:2832
    v_add_f32 v249, v119, v151
    v_mfma_f32_16x16x32_bf16 v[168:171], a[72:75], a[232:235], v[168:171]
    s_waitcnt vmcnt(14)
    ds_read_b128 a[12:15], v254 offset:3184
    v_mfma_f32_16x16x32_bf16 v[168:171], a[76:79], a[236:239], v[168:171]
    v_add_f32 v250, v126, v158
    v_add_f32 v251, v127, v159
    v_mfma_f32_16x16x32_bf16 v[28:31], a[84:87], a[236:239], v[28:31]
    buffer_load_dwordx4 a[72:75], v1, s[20:23], s68 offen offset:0 sc1
    v_mfma_f32_16x16x32_bf16 v[28:31], a[80:83], a[232:235], v[28:31]
    v_fma_f32 v252, v242, s60, v240
    v_fma_f32 v253, v243, s60, v241
    v_mfma_f32_16x16x32_bf16 v[24:27], a[84:87], a[232:235], v[24:27]
    ds_read_b128 a[16:19], v254 offset:3536
    v_fma_f32 v240, v242, -s60, v240
    v_mfma_f32_16x16x32_bf16 v[24:27], a[80:83], a[228:231], v[24:27]
    ds_read_b128 a[20:23], v254 offset:3888
    v_fma_f32 v241, v243, -s60, v241
    v_mfma_f32_16x16x32_bf16 v[20:23], a[84:87], a[228:231], v[20:23]
    v_fma_f32 v248, v134, -s66, v248
    v_fma_f32 v249, v135, -s66, v249
    v_mfma_f32_16x16x32_bf16 v[20:23], a[80:83], a[224:227], v[20:23]
    buffer_load_dwordx4 a[76:79], v1, s[20:23], s68 offen offset:1024 sc1
    v_mfma_f32_16x16x32_bf16 v[16:19], a[84:87], a[224:227], v[16:19]
    v_fma_f32 v242, v246, s64, v244
    v_fma_f32 v243, v247, s64, v245
    v_mfma_f32_16x16x32_bf16 v[16:19], a[80:83], a[220:223], v[16:19]
    v_fma_f32 v244, v246, -s64, v244
    v_fma_f32 v245, v247, -s64, v245
    v_mfma_f32_16x16x32_bf16 v[172:175], a[84:87], a[220:223], v[172:175]
    s_waitcnt vmcnt(14)
    v_fma_f32 v250, v142, -s66, v250
    v_mfma_f32_16x16x32_bf16 v[172:175], a[80:83], a[216:219], v[172:175]
    v_fma_f32 v251, v143, -s66, v251
    v_cvt_pk_bf16_f32 v219, v252, v253
    v_mfma_f32_16x16x32_bf16 v[32:35], a[88:91], a[216:219], v[32:35]
    buffer_load_dwordx4 a[80:83], v1, s[20:23], s68 offen offset:2048 sc1
    v_mfma_f32_16x16x32_bf16 v[32:35], a[92:95], a[220:223], v[32:35]
    v_cvt_pk_bf16_f32 v223, v240, v241
    v_cvt_pk_bf16_f32 v227, v248, v249
    v_mfma_f32_16x16x32_bf16 v[36:39], a[88:91], a[220:223], v[36:39]
    v_cvt_pk_bf16_f32 v231, v242, v243
    v_cvt_pk_bf16_f32 v235, v244, v245
    v_mfma_f32_16x16x32_bf16 v[36:39], a[92:95], a[224:227], v[36:39]
    v_cvt_pk_bf16_f32 v239, v250, v251
    v_mfma_f32_16x16x32_bf16 v[40:43], a[88:91], a[224:227], v[40:43]
    v_mfma_f32_16x16x32_bf16 v[40:43], a[92:95], a[228:231], v[40:43]
    buffer_load_dwordx4 a[84:87], v1, s[20:23], s68 offen offset:3072 sc1
    v_mfma_f32_16x16x32_bf16 v[44:47], a[88:91], a[228:231], v[44:47]
    s_add_u32 s68, s68, 4096
    v_mfma_f32_16x16x32_bf16 v[44:47], a[92:95], a[232:235], v[44:47]
    s_waitcnt lgkmcnt(0)
    v_mfma_f32_16x16x32_bf16 v[48:51], a[88:91], a[232:235], v[48:51]
    s_waitcnt vmcnt(14)
    v_mfma_f32_16x16x32_bf16 v[48:51], a[92:95], a[236:239], v[48:51]
    v_mfma_f32_16x16x32_bf16 v[112:115], a[242:245], a[164:167], 0
    v_mfma_f32_16x16x32_bf16 v[112:115], a[48:51], a[144:147], v[112:115]
    ds_write_b128 v2, v[216:219] offset:4224
    v_mfma_f32_16x16x32_bf16 v[112:115], a[52:55], a[148:151], v[112:115]
    v_mfma_f32_16x16x32_bf16 v[112:115], a[56:59], a[152:155], v[112:115]
    v_mfma_f32_16x16x32_bf16 v[116:119], a[240:243], a[164:167], 0
    v_mfma_f32_16x16x32_bf16 v[116:119], a[60:63], a[144:147], v[116:119]
    ds_write_b128 v2, v[220:223] offset:10560
    v_mfma_f32_16x16x32_bf16 v[116:119], a[64:67], a[148:151], v[116:119]
    v_mfma_f32_16x16x32_bf16 v[116:119], a[68:71], a[152:155], v[116:119]
    v_mfma_f32_16x16x32_bf16 v[120:123], a[242:245], a[188:191], 0
    v_mfma_f32_16x16x32_bf16 v[120:123], a[48:51], a[168:171], v[120:123]
    ds_write_b128 v2, v[224:227] offset:16896
    v_mfma_f32_16x16x32_bf16 v[120:123], a[52:55], a[172:175], v[120:123]
    v_mfma_f32_16x16x32_bf16 v[120:123], a[56:59], a[176:179], v[120:123]
    v_mfma_f32_16x16x32_bf16 v[124:127], a[240:243], a[188:191], 0
    v_mfma_f32_16x16x32_bf16 v[124:127], a[60:63], a[168:171], v[124:127]
    ds_write_b128 v3, v[228:231] offset:4576
    v_mfma_f32_16x16x32_bf16 v[124:127], a[64:67], a[172:175], v[124:127]
    v_mfma_f32_16x16x32_bf16 v[124:127], a[68:71], a[176:179], v[124:127]
    v_mfma_f32_16x16x32_bf16 v[128:131], a[242:245], a[212:215], 0
    v_mfma_f32_16x16x32_bf16 v[128:131], a[48:51], a[192:195], v[128:131]
    ds_write_b128 v3, v[232:235] offset:10912
    v_mfma_f32_16x16x32_bf16 v[128:131], a[52:55], a[196:199], v[128:131]
    v_mfma_f32_16x16x32_bf16 v[128:131], a[56:59], a[200:203], v[128:131]
    v_mfma_f32_16x16x32_bf16 v[132:135], a[240:243], a[212:215], 0
    v_mfma_f32_16x16x32_bf16 v[132:135], a[60:63], a[192:195], v[132:135]
    ds_write_b128 v3, v[236:239] offset:17248
    v_mfma_f32_16x16x32_bf16 v[132:135], a[64:67], a[196:199], v[132:135]
    v_mfma_f32_16x16x32_bf16 v[132:135], a[68:71], a[200:203], v[132:135]
    v_mfma_f32_16x16x32_bf16 v[52:55], a[96:99], a[0:3], v[52:55]
    buffer_load_dwordx4 a[88:91], v1, s[20:23], s68 offen offset:0 sc1
    v_mfma_f32_16x16x32_bf16 v[52:55], a[100:103], a[4:7], v[52:55]
    v_mfma_f32_16x16x32_bf16 v[56:59], a[96:99], a[4:7], v[56:59]
    ds_read_b128 a[216:219], v254 offset:8464
    v_mfma_f32_16x16x32_bf16 v[56:59], a[100:103], a[8:11], v[56:59]
    ds_read_b128 a[220:223], v254 offset:8816
    v_mfma_f32_16x16x32_bf16 v[60:63], a[96:99], a[8:11], v[60:63]
    v_mfma_f32_16x16x32_bf16 v[60:63], a[100:103], a[12:15], v[60:63]
    buffer_load_dwordx4 a[92:95], v1, s[20:23], s68 offen offset:1024 sc1
    v_mfma_f32_16x16x32_bf16 v[176:179], a[96:99], a[12:15], v[176:179]
    v_mfma_f32_16x16x32_bf16 v[176:179], a[100:103], a[16:19], v[176:179]
    ds_read_b128 a[224:227], v254 offset:9168
    v_mfma_f32_16x16x32_bf16 v[180:183], a[96:99], a[16:19], v[180:183]
    s_waitcnt vmcnt(14)
    ds_read_b128 a[228:231], v254 offset:9520
    v_mfma_f32_16x16x32_bf16 v[180:183], a[100:103], a[20:23], v[180:183]
    v_fma_f32 v240, v152, -s58, v120
    v_fma_f32 v241, v153, -s58, v121
    v_mfma_f32_16x16x32_bf16 v[200:203], a[108:111], a[20:23], v[200:203]
    buffer_load_dwordx4 a[144:147], v1, s[20:23], s68 offen offset:2048 sc1
    v_mfma_f32_16x16x32_bf16 v[200:203], a[104:107], a[16:19], v[200:203]
    v_fma_f32 v242, v144, -s58, v112
    v_fma_f32 v243, v145, -s58, v113
L_pg4:
    s_cbranch_execz L_pg8
    v_mfma_f32_16x16x32_bf16 v[196:199], a[108:111], a[16:19], v[196:199]
    ds_read_b128 a[232:235], v254 offset:9872
    v_fma_f32 v244, v152, -s62, v120
    v_mfma_f32_16x16x32_bf16 v[196:199], a[104:107], a[12:15], v[196:199]
    ds_read_b128 a[236:239], v254 offset:10224
    v_fma_f32 v245, v153, -s62, v121
    v_mfma_f32_16x16x32_bf16 v[192:195], a[108:111], a[12:15], v[192:195]
    v_fma_f32 v246, v144, -s62, v112
    v_fma_f32 v247, v145, -s62, v113
    v_mfma_f32_16x16x32_bf16 v[192:195], a[104:107], a[8:11], v[192:195]
    buffer_load_dwordx4 a[148:151], v1, s[20:23], s68 offen offset:3072 sc1
    v_mfma_f32_16x16x32_bf16 v[188:191], a[108:111], a[8:11], v[188:191]
    s_add_u32 s68, s68, 4096
    v_add_f32 v248, v136, v120
    v_mfma_f32_16x16x32_bf16 v[188:191], a[104:107], a[4:7], v[188:191]
    v_add_f32 v249, v137, v121
    v_add_f32 v250, v144, v128
    v_mfma_f32_16x16x32_bf16 v[184:187], a[108:111], a[4:7], v[184:187]
    s_waitcnt vmcnt(14)
    v_add_f32 v251, v145, v129
    v_mfma_f32_16x16x32_bf16 v[184:187], a[104:107], a[0:3], v[184:187]
    buffer_load_dwordx4 a[152:155], v1, s[20:23], s68 offen offset:0 sc1
    v_mfma_f32_16x16x32_bf16 v[204:207], a[112:115], a[0:3], v[204:207]
    buffer_load_dwordx4 a[156:159], v1, s[20:23], s68 offen offset:1024 sc1
    v_mfma_f32_16x16x32_bf16 v[204:207], a[116:119], a[4:7], v[204:207]
    v_fma_f32 v252, v242, s60, v240
    v_fma_f32 v253, v243, s60, v241
    v_mfma_f32_16x16x32_bf16 v[208:211], a[112:115], a[4:7], v[208:211]
    v_fma_f32 v240, v242, -s60, v240
    v_fma_f32 v241, v243, -s60, v241
    v_mfma_f32_16x16x32_bf16 v[208:211], a[116:119], a[8:11], v[208:211]
    v_fma_f32 v248, v152, -s66, v248
    v_fma_f32 v249, v153, -s66, v249
    v_mfma_f32_16x16x32_bf16 v[212:215], a[112:115], a[8:11], v[212:215]
    v_fma_f32 v242, v246, s64, v244
    v_fma_f32 v243, v247, s64, v245
    v_mfma_f32_16x16x32_bf16 v[212:215], a[116:119], a[12:15], v[212:215]
    buffer_load_dwordx4 a[160:163], v1, s[20:23], s68 offen offset:2048 sc1
    v_mfma_f32_16x16x32_bf16 a[248:251], a[112:115], a[12:15], a[248:251]
    v_fma_f32 v244, v246, -s64, v244
    v_fma_f32 v245, v247, -s64, v245
    v_mfma_f32_16x16x32_bf16 a[248:251], a[116:119], a[16:19], a[248:251]
    s_waitcnt lgkmcnt(0)
    v_fma_f32 v250, v112, -s66, v250
    v_mfma_f32_16x16x32_bf16 a[252:255], a[112:115], a[16:19], a[252:255]
    s_waitcnt vmcnt(15)
    v_fma_f32 v251, v113, -s66, v251
    v_mfma_f32_16x16x32_bf16 a[252:255], a[116:119], a[20:23], a[252:255]
    v_cvt_pk_bf16_f32 v216, v252, v253
    v_cvt_pk_bf16_f32 v220, v240, v241
    v_mfma_f32_16x16x32_bf16 v[8:11], a[120:123], a[216:219], v[8:11]
    buffer_load_dwordx4 a[164:167], v1, s[20:23], s68 offen offset:3072 sc1
    v_mfma_f32_16x16x32_bf16 v[8:11], a[124:127], a[220:223], v[8:11]
    s_add_u32 s68, s68, 4096
    v_cvt_pk_bf16_f32 v224, v248, v249
    v_mfma_f32_16x16x32_bf16 v[12:15], a[120:123], a[220:223], v[12:15]
    ds_read_b128 a[0:3], v254 offset:2144
    v_cvt_pk_bf16_f32 v228, v242, v243
    v_mfma_f32_16x16x32_bf16 v[12:15], a[124:127], a[224:227], v[12:15]
    ds_read_b128 a[4:7], v254 offset:2496
    v_cvt_pk_bf16_f32 v232, v244, v245
    v_mfma_f32_16x16x32_bf16 v[160:163], a[120:123], a[224:227], v[160:163]
    v_cvt_pk_bf16_f32 v236, v250, v251
    v_fma_f32 v240, v154, -s58, v122
    v_mfma_f32_16x16x32_bf16 v[160:163], a[124:127], a[228:231], v[160:163]
    buffer_load_dwordx4 a[168:171], v1, s[20:23], s68 offen offset:0 sc1
    v_mfma_f32_16x16x32_bf16 v[164:167], a[120:123], a[228:231], v[164:167]
    v_fma_f32 v241, v155, -s58, v123
    v_fma_f32 v242, v146, -s58, v114
    v_mfma_f32_16x16x32_bf16 v[164:167], a[124:127], a[232:235], v[164:167]
    ds_read_b128 a[8:11], v254 offset:2848
    v_fma_f32 v243, v147, -s58, v115
    v_mfma_f32_16x16x32_bf16 v[168:171], a[120:123], a[232:235], v[168:171]
    s_waitcnt vmcnt(15)
    ds_read_b128 a[12:15], v254 offset:3200
    v_mfma_f32_16x16x32_bf16 v[168:171], a[124:127], a[236:239], v[168:171]
    v_fma_f32 v244, v154, -s62, v122
    v_fma_f32 v245, v155, -s62, v123
    v_mfma_f32_16x16x32_bf16 v[28:31], a[132:135], a[236:239], v[28:31]
    buffer_load_dwordx4 a[172:175], v1, s[20:23], s68 offen offset:1024 sc1
    v_mfma_f32_16x16x32_bf16 v[28:31], a[128:131], a[232:235], v[28:31]
    v_fma_f32 v246, v146, -s62, v114
    v_fma_f32 v247, v147, -s62, v115
    v_mfma_f32_16x16x32_bf16 v[24:27], a[132:135], a[232:235], v[24:27]
    ds_read_b128 a[16:19], v254 offset:3552
    v_add_f32 v248, v138, v122
    v_mfma_f32_16x16x32_bf16 v[24:27], a[128:131], a[228:231], v[24:27]
    ds_read_b128 a[20:23], v254 offset:3904
    v_add_f32 v249, v139, v123
    v_mfma_f32_16x16x32_bf16 v[20:23], a[132:135], a[228:231], v[20:23]
    v_add_f32 v250, v146, v130
    v_add_f32 v251, v147, v131
    v_mfma_f32_16x16x32_bf16 v[20:23], a[128:131], a[224:227], v[20:23]
    buffer_load_dwordx4 a[176:179], v1, s[20:23], s68 offen offset:2048 sc1
    v_mfma_f32_16x16x32_bf16 v[16:19], a[132:135], a[224:227], v[16:19]
    v_fma_f32 v252, v242, s60, v240
    v_fma_f32 v253, v243, s60, v241
    v_mfma_f32_16x16x32_bf16 v[16:19], a[128:131], a[220:223], v[16:19]
    v_fma_f32 v240, v242, -s60, v240
    v_fma_f32 v241, v243, -s60, v241
    v_mfma_f32_16x16x32_bf16 v[172:175], a[132:135], a[220:223], v[172:175]
    s_waitcnt vmcnt(15)
    v_fma_f32 v248, v154, -s66, v248
    v_mfma_f32_16x16x32_bf16 v[172:175], a[128:131], a[216:219], v[172:175]
    v_fma_f32 v249, v155, -s66, v249
    v_fma_f32 v242, v246, s64, v244
    v_mfma_f32_16x16x32_bf16 v[32:35], a[136:139], a[216:219], v[32:35]
    buffer_load_dwordx4 a[180:183], v1, s[20:23], s68 offen offset:3072 sc1
    v_mfma_f32_16x16x32_bf16 v[32:35], a[140:143], a[220:223], v[32:35]
    s_add_u32 s68, s68, 4096
    v_fma_f32 v243, v247, s64, v245
    v_mfma_f32_16x16x32_bf16 v[36:39], a[136:139], a[220:223], v[36:39]
    v_fma_f32 v244, v246, -s64, v244
    v_fma_f32 v245, v247, -s64, v245
    v_mfma_f32_16x16x32_bf16 v[36:39], a[140:143], a[224:227], v[36:39]
    v_fma_f32 v250, v114, -s66, v250
    v_fma_f32 v251, v115, -s66, v251
    v_mfma_f32_16x16x32_bf16 v[40:43], a[136:139], a[224:227], v[40:43]
    v_cvt_pk_bf16_f32 v217, v252, v253
    v_cvt_pk_bf16_f32 v221, v240, v241
    v_mfma_f32_16x16x32_bf16 v[40:43], a[140:143], a[228:231], v[40:43]
    buffer_load_dwordx4 a[184:187], v1, s[20:23], s68 offen offset:0 sc1
    v_mfma_f32_16x16x32_bf16 v[44:47], a[136:139], a[228:231], v[44:47]
    v_cvt_pk_bf16_f32 v225, v248, v249
    v_cvt_pk_bf16_f32 v229, v242, v243
    v_mfma_f32_16x16x32_bf16 v[44:47], a[140:143], a[232:235], v[44:47]
    s_waitcnt lgkmcnt(0)
    v_cvt_pk_bf16_f32 v233, v244, v245
    v_mfma_f32_16x16x32_bf16 v[48:51], a[136:139], a[232:235], v[48:51]
    s_waitcnt vmcnt(15)
    v_cvt_pk_bf16_f32 v237, v250, v251
    v_mfma_f32_16x16x32_bf16 v[48:51], a[140:143], a[236:239], v[48:51]
    v_fma_f32 v240, v156, -s58, v124
    v_fma_f32 v241, v157, -s58, v125
    v_mfma_f32_16x16x32_bf16 v[52:55], a[72:75], a[0:3], v[52:55]
    buffer_load_dwordx4 a[188:191], v1, s[20:23], s68 offen offset:1024 sc1
    v_mfma_f32_16x16x32_bf16 v[52:55], a[76:79], a[4:7], v[52:55]
    v_fma_f32 v242, v148, -s58, v116
    v_fma_f32 v243, v149, -s58, v117
    v_mfma_f32_16x16x32_bf16 v[56:59], a[72:75], a[4:7], v[56:59]
    ds_read_b128 a[216:219], v254 offset:8480
    v_fma_f32 v244, v156, -s62, v124
    v_mfma_f32_16x16x32_bf16 v[56:59], a[76:79], a[8:11], v[56:59]
    ds_read_b128 a[220:223], v254 offset:8832
    v_fma_f32 v245, v157, -s62, v125
    v_mfma_f32_16x16x32_bf16 v[60:63], a[72:75], a[8:11], v[60:63]
    buffer_load_dwordx4 a[192:195], v1, s[20:23], s68 offen offset:2048 sc1
    v_mfma_f32_16x16x32_bf16 v[60:63], a[76:79], a[12:15], v[60:63]
    buffer_load_dwordx4 a[196:199], v1, s[20:23], s68 offen offset:3072 sc1
    v_mfma_f32_16x16x32_bf16 v[176:179], a[72:75], a[12:15], v[176:179]
    s_add_u32 s68, s68, 4096
    v_fma_f32 v246, v148, -s62, v116
    v_mfma_f32_16x16x32_bf16 v[176:179], a[76:79], a[16:19], v[176:179]
    ds_read_b128 a[224:227], v254 offset:9184
    v_fma_f32 v247, v149, -s62, v117
    v_mfma_f32_16x16x32_bf16 v[180:183], a[72:75], a[16:19], v[180:183]
    s_waitcnt vmcnt(16)
    ds_read_b128 a[228:231], v254 offset:9536
    v_mfma_f32_16x16x32_bf16 v[180:183], a[76:79], a[20:23], v[180:183]
    v_add_f32 v248, v140, v124
    v_add_f32 v249, v141, v125
    v_mfma_f32_16x16x32_bf16 v[200:203], a[84:87], a[20:23], v[200:203]
    buffer_load_dwordx4 a[200:203], v1, s[20:23], s68 offen offset:0 sc1
    v_mfma_f32_16x16x32_bf16 v[200:203], a[80:83], a[16:19], v[200:203]
    v_add_f32 v250, v148, v132
    v_add_f32 v251, v149, v133
    v_mfma_f32_16x16x32_bf16 v[196:199], a[84:87], a[16:19], v[196:199]
    ds_read_b128 a[232:235], v254 offset:9888
    v_fma_f32 v252, v242, s60, v240
    v_mfma_f32_16x16x32_bf16 v[196:199], a[80:83], a[12:15], v[196:199]
    ds_read_b128 a[236:239], v254 offset:10240
    v_fma_f32 v253, v243, s60, v241
    v_mfma_f32_16x16x32_bf16 v[192:195], a[84:87], a[12:15], v[192:195]
    v_fma_f32 v240, v242, -s60, v240
    v_fma_f32 v241, v243, -s60, v241
    v_mfma_f32_16x16x32_bf16 v[192:195], a[80:83], a[8:11], v[192:195]
    buffer_load_dwordx4 a[204:207], v1, s[20:23], s68 offen offset:1024 sc1
    v_mfma_f32_16x16x32_bf16 v[188:191], a[84:87], a[8:11], v[188:191]
    v_fma_f32 v248, v156, -s66, v248
    v_fma_f32 v249, v157, -s66, v249
    v_mfma_f32_16x16x32_bf16 v[188:191], a[80:83], a[4:7], v[188:191]
    v_fma_f32 v242, v246, s64, v244
    v_fma_f32 v243, v247, s64, v245
    v_mfma_f32_16x16x32_bf16 v[184:187], a[84:87], a[4:7], v[184:187]
    s_waitcnt vmcnt(16)
    v_fma_f32 v244, v246, -s64, v244
    v_mfma_f32_16x16x32_bf16 v[184:187], a[80:83], a[0:3], v[184:187]
    v_fma_f32 v245, v247, -s64, v245
    v_fma_f32 v250, v116, -s66, v250
    v_mfma_f32_16x16x32_bf16 v[204:207], a[88:91], a[0:3], v[204:207]
    buffer_load_dwordx4 a[208:211], v1, s[20:23], s68 offen offset:2048 sc1
    v_mfma_f32_16x16x32_bf16 v[204:207], a[92:95], a[4:7], v[204:207]
    v_fma_f32 v251, v117, -s66, v251
    v_cvt_pk_bf16_f32 v218, v252, v253
    v_mfma_f32_16x16x32_bf16 v[208:211], a[88:91], a[4:7], v[208:211]
    v_cvt_pk_bf16_f32 v222, v240, v241
    v_cvt_pk_bf16_f32 v226, v248, v249
    v_mfma_f32_16x16x32_bf16 v[208:211], a[92:95], a[8:11], v[208:211]
    v_cvt_pk_bf16_f32 v230, v242, v243
    v_cvt_pk_bf16_f32 v234, v244, v245
    v_mfma_f32_16x16x32_bf16 v[212:215], a[88:91], a[8:11], v[212:215]
    v_cvt_pk_bf16_f32 v238, v250, v251
    v_fma_f32 v240, v158, -s58, v126
    v_mfma_f32_16x16x32_bf16 v[212:215], a[92:95], a[12:15], v[212:215]
    buffer_load_dwordx4 a[212:215], v1, s[20:23], s68 offen offset:3072 sc1
    v_mfma_f32_16x16x32_bf16 a[248:251], a[88:91], a[12:15], a[248:251]
    s_add_u32 s68, s68, 4096
    v_fma_f32 v241, v159, -s58, v127
    v_mfma_f32_16x16x32_bf16 a[248:251], a[92:95], a[16:19], a[248:251]
    s_waitcnt lgkmcnt(0)
    v_fma_f32 v242, v150, -s58, v118
    v_mfma_f32_16x16x32_bf16 a[252:255], a[88:91], a[16:19], a[252:255]
    s_waitcnt vmcnt(16)
    v_fma_f32 v243, v151, -s58, v119
    v_mfma_f32_16x16x32_bf16 a[252:255], a[92:95], a[20:23], a[252:255]
    v_fma_f32 v244, v158, -s62, v126
    v_fma_f32 v245, v159, -s62, v127
    v_mfma_f32_16x16x32_bf16 v[8:11], a[144:147], a[216:219], v[8:11]
    buffer_load_dwordx4 a[96:99], v1, s[20:23], s68 offen offset:0 sc1
    v_mfma_f32_16x16x32_bf16 v[8:11], a[148:151], a[220:223], v[8:11]
    v_fma_f32 v246, v150, -s62, v118
    v_fma_f32 v247, v151, -s62, v119
    v_mfma_f32_16x16x32_bf16 v[12:15], a[144:147], a[220:223], v[12:15]
    ds_read_b128 a[0:3], v254 offset:2160
    v_add_f32 v248, v142, v126
    v_mfma_f32_16x16x32_bf16 v[12:15], a[148:151], a[224:227], v[12:15]
    ds_read_b128 a[4:7], v254 offset:2512
    v_add_f32 v249, v143, v127
    v_mfma_f32_16x16x32_bf16 v[160:163], a[144:147], a[224:227], v[160:163]
    v_add_f32 v250, v150, v134
    v_add_f32 v251, v151, v135
    v_mfma_f32_16x16x32_bf16 v[160:163], a[148:151], a[228:231], v[160:163]
    buffer_load_dwordx4 a[100:103], v1, s[20:23], s68 offen offset:1024 sc1
    v_mfma_f32_16x16x32_bf16 v[164:167], a[144:147], a[228:231], v[164:167]
    v_fma_f32 v252, v242, s60, v240
    v_fma_f32 v253, v243, s60, v241
    v_mfma_f32_16x16x32_bf16 v[164:167], a[148:151], a[232:235], v[164:167]
    ds_read_b128 a[8:11], v254 offset:2864
    v_fma_f32 v240, v242, -s60, v240
    v_mfma_f32_16x16x32_bf16 v[168:171], a[144:147], a[232:235], v[168:171]
    s_waitcnt vmcnt(16)
    ds_read_b128 a[12:15], v254 offset:3216
    v_mfma_f32_16x16x32_bf16 v[168:171], a[148:151], a[236:239], v[168:171]
    v_fma_f32 v241, v243, -s60, v241
    v_fma_f32 v248, v158, -s66, v248
    v_mfma_f32_16x16x32_bf16 v[28:31], a[156:159], a[236:239], v[28:31]
    buffer_load_dwordx4 a[104:107], v1, s[20:23], s68 offen offset:2048 sc1
    v_mfma_f32_16x16x32_bf16 v[28:31], a[152:155], a[232:235], v[28:31]
    v_fma_f32 v249, v159, -s66, v249
    v_fma_f32 v242, v246, s64, v244
    v_mfma_f32_16x16x32_bf16 v[24:27], a[156:159], a[232:235], v[24:27]
    ds_read_b128 a[16:19], v254 offset:3568
    v_fma_f32 v243, v247, s64, v245
    v_mfma_f32_16x16x32_bf16 v[24:27], a[152:155], a[228:231], v[24:27]
    ds_read_b128 a[20:23], v254 offset:3920
    v_fma_f32 v244, v246, -s64, v244
    v_mfma_f32_16x16x32_bf16 v[20:23], a[156:159], a[228:231], v[20:23]
    v_fma_f32 v245, v247, -s64, v245
    v_fma_f32 v250, v118, -s66, v250
    v_mfma_f32_16x16x32_bf16 v[20:23], a[152:155], a[224:227], v[20:23]
    buffer_load_dwordx4 a[108:111], v1, s[20:23], s68 offen offset:3072 sc1
    v_mfma_f32_16x16x32_bf16 v[16:19], a[156:159], a[224:227], v[16:19]
    s_add_u32 s68, s68, 4096
    v_fma_f32 v251, v119, -s66, v251
    v_mfma_f32_16x16x32_bf16 v[16:19], a[152:155], a[220:223], v[16:19]
    v_cvt_pk_bf16_f32 v219, v252, v253
    v_cvt_pk_bf16_f32 v223, v240, v241
    v_mfma_f32_16x16x32_bf16 v[172:175], a[156:159], a[220:223], v[172:175]
    s_waitcnt vmcnt(16)
    v_cvt_pk_bf16_f32 v227, v248, v249
    v_mfma_f32_16x16x32_bf16 v[172:175], a[152:155], a[216:219], v[172:175]
    buffer_load_dwordx4 a[112:115], v1, s[20:23], s68 offen offset:0 sc1
    v_mfma_f32_16x16x32_bf16 v[32:35], a[160:163], a[216:219], v[32:35]
    buffer_load_dwordx4 a[116:119], v1, s[20:23], s68 offen offset:1024 sc1
    v_mfma_f32_16x16x32_bf16 v[32:35], a[164:167], a[220:223], v[32:35]
    v_cvt_pk_bf16_f32 v231, v242, v243
    v_cvt_pk_bf16_f32 v235, v244, v245
    v_mfma_f32_16x16x32_bf16 v[36:39], a[160:163], a[220:223], v[36:39]
    v_cvt_pk_bf16_f32 v239, v250, v251
    v_mfma_f32_16x16x32_bf16 v[36:39], a[164:167], a[224:227], v[36:39]
    ds_write_b128 v2, v[216:219] offset:4576
    v_mfma_f32_16x16x32_bf16 v[40:43], a[160:163], a[224:227], v[40:43]
    v_mfma_f32_16x16x32_bf16 v[40:43], a[164:167], a[228:231], v[40:43]
    buffer_load_dwordx4 a[120:123], v1, s[20:23], s68 offen offset:2048 sc1
    v_mfma_f32_16x16x32_bf16 v[44:47], a[160:163], a[228:231], v[44:47]
    ds_write_b128 v2, v[220:223] offset:10912
    v_mfma_f32_16x16x32_bf16 v[44:47], a[164:167], a[232:235], v[44:47]
    s_waitcnt lgkmcnt(2)
    v_mfma_f32_16x16x32_bf16 v[48:51], a[160:163], a[232:235], v[48:51]
    s_waitcnt vmcnt(17)
    v_mfma_f32_16x16x32_bf16 v[48:51], a[164:167], a[236:239], v[48:51]
    ds_write_b128 v2, v[224:227] offset:17248
    v_mfma_f32_16x16x32_bf16 v[52:55], a[168:171], a[0:3], v[52:55]
    buffer_load_dwordx4 a[124:127], v1, s[20:23], s68 offen offset:3072 sc1
    v_mfma_f32_16x16x32_bf16 v[52:55], a[172:175], a[4:7], v[52:55]
    s_add_u32 s68, s68, 4096
    v_mfma_f32_16x16x32_bf16 v[56:59], a[168:171], a[4:7], v[56:59]
    ds_read_b128 a[216:219], v254 offset:8496
    v_mfma_f32_16x16x32_bf16 v[56:59], a[172:175], a[8:11], v[56:59]
    ds_read_b128 a[220:223], v254 offset:8848
    v_mfma_f32_16x16x32_bf16 v[60:63], a[168:171], a[8:11], v[60:63]
    ds_write_b128 v3, v[228:231] offset:4224
    v_mfma_f32_16x16x32_bf16 v[60:63], a[172:175], a[12:15], v[60:63]
    buffer_load_dwordx4 a[128:131], v1, s[20:23], s68 offen offset:0 sc1
    v_mfma_f32_16x16x32_bf16 v[176:179], a[168:171], a[12:15], v[176:179]
    v_mfma_f32_16x16x32_bf16 v[176:179], a[172:175], a[16:19], v[176:179]
    ds_read_b128 a[224:227], v254 offset:9200
    v_mfma_f32_16x16x32_bf16 v[180:183], a[168:171], a[16:19], v[180:183]
    s_waitcnt vmcnt(17)
    ds_read_b128 a[228:231], v254 offset:9552
    v_mfma_f32_16x16x32_bf16 v[180:183], a[172:175], a[20:23], v[180:183]
    ds_write_b128 v3, v[232:235] offset:10560
    v_mfma_f32_16x16x32_bf16 v[200:203], a[180:183], a[20:23], v[200:203]
    buffer_load_dwordx4 a[132:135], v1, s[20:23], s68 offen offset:1024 sc1
    v_mfma_f32_16x16x32_bf16 v[200:203], a[176:179], a[16:19], v[200:203]
    v_mfma_f32_16x16x32_bf16 v[196:199], a[180:183], a[16:19], v[196:199]
    ds_read_b128 a[232:235], v254 offset:9904
    v_mfma_f32_16x16x32_bf16 v[196:199], a[176:179], a[12:15], v[196:199]
    ds_read_b128 a[236:239], v254 offset:10256
    v_mfma_f32_16x16x32_bf16 v[192:195], a[180:183], a[12:15], v[192:195]
    ds_write_b128 v3, v[236:239] offset:16896
    v_mfma_f32_16x16x32_bf16 v[192:195], a[176:179], a[8:11], v[192:195]
    buffer_load_dwordx4 a[136:139], v1, s[20:23], s68 offen offset:2048 sc1
    v_mfma_f32_16x16x32_bf16 v[188:191], a[180:183], a[8:11], v[188:191]
    v_lshlrev_b32 v157, 2, v0
    s_lshl_b32 s77, s3, 8
    v_mfma_f32_16x16x32_bf16 v[188:191], a[176:179], a[4:7], v[188:191]
    s_add_u32 s69, s77, 133632
    v_add_u32 v152, s69, v157
    v_mfma_f32_16x16x32_bf16 v[184:187], a[180:183], a[4:7], v[184:187]
    s_waitcnt vmcnt(17)
    s_xor_b32 s77, s77, 512
    v_mfma_f32_16x16x32_bf16 v[184:187], a[176:179], a[0:3], v[184:187]
    v_add_u32 v153, s77, v157
    v_lshrrev_b32 v157, 2, v0
    v_mfma_f32_16x16x32_bf16 v[204:207], a[184:187], a[0:3], v[204:207]
    buffer_load_dwordx4 a[140:143], v1, s[20:23], s68 offen offset:3072 sc1
    v_mfma_f32_16x16x32_bf16 v[204:207], a[188:191], a[4:7], v[204:207]
    s_add_u32 s68, s68, 4096
    v_and_b32 v158, 3, v0
    v_mfma_f32_16x16x32_bf16 v[208:211], a[184:187], a[4:7], v[208:211]
    v_lshl_add_u32 v159, v158, 4, v157
    v_lshlrev_b32 v156, 2, v159
    v_mfma_f32_16x16x32_bf16 v[208:211], a[188:191], a[8:11], v[208:211]
    v_mul_u32_u24 v157, 192, v157
    s_lshl_b32 s77, s33, 6
    v_mfma_f32_16x16x32_bf16 v[212:215], a[184:187], a[8:11], v[212:215]
    v_lshl_add_u32 v154, v158, 4, v157
    v_add_u32 v154, s77, v154
    v_mfma_f32_16x16x32_bf16 v[212:215], a[188:191], a[12:15], v[212:215]
    buffer_load_dwordx4 a[72:75], v1, s[20:23], s68 offen offset:0 sc1
    v_mfma_f32_16x16x32_bf16 a[248:251], a[184:187], a[12:15], a[248:251]
    s_lshl_b32 s77, s33, 5
    s_add_u32 s77, s77, 128
    v_mfma_f32_16x16x32_bf16 a[248:251], a[188:191], a[16:19], a[248:251]
    s_waitcnt lgkmcnt(1)
    v_lshl_add_u32 v155, v158, 3, v157
    v_mfma_f32_16x16x32_bf16 a[252:255], a[184:187], a[16:19], a[252:255]
    s_waitcnt vmcnt(17)
    v_add_u32 v155, s77, v155
    v_mfma_f32_16x16x32_bf16 a[252:255], a[188:191], a[20:23], a[252:255]
    v_mfma_f32_16x16x32_bf16 v[8:11], a[192:195], a[216:219], v[8:11]
    buffer_load_dwordx4 a[76:79], v1, s[20:23], s68 offen offset:1024 sc1
    v_mfma_f32_16x16x32_bf16 v[8:11], a[196:199], a[220:223], v[8:11]
    v_mfma_f32_16x16x32_bf16 v[12:15], a[192:195], a[220:223], v[12:15]
    ds_read_b128 a[0:3], v254 offset:2176
    v_mfma_f32_16x16x32_bf16 v[12:15], a[196:199], a[224:227], v[12:15]
    ds_read_b128 a[4:7], v254 offset:2528
    v_mfma_f32_16x16x32_bf16 v[160:163], a[192:195], a[224:227], v[160:163]
    buffer_load_dwordx4 a[80:83], v1, s[20:23], s68 offen offset:2048 sc1
    v_mfma_f32_16x16x32_bf16 v[160:163], a[196:199], a[228:231], v[160:163]
    buffer_load_dwordx4 a[84:87], v1, s[20:23], s68 offen offset:3072 sc1
    v_mfma_f32_16x16x32_bf16 v[164:167], a[192:195], a[228:231], v[164:167]
    s_add_u32 s68, s68, 4096
    v_mfma_f32_16x16x32_bf16 v[164:167], a[196:199], a[232:235], v[164:167]
    ds_read_b128 a[8:11], v254 offset:2880
    v_mfma_f32_16x16x32_bf16 v[168:171], a[192:195], a[232:235], v[168:171]
    s_waitcnt vmcnt(18)
    ds_read_b128 a[12:15], v254 offset:3232
    v_mfma_f32_16x16x32_bf16 v[168:171], a[196:199], a[236:239], v[168:171]
    v_mfma_f32_16x16x32_bf16 v[28:31], a[204:207], a[236:239], v[28:31]
    buffer_load_dwordx4 a[88:91], v1, s[20:23], s68 offen offset:0 sc1
    v_mfma_f32_16x16x32_bf16 v[28:31], a[200:203], a[232:235], v[28:31]
    v_mfma_f32_16x16x32_bf16 v[24:27], a[204:207], a[232:235], v[24:27]
    ds_read_b128 a[16:19], v254 offset:3584
    v_mfma_f32_16x16x32_bf16 v[24:27], a[200:203], a[228:231], v[24:27]
    ds_read_b128 a[20:23], v254 offset:3936
    v_mfma_f32_16x16x32_bf16 v[20:23], a[204:207], a[228:231], v[20:23]
    v_mfma_f32_16x16x32_bf16 v[20:23], a[200:203], a[224:227], v[20:23]
    buffer_load_dwordx4 a[92:95], v1, s[20:23], s68 offen offset:1024 sc1
    v_mfma_f32_16x16x32_bf16 v[16:19], a[204:207], a[224:227], v[16:19]
    v_mfma_f32_16x16x32_bf16 v[16:19], a[200:203], a[220:223], v[16:19]
    v_mfma_f32_16x16x32_bf16 v[172:175], a[204:207], a[220:223], v[172:175]
    s_waitcnt vmcnt(18)
    v_mfma_f32_16x16x32_bf16 v[172:175], a[200:203], a[216:219], v[172:175]
    v_mfma_f32_16x16x32_bf16 v[32:35], a[208:211], a[216:219], v[32:35]
    buffer_load_dwordx4 a[144:147], v1, s[20:23], s68 offen offset:2048 sc1
    v_mfma_f32_16x16x32_bf16 v[32:35], a[212:215], a[220:223], v[32:35]
    v_mfma_f32_16x16x32_bf16 v[36:39], a[208:211], a[220:223], v[36:39]
    v_mfma_f32_16x16x32_bf16 v[36:39], a[212:215], a[224:227], v[36:39]
    v_mfma_f32_16x16x32_bf16 v[40:43], a[208:211], a[224:227], v[40:43]
    v_mfma_f32_16x16x32_bf16 v[40:43], a[212:215], a[228:231], v[40:43]
    buffer_load_dwordx4 a[148:151], v1, s[20:23], s68 offen offset:3072 sc1
    v_mfma_f32_16x16x32_bf16 v[44:47], a[208:211], a[228:231], v[44:47]
    s_add_u32 s68, s68, 4096
    v_mfma_f32_16x16x32_bf16 v[44:47], a[212:215], a[232:235], v[44:47]
    s_waitcnt lgkmcnt(0)
    v_mfma_f32_16x16x32_bf16 v[48:51], a[208:211], a[232:235], v[48:51]
    s_waitcnt vmcnt(18)
    v_mfma_f32_16x16x32_bf16 v[48:51], a[212:215], a[236:239], v[48:51]
    v_mfma_f32_16x16x32_bf16 v[52:55], a[96:99], a[0:3], v[52:55]
    buffer_load_dwordx4 a[152:155], v1, s[20:23], s68 offen offset:0 sc1
    v_mfma_f32_16x16x32_bf16 v[52:55], a[100:103], a[4:7], v[52:55]
    v_mfma_f32_16x16x32_bf16 v[56:59], a[96:99], a[4:7], v[56:59]
    ds_read_b128 a[216:219], v254 offset:8512
    v_mfma_f32_16x16x32_bf16 v[56:59], a[100:103], a[8:11], v[56:59]
    ds_read_b128 a[220:223], v254 offset:8864
    v_mfma_f32_16x16x32_bf16 v[60:63], a[96:99], a[8:11], v[60:63]
    v_mfma_f32_16x16x32_bf16 v[60:63], a[100:103], a[12:15], v[60:63]
    buffer_load_dwordx4 a[156:159], v1, s[20:23], s68 offen offset:1024 sc1
    v_mfma_f32_16x16x32_bf16 v[176:179], a[96:99], a[12:15], v[176:179]
    v_mfma_f32_16x16x32_bf16 v[176:179], a[100:103], a[16:19], v[176:179]
    ds_read_b128 a[224:227], v254 offset:9216
    v_mfma_f32_16x16x32_bf16 v[180:183], a[96:99], a[16:19], v[180:183]
    s_waitcnt vmcnt(18)
    ds_read_b128 a[228:231], v254 offset:9568
    v_mfma_f32_16x16x32_bf16 v[180:183], a[100:103], a[20:23], v[180:183]
    v_mfma_f32_16x16x32_bf16 v[200:203], a[108:111], a[20:23], v[200:203]
    buffer_load_dwordx4 a[160:163], v1, s[20:23], s68 offen offset:2048 sc1
    v_mfma_f32_16x16x32_bf16 v[200:203], a[104:107], a[16:19], v[200:203]
    v_mfma_f32_16x16x32_bf16 v[196:199], a[108:111], a[16:19], v[196:199]
    ds_read_b128 a[232:235], v254 offset:9920
    v_mfma_f32_16x16x32_bf16 v[196:199], a[104:107], a[12:15], v[196:199]
    ds_read_b128 a[236:239], v254 offset:10272
    v_mfma_f32_16x16x32_bf16 v[192:195], a[108:111], a[12:15], v[192:195]
    v_mfma_f32_16x16x32_bf16 v[192:195], a[104:107], a[8:11], v[192:195]
    buffer_load_dwordx4 a[164:167], v1, s[20:23], s68 offen offset:3072 sc1
    v_mfma_f32_16x16x32_bf16 v[188:191], a[108:111], a[8:11], v[188:191]
    s_add_u32 s68, s68, 4096
    v_mfma_f32_16x16x32_bf16 v[188:191], a[104:107], a[4:7], v[188:191]
    v_mfma_f32_16x16x32_bf16 v[184:187], a[108:111], a[4:7], v[184:187]
    s_waitcnt vmcnt(18)
    v_mfma_f32_16x16x32_bf16 v[184:187], a[104:107], a[0:3], v[184:187]
    buffer_load_dwordx4 a[168:171], v1, s[20:23], s68 offen offset:0 sc1
    v_mfma_f32_16x16x32_bf16 v[204:207], a[112:115], a[0:3], v[204:207]
    buffer_load_dwordx4 a[172:175], v1, s[20:23], s68 offen offset:1024 sc1
    v_mfma_f32_16x16x32_bf16 v[204:207], a[116:119], a[4:7], v[204:207]
    v_mfma_f32_16x16x32_bf16 v[208:211], a[112:115], a[4:7], v[208:211]
    v_mfma_f32_16x16x32_bf16 v[208:211], a[116:119], a[8:11], v[208:211]
    v_mfma_f32_16x16x32_bf16 v[212:215], a[112:115], a[8:11], v[212:215]
    v_mfma_f32_16x16x32_bf16 v[212:215], a[116:119], a[12:15], v[212:215]
    buffer_load_dwordx4 a[176:179], v1, s[20:23], s68 offen offset:2048 sc1
    v_mfma_f32_16x16x32_bf16 a[248:251], a[112:115], a[12:15], a[248:251]
    v_mfma_f32_16x16x32_bf16 a[248:251], a[116:119], a[16:19], a[248:251]
    s_waitcnt lgkmcnt(0)
    v_mfma_f32_16x16x32_bf16 a[252:255], a[112:115], a[16:19], a[252:255]
    s_waitcnt vmcnt(19)
    v_mfma_f32_16x16x32_bf16 a[252:255], a[116:119], a[20:23], a[252:255]
    v_mfma_f32_16x16x32_bf16 v[8:11], a[120:123], a[216:219], v[8:11]
    buffer_load_dwordx4 a[180:183], v1, s[20:23], s68 offen offset:3072 sc1
    v_mfma_f32_16x16x32_bf16 v[8:11], a[124:127], a[220:223], v[8:11]
    s_add_u32 s68, s68, 4096
    v_mfma_f32_16x16x32_bf16 v[12:15], a[120:123], a[220:223], v[12:15]
    ds_read_b128 a[0:3], v254 offset:2192
    v_mfma_f32_16x16x32_bf16 v[12:15], a[124:127], a[224:227], v[12:15]
    ds_read_b128 a[4:7], v254 offset:2544
    v_mfma_f32_16x16x32_bf16 v[160:163], a[120:123], a[224:227], v[160:163]
    v_mfma_f32_16x16x32_bf16 v[160:163], a[124:127], a[228:231], v[160:163]
    buffer_load_dwordx4 a[184:187], v1, s[20:23], s68 offen offset:0 sc1
    v_mfma_f32_16x16x32_bf16 v[164:167], a[120:123], a[228:231], v[164:167]
    v_mfma_f32_16x16x32_bf16 v[164:167], a[124:127], a[232:235], v[164:167]
    ds_read_b128 a[8:11], v254 offset:2896
    v_mfma_f32_16x16x32_bf16 v[168:171], a[120:123], a[232:235], v[168:171]
    s_waitcnt vmcnt(19)
    ds_read_b128 a[12:15], v254 offset:3248
    v_mfma_f32_16x16x32_bf16 v[168:171], a[124:127], a[236:239], v[168:171]
    v_mfma_f32_16x16x32_bf16 v[28:31], a[132:135], a[236:239], v[28:31]
    buffer_load_dwordx4 a[188:191], v1, s[20:23], s68 offen offset:1024 sc1
    v_mfma_f32_16x16x32_bf16 v[28:31], a[128:131], a[232:235], v[28:31]
    v_mfma_f32_16x16x32_bf16 v[24:27], a[132:135], a[232:235], v[24:27]
    ds_read_b128 a[16:19], v254 offset:3600
    v_mfma_f32_16x16x32_bf16 v[24:27], a[128:131], a[228:231], v[24:27]
    ds_read_b128 a[20:23], v254 offset:3952
    v_mfma_f32_16x16x32_bf16 v[20:23], a[132:135], a[228:231], v[20:23]
    v_mfma_f32_16x16x32_bf16 v[20:23], a[128:131], a[224:227], v[20:23]
    buffer_load_dwordx4 a[192:195], v1, s[20:23], s68 offen offset:2048 sc1
    v_mfma_f32_16x16x32_bf16 v[16:19], a[132:135], a[224:227], v[16:19]
    v_mfma_f32_16x16x32_bf16 v[16:19], a[128:131], a[220:223], v[16:19]
    v_mfma_f32_16x16x32_bf16 v[172:175], a[132:135], a[220:223], v[172:175]
    s_waitcnt vmcnt(19)
    v_mfma_f32_16x16x32_bf16 v[172:175], a[128:131], a[216:219], v[172:175]
    v_mfma_f32_16x16x32_bf16 v[32:35], a[136:139], a[216:219], v[32:35]
    buffer_load_dwordx4 a[196:199], v1, s[20:23], s68 offen offset:3072 sc1
    v_mfma_f32_16x16x32_bf16 v[32:35], a[140:143], a[220:223], v[32:35]
    s_add_u32 s68, s68, 4096
    v_mfma_f32_16x16x32_bf16 v[36:39], a[136:139], a[220:223], v[36:39]
    v_mfma_f32_16x16x32_bf16 v[36:39], a[140:143], a[224:227], v[36:39]
    v_mfma_f32_16x16x32_bf16 v[40:43], a[136:139], a[224:227], v[40:43]
    v_mfma_f32_16x16x32_bf16 v[40:43], a[140:143], a[228:231], v[40:43]
    buffer_load_dwordx4 a[200:203], v1, s[20:23], s68 offen offset:0 sc1
    v_mfma_f32_16x16x32_bf16 v[44:47], a[136:139], a[228:231], v[44:47]
    v_mfma_f32_16x16x32_bf16 v[44:47], a[140:143], a[232:235], v[44:47]
    s_waitcnt lgkmcnt(0)
    v_mfma_f32_16x16x32_bf16 v[48:51], a[136:139], a[232:235], v[48:51]
    s_waitcnt vmcnt(19)
    v_mfma_f32_16x16x32_bf16 v[48:51], a[140:143], a[236:239], v[48:51]
    v_mfma_f32_16x16x32_bf16 v[52:55], a[72:75], a[0:3], v[52:55]
    buffer_load_dwordx4 a[204:207], v1, s[20:23], s68 offen offset:1024 sc1
    v_mfma_f32_16x16x32_bf16 v[52:55], a[76:79], a[4:7], v[52:55]
    v_mfma_f32_16x16x32_bf16 v[56:59], a[72:75], a[4:7], v[56:59]
    ds_read_b128 a[216:219], v254 offset:8528
    v_mfma_f32_16x16x32_bf16 v[56:59], a[76:79], a[8:11], v[56:59]
    ds_read_b128 a[220:223], v254 offset:8880
    v_mfma_f32_16x16x32_bf16 v[60:63], a[72:75], a[8:11], v[60:63]
    buffer_load_dwordx4 a[208:211], v1, s[20:23], s68 offen offset:2048 sc1
    v_mfma_f32_16x16x32_bf16 v[60:63], a[76:79], a[12:15], v[60:63]
    buffer_load_dwordx4 a[212:215], v1, s[20:23], s68 offen offset:3072 sc1
    v_mfma_f32_16x16x32_bf16 v[176:179], a[72:75], a[12:15], v[176:179]
    s_add_u32 s68, s68, 4096
    v_mfma_f32_16x16x32_bf16 v[176:179], a[76:79], a[16:19], v[176:179]
    ds_read_b128 a[224:227], v254 offset:9232
    v_mfma_f32_16x16x32_bf16 v[180:183], a[72:75], a[16:19], v[180:183]
    s_waitcnt vmcnt(20)
    ds_read_b128 a[228:231], v254 offset:9584
    v_mfma_f32_16x16x32_bf16 v[180:183], a[76:79], a[20:23], v[180:183]
    v_mfma_f32_16x16x32_bf16 v[200:203], a[84:87], a[20:23], v[200:203]
    buffer_load_dwordx4 a[96:99], v1, s[20:23], s68 offen offset:0 sc1
    v_mfma_f32_16x16x32_bf16 v[200:203], a[80:83], a[16:19], v[200:203]
    v_mfma_f32_16x16x32_bf16 v[196:199], a[84:87], a[16:19], v[196:199]
    ds_read_b128 a[232:235], v254 offset:9936
    v_mfma_f32_16x16x32_bf16 v[196:199], a[80:83], a[12:15], v[196:199]
    ds_read_b128 a[236:239], v254 offset:10288
    v_mfma_f32_16x16x32_bf16 v[192:195], a[84:87], a[12:15], v[192:195]
    v_mfma_f32_16x16x32_bf16 v[192:195], a[80:83], a[8:11], v[192:195]
    buffer_load_dwordx4 a[100:103], v1, s[20:23], s68 offen offset:1024 sc1
    v_mfma_f32_16x16x32_bf16 v[188:191], a[84:87], a[8:11], v[188:191]
    v_mfma_f32_16x16x32_bf16 v[188:191], a[80:83], a[4:7], v[188:191]
    v_mfma_f32_16x16x32_bf16 v[184:187], a[84:87], a[4:7], v[184:187]
    s_waitcnt vmcnt(20)
    v_mfma_f32_16x16x32_bf16 v[184:187], a[80:83], a[0:3], v[184:187]
L_pg5:
    s_cbranch_execz L_warmed
    v_mfma_f32_16x16x32_bf16 v[204:207], a[88:91], a[0:3], v[204:207]
    buffer_load_dwordx4 a[104:107], v1, s[20:23], s68 offen offset:2048 sc1
    v_mfma_f32_16x16x32_bf16 v[204:207], a[92:95], a[4:7], v[204:207]
    v_mfma_f32_16x16x32_bf16 v[208:211], a[88:91], a[4:7], v[208:211]
    v_mfma_f32_16x16x32_bf16 v[208:211], a[92:95], a[8:11], v[208:211]
    v_mfma_f32_16x16x32_bf16 v[212:215], a[88:91], a[8:11], v[212:215]
    v_mfma_f32_16x16x32_bf16 v[212:215], a[92:95], a[12:15], v[212:215]
    buffer_load_dwordx4 a[108:111], v1, s[20:23], s68 offen offset:3072 sc1
    v_mfma_f32_16x16x32_bf16 a[248:251], a[88:91], a[12:15], a[248:251]
    s_add_u32 s68, s68, 4096
    v_mfma_f32_16x16x32_bf16 a[248:251], a[92:95], a[16:19], a[248:251]
    s_waitcnt lgkmcnt(0)
    v_mfma_f32_16x16x32_bf16 a[252:255], a[88:91], a[16:19], a[252:255]
    s_waitcnt vmcnt(20)
    v_mfma_f32_16x16x32_bf16 a[252:255], a[92:95], a[20:23], a[252:255]
    v_mfma_f32_16x16x32_bf16 v[8:11], a[144:147], a[216:219], v[8:11]
    buffer_load_dwordx4 a[112:115], v1, s[20:23], s68 offen offset:0 sc1
    v_mfma_f32_16x16x32_bf16 v[8:11], a[148:151], a[220:223], v[8:11]
    v_mfma_f32_16x16x32_bf16 v[12:15], a[144:147], a[220:223], v[12:15]
    ds_read_b128 a[0:3], v254 offset:2208
    v_mfma_f32_16x16x32_bf16 v[12:15], a[148:151], a[224:227], v[12:15]
    ds_read_b128 a[4:7], v254 offset:2560
    v_mfma_f32_16x16x32_bf16 v[160:163], a[144:147], a[224:227], v[160:163]
    v_mfma_f32_16x16x32_bf16 v[160:163], a[148:151], a[228:231], v[160:163]
    buffer_load_dwordx4 a[116:119], v1, s[20:23], s68 offen offset:1024 sc1
    v_mfma_f32_16x16x32_bf16 v[164:167], a[144:147], a[228:231], v[164:167]
    v_mfma_f32_16x16x32_bf16 v[164:167], a[148:151], a[232:235], v[164:167]
    ds_read_b128 a[8:11], v254 offset:2912
    v_mfma_f32_16x16x32_bf16 v[168:171], a[144:147], a[232:235], v[168:171]
    s_waitcnt vmcnt(20)
    ds_read_b128 a[12:15], v254 offset:3264
    v_mfma_f32_16x16x32_bf16 v[168:171], a[148:151], a[236:239], v[168:171]
    v_mfma_f32_16x16x32_bf16 v[28:31], a[156:159], a[236:239], v[28:31]
    buffer_load_dwordx4 a[120:123], v1, s[20:23], s68 offen offset:2048 sc1
    v_mfma_f32_16x16x32_bf16 v[28:31], a[152:155], a[232:235], v[28:31]
    v_mfma_f32_16x16x32_bf16 v[24:27], a[156:159], a[232:235], v[24:27]
    ds_read_b128 a[16:19], v254 offset:3616
    v_mfma_f32_16x16x32_bf16 v[24:27], a[152:155], a[228:231], v[24:27]
    ds_read_b128 a[20:23], v254 offset:3968
    v_mfma_f32_16x16x32_bf16 v[20:23], a[156:159], a[228:231], v[20:23]
    v_mfma_f32_16x16x32_bf16 v[20:23], a[152:155], a[224:227], v[20:23]
    buffer_load_dwordx4 a[124:127], v1, s[20:23], s68 offen offset:3072 sc1
    v_mfma_f32_16x16x32_bf16 v[16:19], a[156:159], a[224:227], v[16:19]
    s_add_u32 s68, s68, 4096
    v_mfma_f32_16x16x32_bf16 v[16:19], a[152:155], a[220:223], v[16:19]
    v_mfma_f32_16x16x32_bf16 v[172:175], a[156:159], a[220:223], v[172:175]
    s_waitcnt vmcnt(20)
    v_mfma_f32_16x16x32_bf16 v[172:175], a[152:155], a[216:219], v[172:175]
    buffer_load_dwordx4 a[128:131], v1, s[20:23], s68 offen offset:0 sc1
    v_mfma_f32_16x16x32_bf16 v[32:35], a[160:163], a[216:219], v[32:35]
    buffer_load_dwordx4 a[132:135], v1, s[20:23], s68 offen offset:1024 sc1
    v_mfma_f32_16x16x32_bf16 v[32:35], a[164:167], a[220:223], v[32:35]
    v_mfma_f32_16x16x32_bf16 v[36:39], a[160:163], a[220:223], v[36:39]
    v_mfma_f32_16x16x32_bf16 v[36:39], a[164:167], a[224:227], v[36:39]
    v_mfma_f32_16x16x32_bf16 v[40:43], a[160:163], a[224:227], v[40:43]
    v_mfma_f32_16x16x32_bf16 v[40:43], a[164:167], a[228:231], v[40:43]
    buffer_load_dwordx4 a[136:139], v1, s[20:23], s68 offen offset:2048 sc1
    v_mfma_f32_16x16x32_bf16 v[44:47], a[160:163], a[228:231], v[44:47]
    v_mfma_f32_16x16x32_bf16 v[44:47], a[164:167], a[232:235], v[44:47]
    s_waitcnt lgkmcnt(0)
    v_mfma_f32_16x16x32_bf16 v[48:51], a[160:163], a[232:235], v[48:51]
    s_waitcnt vmcnt(21)
    v_mfma_f32_16x16x32_bf16 v[48:51], a[164:167], a[236:239], v[48:51]
    v_mfma_f32_16x16x32_bf16 v[52:55], a[168:171], a[0:3], v[52:55]
    buffer_load_dwordx4 a[140:143], v1, s[20:23], s68 offen offset:3072 sc1
    v_mfma_f32_16x16x32_bf16 v[52:55], a[172:175], a[4:7], v[52:55]
    s_add_u32 s68, s68, 4096
    v_mfma_f32_16x16x32_bf16 v[56:59], a[168:171], a[4:7], v[56:59]
    ds_read_b128 a[216:219], v254 offset:8544
    v_mfma_f32_16x16x32_bf16 v[56:59], a[172:175], a[8:11], v[56:59]
    ds_read_b128 a[220:223], v254 offset:8896
    v_mfma_f32_16x16x32_bf16 v[60:63], a[168:171], a[8:11], v[60:63]
    v_mfma_f32_16x16x32_bf16 v[60:63], a[172:175], a[12:15], v[60:63]
    buffer_load_dwordx4 a[72:75], v1, s[20:23], s68 offen offset:0 sc1
    v_mfma_f32_16x16x32_bf16 v[176:179], a[168:171], a[12:15], v[176:179]
    v_mfma_f32_16x16x32_bf16 v[176:179], a[172:175], a[16:19], v[176:179]
    ds_read_b128 a[224:227], v254 offset:9248
    v_mfma_f32_16x16x32_bf16 v[180:183], a[168:171], a[16:19], v[180:183]
    s_waitcnt vmcnt(21)
    ds_read_b128 a[228:231], v254 offset:9600
    v_mfma_f32_16x16x32_bf16 v[180:183], a[172:175], a[20:23], v[180:183]
    v_mfma_f32_16x16x32_bf16 v[200:203], a[180:183], a[20:23], v[200:203]
    buffer_load_dwordx4 a[76:79], v1, s[20:23], s68 offen offset:1024 sc1
    v_mfma_f32_16x16x32_bf16 v[200:203], a[176:179], a[16:19], v[200:203]
    v_mfma_f32_16x16x32_bf16 v[196:199], a[180:183], a[16:19], v[196:199]
    ds_read_b128 a[232:235], v254 offset:9952
    v_mfma_f32_16x16x32_bf16 v[196:199], a[176:179], a[12:15], v[196:199]
    ds_read_b128 a[236:239], v254 offset:10304
    v_mfma_f32_16x16x32_bf16 v[192:195], a[180:183], a[12:15], v[192:195]
    v_mfma_f32_16x16x32_bf16 v[192:195], a[176:179], a[8:11], v[192:195]
    buffer_load_dwordx4 a[80:83], v1, s[20:23], s68 offen offset:2048 sc1
    v_mfma_f32_16x16x32_bf16 v[188:191], a[180:183], a[8:11], v[188:191]
    v_mfma_f32_16x16x32_bf16 v[188:191], a[176:179], a[4:7], v[188:191]
    v_mfma_f32_16x16x32_bf16 v[184:187], a[180:183], a[4:7], v[184:187]
    s_waitcnt vmcnt(21)
    v_mfma_f32_16x16x32_bf16 v[184:187], a[176:179], a[0:3], v[184:187]
    v_mfma_f32_16x16x32_bf16 v[204:207], a[184:187], a[0:3], v[204:207]
    buffer_load_dwordx4 a[84:87], v1, s[20:23], s68 offen offset:3072 sc1
    v_mfma_f32_16x16x32_bf16 v[204:207], a[188:191], a[4:7], v[204:207]
    s_add_u32 s68, s68, 4096
    v_mfma_f32_16x16x32_bf16 v[208:211], a[184:187], a[4:7], v[208:211]
    v_mfma_f32_16x16x32_bf16 v[208:211], a[188:191], a[8:11], v[208:211]
    v_mfma_f32_16x16x32_bf16 v[212:215], a[184:187], a[8:11], v[212:215]
    v_mfma_f32_16x16x32_bf16 v[212:215], a[188:191], a[12:15], v[212:215]
    buffer_load_dwordx4 a[88:91], v1, s[20:23], s68 offen offset:0 sc1
    v_mfma_f32_16x16x32_bf16 a[248:251], a[184:187], a[12:15], a[248:251]
    v_mfma_f32_16x16x32_bf16 a[248:251], a[188:191], a[16:19], a[248:251]
    s_waitcnt lgkmcnt(0)
    v_mfma_f32_16x16x32_bf16 a[252:255], a[184:187], a[16:19], a[252:255]
    s_waitcnt vmcnt(21)
    v_mfma_f32_16x16x32_bf16 a[252:255], a[188:191], a[20:23], a[252:255]
    v_mfma_f32_16x16x32_bf16 v[8:11], a[192:195], a[216:219], v[8:11]
    buffer_load_dwordx4 a[92:95], v1, s[20:23], s68 offen offset:1024 sc1
    v_mfma_f32_16x16x32_bf16 v[8:11], a[196:199], a[220:223], v[8:11]
    v_mfma_f32_16x16x32_bf16 v[12:15], a[192:195], a[220:223], v[12:15]
    v_mfma_f32_16x16x32_bf16 v[12:15], a[196:199], a[224:227], v[12:15]
    v_mfma_f32_16x16x32_bf16 v[160:163], a[192:195], a[224:227], v[160:163]
    buffer_load_dwordx4 a[144:147], v1, s[20:23], s68 offen offset:2048 sc1
    v_mfma_f32_16x16x32_bf16 v[160:163], a[196:199], a[228:231], v[160:163]
    buffer_load_dwordx4 a[148:151], v1, s[20:23], s68 offen offset:3072 sc1
    v_mfma_f32_16x16x32_bf16 v[164:167], a[192:195], a[228:231], v[164:167]
    s_add_u32 s68, s68, 4096
    s_barrier
    v_mfma_f32_16x16x32_bf16 v[164:167], a[196:199], a[232:235], v[164:167]
    ds_read_b128 a[0:3], v254 offset:4224
    v_mfma_f32_16x16x32_bf16 v[168:171], a[192:195], a[232:235], v[168:171]
    s_waitcnt vmcnt(22)
    ds_read_b128 a[4:7], v254 offset:4576
    v_mfma_f32_16x16x32_bf16 v[168:171], a[196:199], a[236:239], v[168:171]
    v_mfma_f32_16x16x32_bf16 v[28:31], a[204:207], a[236:239], v[28:31]
    buffer_load_dwordx4 a[152:155], v1, s[20:23], s68 offen offset:0 sc1
    v_mfma_f32_16x16x32_bf16 v[28:31], a[200:203], a[232:235], v[28:31]
    v_mfma_f32_16x16x32_bf16 v[24:27], a[204:207], a[232:235], v[24:27]
    ds_read_b128 a[8:11], v254 offset:4928
    v_mfma_f32_16x16x32_bf16 v[24:27], a[200:203], a[228:231], v[24:27]
    ds_read_b128 a[12:15], v254 offset:5280
    v_mfma_f32_16x16x32_bf16 v[20:23], a[204:207], a[228:231], v[20:23]
    v_mfma_f32_16x16x32_bf16 v[20:23], a[200:203], a[224:227], v[20:23]
    buffer_load_dwordx4 a[156:159], v1, s[20:23], s68 offen offset:1024 sc1
    v_mfma_f32_16x16x32_bf16 v[16:19], a[204:207], a[224:227], v[16:19]
    v_mfma_f32_16x16x32_bf16 v[16:19], a[200:203], a[220:223], v[16:19]
    ds_read_b128 a[16:19], v254 offset:5632
    v_mfma_f32_16x16x32_bf16 v[172:175], a[204:207], a[220:223], v[172:175]
    s_waitcnt vmcnt(22)
    ds_read_b128 a[20:23], v254 offset:5984
    v_mfma_f32_16x16x32_bf16 v[172:175], a[200:203], a[216:219], v[172:175]
    v_mfma_f32_16x16x32_bf16 v[32:35], a[208:211], a[216:219], v[32:35]
    buffer_load_dwordx4 a[160:163], v1, s[20:23], s68 offen offset:2048 sc1
    v_mfma_f32_16x16x32_bf16 v[32:35], a[212:215], a[220:223], v[32:35]
    v_mfma_f32_16x16x32_bf16 v[36:39], a[208:211], a[220:223], v[36:39]
    v_mfma_f32_16x16x32_bf16 v[36:39], a[212:215], a[224:227], v[36:39]
    v_mfma_f32_16x16x32_bf16 v[40:43], a[208:211], a[224:227], v[40:43]
    v_mfma_f32_16x16x32_bf16 v[40:43], a[212:215], a[228:231], v[40:43]
    buffer_load_dwordx4 a[164:167], v1, s[20:23], s68 offen offset:3072 sc1
    v_mfma_f32_16x16x32_bf16 v[44:47], a[208:211], a[228:231], v[44:47]
    s_add_u32 s68, s68, 4096
    v_mfma_f32_16x16x32_bf16 v[44:47], a[212:215], a[232:235], v[44:47]
    s_waitcnt lgkmcnt(0)
    v_mfma_f32_16x16x32_bf16 v[48:51], a[208:211], a[232:235], v[48:51]
    s_waitcnt vmcnt(22)
    v_mfma_f32_16x16x32_bf16 v[48:51], a[212:215], a[236:239], v[48:51]
    v_mfma_f32_16x16x32_bf16 v[52:55], a[96:99], a[0:3], v[52:55]
    buffer_load_dwordx4 a[168:171], v1, s[20:23], s68 offen offset:0 sc1
    v_mfma_f32_16x16x32_bf16 v[52:55], a[100:103], a[4:7], v[52:55]
    v_mfma_f32_16x16x32_bf16 v[56:59], a[96:99], a[4:7], v[56:59]
    ds_read_b128 a[216:219], v254 offset:10560
    v_mfma_f32_16x16x32_bf16 v[56:59], a[100:103], a[8:11], v[56:59]
    ds_read_b128 a[220:223], v254 offset:10912
    v_mfma_f32_16x16x32_bf16 v[60:63], a[96:99], a[8:11], v[60:63]
    v_mfma_f32_16x16x32_bf16 v[60:63], a[100:103], a[12:15], v[60:63]
    buffer_load_dwordx4 a[172:175], v1, s[20:23], s68 offen offset:1024 sc1
    v_mfma_f32_16x16x32_bf16 v[176:179], a[96:99], a[12:15], v[176:179]
    v_mfma_f32_16x16x32_bf16 v[176:179], a[100:103], a[16:19], v[176:179]
    ds_read_b128 a[224:227], v254 offset:11264
    v_mfma_f32_16x16x32_bf16 v[180:183], a[96:99], a[16:19], v[180:183]
    s_waitcnt vmcnt(22)
    ds_read_b128 a[228:231], v254 offset:11616
    v_mfma_f32_16x16x32_bf16 v[180:183], a[100:103], a[20:23], v[180:183]
    v_mfma_f32_16x16x32_bf16 v[200:203], a[108:111], a[20:23], v[200:203]
    buffer_load_dwordx4 a[176:179], v1, s[20:23], s68 offen offset:2048 sc1
    v_mfma_f32_16x16x32_bf16 v[200:203], a[104:107], a[16:19], v[200:203]
    v_mfma_f32_16x16x32_bf16 v[196:199], a[108:111], a[16:19], v[196:199]
    ds_read_b128 a[232:235], v254 offset:11968
    v_mfma_f32_16x16x32_bf16 v[196:199], a[104:107], a[12:15], v[196:199]
    ds_read_b128 a[236:239], v254 offset:12320
    v_mfma_f32_16x16x32_bf16 v[192:195], a[108:111], a[12:15], v[192:195]
    v_mfma_f32_16x16x32_bf16 v[192:195], a[104:107], a[8:11], v[192:195]
    buffer_load_dwordx4 a[180:183], v1, s[20:23], s68 offen offset:3072 sc1
    v_mfma_f32_16x16x32_bf16 v[188:191], a[108:111], a[8:11], v[188:191]
    s_add_u32 s68, s68, 4096
    v_mfma_f32_16x16x32_bf16 v[188:191], a[104:107], a[4:7], v[188:191]
    v_mfma_f32_16x16x32_bf16 v[184:187], a[108:111], a[4:7], v[184:187]
    s_waitcnt vmcnt(22)
    v_mfma_f32_16x16x32_bf16 v[184:187], a[104:107], a[0:3], v[184:187]
    buffer_load_dwordx4 a[184:187], v1, s[20:23], s68 offen offset:0 sc1
    v_mfma_f32_16x16x32_bf16 v[204:207], a[112:115], a[0:3], v[204:207]
    buffer_load_dwordx4 a[188:191], v1, s[20:23], s68 offen offset:1024 sc1
    v_mfma_f32_16x16x32_bf16 v[204:207], a[116:119], a[4:7], v[204:207]
    v_mfma_f32_16x16x32_bf16 v[208:211], a[112:115], a[4:7], v[208:211]
    v_mfma_f32_16x16x32_bf16 v[208:211], a[116:119], a[8:11], v[208:211]
    v_mfma_f32_16x16x32_bf16 v[212:215], a[112:115], a[8:11], v[212:215]
    v_mfma_f32_16x16x32_bf16 v[212:215], a[116:119], a[12:15], v[212:215]
    buffer_load_dwordx4 a[192:195], v1, s[20:23], s68 offen offset:2048 sc1
    v_mfma_f32_16x16x32_bf16 a[248:251], a[112:115], a[12:15], a[248:251]
    v_mfma_f32_16x16x32_bf16 a[248:251], a[116:119], a[16:19], a[248:251]
    s_waitcnt lgkmcnt(0)
    v_mfma_f32_16x16x32_bf16 a[252:255], a[112:115], a[16:19], a[252:255]
    s_waitcnt vmcnt(23)
    v_mfma_f32_16x16x32_bf16 a[252:255], a[116:119], a[20:23], a[252:255]
    v_mfma_f32_16x16x32_bf16 v[8:11], a[120:123], a[216:219], v[8:11]
    buffer_load_dwordx4 a[196:199], v1, s[20:23], s68 offen offset:3072 sc1
    v_mfma_f32_16x16x32_bf16 v[8:11], a[124:127], a[220:223], v[8:11]
    s_add_u32 s68, s68, 4096
    v_mfma_f32_16x16x32_bf16 v[12:15], a[120:123], a[220:223], v[12:15]
    ds_read_b128 a[0:3], v254 offset:4240
    v_mfma_f32_16x16x32_bf16 v[12:15], a[124:127], a[224:227], v[12:15]
    ds_read_b128 a[4:7], v254 offset:4592
    v_mfma_f32_16x16x32_bf16 v[160:163], a[120:123], a[224:227], v[160:163]
    v_mfma_f32_16x16x32_bf16 v[160:163], a[124:127], a[228:231], v[160:163]
    buffer_load_dwordx4 a[200:203], v1, s[20:23], s68 offen offset:0 sc1
    v_mfma_f32_16x16x32_bf16 v[164:167], a[120:123], a[228:231], v[164:167]
    v_mfma_f32_16x16x32_bf16 v[164:167], a[124:127], a[232:235], v[164:167]
    ds_read_b128 a[8:11], v254 offset:4944
    v_mfma_f32_16x16x32_bf16 v[168:171], a[120:123], a[232:235], v[168:171]
    s_waitcnt vmcnt(23)
    ds_read_b128 a[12:15], v254 offset:5296
    v_mfma_f32_16x16x32_bf16 v[168:171], a[124:127], a[236:239], v[168:171]
    v_mfma_f32_16x16x32_bf16 v[28:31], a[132:135], a[236:239], v[28:31]
    buffer_load_dwordx4 a[204:207], v1, s[20:23], s68 offen offset:1024 sc1
    v_mfma_f32_16x16x32_bf16 v[28:31], a[128:131], a[232:235], v[28:31]
    v_mfma_f32_16x16x32_bf16 v[24:27], a[132:135], a[232:235], v[24:27]
    ds_read_b128 a[16:19], v254 offset:5648
    v_mfma_f32_16x16x32_bf16 v[24:27], a[128:131], a[228:231], v[24:27]
    ds_read_b128 a[20:23], v254 offset:6000
    v_mfma_f32_16x16x32_bf16 v[20:23], a[132:135], a[228:231], v[20:23]
    v_mfma_f32_16x16x32_bf16 v[20:23], a[128:131], a[224:227], v[20:23]
    buffer_load_dwordx4 a[208:211], v1, s[20:23], s68 offen offset:2048 sc1
    v_mfma_f32_16x16x32_bf16 v[16:19], a[132:135], a[224:227], v[16:19]
    v_mfma_f32_16x16x32_bf16 v[16:19], a[128:131], a[220:223], v[16:19]
    v_mfma_f32_16x16x32_bf16 v[172:175], a[132:135], a[220:223], v[172:175]
    s_waitcnt vmcnt(23)
    v_mfma_f32_16x16x32_bf16 v[172:175], a[128:131], a[216:219], v[172:175]
    v_mfma_f32_16x16x32_bf16 v[32:35], a[136:139], a[216:219], v[32:35]
    buffer_load_dwordx4 a[212:215], v1, s[20:23], s68 offen offset:3072 sc1
    v_mfma_f32_16x16x32_bf16 v[32:35], a[140:143], a[220:223], v[32:35]
    s_add_u32 s68, s68, 4096
    v_mfma_f32_16x16x32_bf16 v[36:39], a[136:139], a[220:223], v[36:39]
    v_mfma_f32_16x16x32_bf16 v[36:39], a[140:143], a[224:227], v[36:39]
    v_mfma_f32_16x16x32_bf16 v[40:43], a[136:139], a[224:227], v[40:43]
    v_mfma_f32_16x16x32_bf16 v[40:43], a[140:143], a[228:231], v[40:43]
    buffer_load_dwordx4 a[96:99], v1, s[20:23], s68 offen offset:0 sc1
    v_mfma_f32_16x16x32_bf16 v[44:47], a[136:139], a[228:231], v[44:47]
    v_mfma_f32_16x16x32_bf16 v[44:47], a[140:143], a[232:235], v[44:47]
    s_waitcnt lgkmcnt(0)
    v_mfma_f32_16x16x32_bf16 v[48:51], a[136:139], a[232:235], v[48:51]
    s_waitcnt vmcnt(23)
    v_mfma_f32_16x16x32_bf16 v[48:51], a[140:143], a[236:239], v[48:51]
    v_mfma_f32_16x16x32_bf16 v[52:55], a[72:75], a[0:3], v[52:55]
    buffer_load_dwordx4 a[100:103], v1, s[20:23], s68 offen offset:1024 sc1
    v_mfma_f32_16x16x32_bf16 v[52:55], a[76:79], a[4:7], v[52:55]
    v_mfma_f32_16x16x32_bf16 v[56:59], a[72:75], a[4:7], v[56:59]
    ds_read_b128 a[216:219], v254 offset:10576
    v_mfma_f32_16x16x32_bf16 v[56:59], a[76:79], a[8:11], v[56:59]
    ds_read_b128 a[220:223], v254 offset:10928
    v_mfma_f32_16x16x32_bf16 v[60:63], a[72:75], a[8:11], v[60:63]
    buffer_load_dwordx4 a[104:107], v1, s[20:23], s68 offen offset:2048 sc1
    v_mfma_f32_16x16x32_bf16 v[60:63], a[76:79], a[12:15], v[60:63]
    buffer_load_dwordx4 a[108:111], v1, s[20:23], s68 offen offset:3072 sc1
    v_mfma_f32_16x16x32_bf16 v[176:179], a[72:75], a[12:15], v[176:179]
    s_add_u32 s68, s68, 4096
    v_mfma_f32_16x16x32_bf16 v[176:179], a[76:79], a[16:19], v[176:179]
    ds_read_b128 a[224:227], v254 offset:11280
    v_mfma_f32_16x16x32_bf16 v[180:183], a[72:75], a[16:19], v[180:183]
    s_waitcnt vmcnt(24)
    ds_read_b128 a[228:231], v254 offset:11632
    v_mfma_f32_16x16x32_bf16 v[180:183], a[76:79], a[20:23], v[180:183]
    v_mfma_f32_16x16x32_bf16 v[200:203], a[84:87], a[20:23], v[200:203]
    buffer_load_dwordx4 a[112:115], v1, s[20:23], s68 offen offset:0 sc1
    v_mfma_f32_16x16x32_bf16 v[200:203], a[80:83], a[16:19], v[200:203]
    v_mfma_f32_16x16x32_bf16 v[196:199], a[84:87], a[16:19], v[196:199]
    ds_read_b128 a[232:235], v254 offset:11984
    v_mfma_f32_16x16x32_bf16 v[196:199], a[80:83], a[12:15], v[196:199]
    ds_read_b128 a[236:239], v254 offset:12336
    v_mfma_f32_16x16x32_bf16 v[192:195], a[84:87], a[12:15], v[192:195]
    v_mfma_f32_16x16x32_bf16 v[192:195], a[80:83], a[8:11], v[192:195]
    buffer_load_dwordx4 a[116:119], v1, s[20:23], s68 offen offset:1024 sc1
    v_mfma_f32_16x16x32_bf16 v[188:191], a[84:87], a[8:11], v[188:191]
    v_mfma_f32_16x16x32_bf16 v[188:191], a[80:83], a[4:7], v[188:191]
    v_mfma_f32_16x16x32_bf16 v[184:187], a[84:87], a[4:7], v[184:187]
    s_waitcnt vmcnt(24)
    v_mfma_f32_16x16x32_bf16 v[184:187], a[80:83], a[0:3], v[184:187]
    v_mfma_f32_16x16x32_bf16 v[204:207], a[88:91], a[0:3], v[204:207]
    buffer_load_dwordx4 a[120:123], v1, s[20:23], s68 offen offset:2048 sc1
    v_mfma_f32_16x16x32_bf16 v[204:207], a[92:95], a[4:7], v[204:207]
    v_mfma_f32_16x16x32_bf16 v[208:211], a[88:91], a[4:7], v[208:211]
    v_mfma_f32_16x16x32_bf16 v[208:211], a[92:95], a[8:11], v[208:211]
    v_mfma_f32_16x16x32_bf16 v[212:215], a[88:91], a[8:11], v[212:215]
    v_mfma_f32_16x16x32_bf16 v[212:215], a[92:95], a[12:15], v[212:215]
    buffer_load_dwordx4 a[124:127], v1, s[20:23], s68 offen offset:3072 sc1
    v_mfma_f32_16x16x32_bf16 a[248:251], a[88:91], a[12:15], a[248:251]
    s_add_u32 s68, s68, 4096
    v_mfma_f32_16x16x32_bf16 a[248:251], a[92:95], a[16:19], a[248:251]
    s_waitcnt lgkmcnt(0)
    v_mfma_f32_16x16x32_bf16 a[252:255], a[88:91], a[16:19], a[252:255]
    s_waitcnt vmcnt(20)
    v_mfma_f32_16x16x32_bf16 a[252:255], a[92:95], a[20:23], a[252:255]
    v_mfma_f32_16x16x32_bf16 v[8:11], a[144:147], a[216:219], v[8:11]
    buffer_load_dwordx4 a[128:131], v1, s[20:23], s68 offen offset:0 sc1
    v_mfma_f32_16x16x32_bf16 v[8:11], a[148:151], a[220:223], v[8:11]
    v_mfma_f32_16x16x32_bf16 v[12:15], a[144:147], a[220:223], v[12:15]
    ds_read_b128 a[0:3], v254 offset:4256
    v_mfma_f32_16x16x32_bf16 v[12:15], a[148:151], a[224:227], v[12:15]
    ds_read_b128 a[4:7], v254 offset:4608
    v_mfma_f32_16x16x32_bf16 v[160:163], a[144:147], a[224:227], v[160:163]
    v_mfma_f32_16x16x32_bf16 v[160:163], a[148:151], a[228:231], v[160:163]
    buffer_load_dwordx4 a[132:135], v1, s[20:23], s68 offen offset:1024 sc1
    v_mfma_f32_16x16x32_bf16 v[164:167], a[144:147], a[228:231], v[164:167]
    v_mfma_f32_16x16x32_bf16 v[164:167], a[148:151], a[232:235], v[164:167]
    ds_read_b128 a[8:11], v254 offset:4960
    v_mfma_f32_16x16x32_bf16 v[168:171], a[144:147], a[232:235], v[168:171]
    ds_read_b128 a[12:15], v254 offset:5312
    v_mfma_f32_16x16x32_bf16 v[168:171], a[148:151], a[236:239], v[168:171]
    v_mfma_f32_16x16x32_bf16 v[28:31], a[156:159], a[236:239], v[28:31]
    buffer_load_dwordx4 a[136:139], v1, s[20:23], s68 offen offset:2048 sc1
    v_mfma_f32_16x16x32_bf16 v[28:31], a[152:155], a[232:235], v[28:31]
    v_mfma_f32_16x16x32_bf16 v[24:27], a[156:159], a[232:235], v[24:27]
    ds_read_b128 a[16:19], v254 offset:5664
    v_mfma_f32_16x16x32_bf16 v[24:27], a[152:155], a[228:231], v[24:27]
    ds_read_b128 a[20:23], v254 offset:6016
    v_mfma_f32_16x16x32_bf16 v[20:23], a[156:159], a[228:231], v[20:23]
    v_mfma_f32_16x16x32_bf16 v[20:23], a[152:155], a[224:227], v[20:23]
    buffer_load_dwordx4 a[140:143], v1, s[20:23], s68 offen offset:3072 sc1
    v_mfma_f32_16x16x32_bf16 v[16:19], a[156:159], a[224:227], v[16:19]
    s_add_u32 s68, s68, 4096
    v_mfma_f32_16x16x32_bf16 v[16:19], a[152:155], a[220:223], v[16:19]
    v_mfma_f32_16x16x32_bf16 v[172:175], a[156:159], a[220:223], v[172:175]
    v_mfma_f32_16x16x32_bf16 v[172:175], a[152:155], a[216:219], v[172:175]
    buffer_load_dwordx4 a[72:75], v1, s[20:23], s68 offen offset:0 sc1
    v_mfma_f32_16x16x32_bf16 v[32:35], a[160:163], a[216:219], v[32:35]
    buffer_load_dwordx4 a[76:79], v1, s[20:23], s68 offen offset:1024 sc1
    v_mfma_f32_16x16x32_bf16 v[32:35], a[164:167], a[220:223], v[32:35]
    v_mfma_f32_16x16x32_bf16 v[36:39], a[160:163], a[220:223], v[36:39]
    v_mfma_f32_16x16x32_bf16 v[36:39], a[164:167], a[224:227], v[36:39]
    v_mfma_f32_16x16x32_bf16 v[40:43], a[160:163], a[224:227], v[40:43]
    v_mfma_f32_16x16x32_bf16 v[40:43], a[164:167], a[228:231], v[40:43]
    buffer_load_dwordx4 a[80:83], v1, s[20:23], s68 offen offset:2048 sc1
    v_mfma_f32_16x16x32_bf16 v[44:47], a[160:163], a[228:231], v[44:47]
    v_mfma_f32_16x16x32_bf16 v[44:47], a[164:167], a[232:235], v[44:47]
    s_waitcnt lgkmcnt(0)
    v_mfma_f32_16x16x32_bf16 v[48:51], a[160:163], a[232:235], v[48:51]
    s_waitcnt vmcnt(21)
    v_mfma_f32_16x16x32_bf16 v[48:51], a[164:167], a[236:239], v[48:51]
    v_mfma_f32_16x16x32_bf16 v[52:55], a[168:171], a[0:3], v[52:55]
    buffer_load_dwordx4 a[84:87], v1, s[20:23], s68 offen offset:3072 sc1
    v_mfma_f32_16x16x32_bf16 v[52:55], a[172:175], a[4:7], v[52:55]
    s_add_u32 s68, s68, 4096
    v_mfma_f32_16x16x32_bf16 v[56:59], a[168:171], a[4:7], v[56:59]
    ds_read_b128 a[216:219], v254 offset:10592
    v_mfma_f32_16x16x32_bf16 v[56:59], a[172:175], a[8:11], v[56:59]
    ds_read_b128 a[220:223], v254 offset:10944
    v_mfma_f32_16x16x32_bf16 v[60:63], a[168:171], a[8:11], v[60:63]
    v_mfma_f32_16x16x32_bf16 v[60:63], a[172:175], a[12:15], v[60:63]
    buffer_load_dwordx4 a[88:91], v1, s[20:23], s68 offen offset:0 sc1
    v_mfma_f32_16x16x32_bf16 v[176:179], a[168:171], a[12:15], v[176:179]
    v_mfma_f32_16x16x32_bf16 v[176:179], a[172:175], a[16:19], v[176:179]
    ds_read_b128 a[224:227], v254 offset:11296
    v_mfma_f32_16x16x32_bf16 v[180:183], a[168:171], a[16:19], v[180:183]
    ds_read_b128 a[228:231], v254 offset:11648
    v_mfma_f32_16x16x32_bf16 v[180:183], a[172:175], a[20:23], v[180:183]
    v_mfma_f32_16x16x32_bf16 v[200:203], a[180:183], a[20:23], v[200:203]
    buffer_load_dwordx4 a[92:95], v1, s[20:23], s68 offen offset:1024 sc1
    v_mfma_f32_16x16x32_bf16 v[200:203], a[176:179], a[16:19], v[200:203]
    v_mfma_f32_16x16x32_bf16 v[196:199], a[180:183], a[16:19], v[196:199]
    ds_read_b128 a[232:235], v254 offset:12000
    v_mfma_f32_16x16x32_bf16 v[196:199], a[176:179], a[12:15], v[196:199]
    ds_read_b128 a[236:239], v254 offset:12352
    v_mfma_f32_16x16x32_bf16 v[192:195], a[180:183], a[12:15], v[192:195]
    v_mfma_f32_16x16x32_bf16 v[192:195], a[176:179], a[8:11], v[192:195]
    buffer_load_dwordx4 a[144:147], v1, s[20:23], s68 offen offset:2048 sc1
    v_mfma_f32_16x16x32_bf16 v[188:191], a[180:183], a[8:11], v[188:191]
    v_mfma_f32_16x16x32_bf16 v[188:191], a[176:179], a[4:7], v[188:191]
    v_mfma_f32_16x16x32_bf16 v[184:187], a[180:183], a[4:7], v[184:187]
    v_mfma_f32_16x16x32_bf16 v[184:187], a[176:179], a[0:3], v[184:187]
    v_mfma_f32_16x16x32_bf16 v[204:207], a[184:187], a[0:3], v[204:207]
    buffer_load_dwordx4 a[148:151], v1, s[20:23], s68 offen offset:3072 sc1
    v_mfma_f32_16x16x32_bf16 v[204:207], a[188:191], a[4:7], v[204:207]
    s_add_u32 s68, s68, 4096
    v_mfma_f32_16x16x32_bf16 v[208:211], a[184:187], a[4:7], v[208:211]
    v_mfma_f32_16x16x32_bf16 v[208:211], a[188:191], a[8:11], v[208:211]
    v_mfma_f32_16x16x32_bf16 v[212:215], a[184:187], a[8:11], v[212:215]
    v_mfma_f32_16x16x32_bf16 v[212:215], a[188:191], a[12:15], v[212:215]
    buffer_load_dwordx4 a[152:155], v1, s[20:23], s68 offen offset:0 sc1
    v_mfma_f32_16x16x32_bf16 a[248:251], a[184:187], a[12:15], a[248:251]
    v_mfma_f32_16x16x32_bf16 a[248:251], a[188:191], a[16:19], a[248:251]
    s_waitcnt lgkmcnt(0)
    v_mfma_f32_16x16x32_bf16 a[252:255], a[184:187], a[16:19], a[252:255]
    s_waitcnt vmcnt(21)
    v_mfma_f32_16x16x32_bf16 a[252:255], a[188:191], a[20:23], a[252:255]
    v_mfma_f32_16x16x32_bf16 v[8:11], a[192:195], a[216:219], v[8:11]
    buffer_load_dwordx4 a[156:159], v1, s[20:23], s68 offen offset:1024 sc1
    v_mfma_f32_16x16x32_bf16 v[8:11], a[196:199], a[220:223], v[8:11]
    v_mfma_f32_16x16x32_bf16 v[12:15], a[192:195], a[220:223], v[12:15]
    ds_read_b128 a[0:3], v254 offset:4272
    v_mfma_f32_16x16x32_bf16 v[12:15], a[196:199], a[224:227], v[12:15]
    ds_read_b128 a[4:7], v254 offset:4624
    v_mfma_f32_16x16x32_bf16 v[160:163], a[192:195], a[224:227], v[160:163]
    buffer_load_dwordx4 a[160:163], v1, s[20:23], s68 offen offset:2048 sc1
    v_mfma_f32_16x16x32_bf16 v[160:163], a[196:199], a[228:231], v[160:163]
    buffer_load_dwordx4 a[164:167], v1, s[20:23], s68 offen offset:3072 sc1
    v_mfma_f32_16x16x32_bf16 v[164:167], a[192:195], a[228:231], v[164:167]
    s_add_u32 s68, s68, 4096
    v_mfma_f32_16x16x32_bf16 v[164:167], a[196:199], a[232:235], v[164:167]
    ds_read_b128 a[8:11], v254 offset:4976
    v_mfma_f32_16x16x32_bf16 v[168:171], a[192:195], a[232:235], v[168:171]
    ds_read_b128 a[12:15], v254 offset:5328
    v_mfma_f32_16x16x32_bf16 v[168:171], a[196:199], a[236:239], v[168:171]
    v_mfma_f32_16x16x32_bf16 v[28:31], a[204:207], a[236:239], v[28:31]
    buffer_load_dwordx4 a[168:171], v1, s[20:23], s68 offen offset:0 sc1
    v_mfma_f32_16x16x32_bf16 v[28:31], a[200:203], a[232:235], v[28:31]
    v_mfma_f32_16x16x32_bf16 v[24:27], a[204:207], a[232:235], v[24:27]
    ds_read_b128 a[16:19], v254 offset:5680
    v_mfma_f32_16x16x32_bf16 v[24:27], a[200:203], a[228:231], v[24:27]
    ds_read_b128 a[20:23], v254 offset:6032
    v_mfma_f32_16x16x32_bf16 v[20:23], a[204:207], a[228:231], v[20:23]
    v_mfma_f32_16x16x32_bf16 v[20:23], a[200:203], a[224:227], v[20:23]
    buffer_load_dwordx4 a[172:175], v1, s[20:23], s68 offen offset:1024 sc1
    v_mfma_f32_16x16x32_bf16 v[16:19], a[204:207], a[224:227], v[16:19]
    v_mfma_f32_16x16x32_bf16 v[16:19], a[200:203], a[220:223], v[16:19]
    v_mfma_f32_16x16x32_bf16 v[172:175], a[204:207], a[220:223], v[172:175]
    v_mfma_f32_16x16x32_bf16 v[172:175], a[200:203], a[216:219], v[172:175]
    v_mfma_f32_16x16x32_bf16 v[32:35], a[208:211], a[216:219], v[32:35]
    buffer_load_dwordx4 a[176:179], v1, s[20:23], s68 offen offset:2048 sc1
    v_mfma_f32_16x16x32_bf16 v[32:35], a[212:215], a[220:223], v[32:35]
    v_mfma_f32_16x16x32_bf16 v[36:39], a[208:211], a[220:223], v[36:39]
    v_mfma_f32_16x16x32_bf16 v[36:39], a[212:215], a[224:227], v[36:39]
    v_mfma_f32_16x16x32_bf16 v[40:43], a[208:211], a[224:227], v[40:43]
    v_mfma_f32_16x16x32_bf16 v[40:43], a[212:215], a[228:231], v[40:43]
    buffer_load_dwordx4 a[180:183], v1, s[20:23], s68 offen offset:3072 sc1
    v_mfma_f32_16x16x32_bf16 v[44:47], a[208:211], a[228:231], v[44:47]
    s_add_u32 s68, s68, 4096
    v_mfma_f32_16x16x32_bf16 v[44:47], a[212:215], a[232:235], v[44:47]
    s_waitcnt lgkmcnt(0)
    v_mfma_f32_16x16x32_bf16 v[48:51], a[208:211], a[232:235], v[48:51]
    s_waitcnt vmcnt(22)
    v_mfma_f32_16x16x32_bf16 v[48:51], a[212:215], a[236:239], v[48:51]
    v_mfma_f32_16x16x32_bf16 v[52:55], a[96:99], a[0:3], v[52:55]
    buffer_load_dwordx4 a[184:187], v1, s[20:23], s68 offen offset:0 sc1
    v_mfma_f32_16x16x32_bf16 v[52:55], a[100:103], a[4:7], v[52:55]
    v_mfma_f32_16x16x32_bf16 v[56:59], a[96:99], a[4:7], v[56:59]
    ds_read_b128 a[216:219], v254 offset:10608
    v_mfma_f32_16x16x32_bf16 v[56:59], a[100:103], a[8:11], v[56:59]
    ds_read_b128 a[220:223], v254 offset:10960
    v_mfma_f32_16x16x32_bf16 v[60:63], a[96:99], a[8:11], v[60:63]
    v_mfma_f32_16x16x32_bf16 v[60:63], a[100:103], a[12:15], v[60:63]
    buffer_load_dwordx4 a[188:191], v1, s[20:23], s68 offen offset:1024 sc1
    v_mfma_f32_16x16x32_bf16 v[176:179], a[96:99], a[12:15], v[176:179]
    v_mfma_f32_16x16x32_bf16 v[176:179], a[100:103], a[16:19], v[176:179]
    ds_read_b128 a[224:227], v254 offset:11312
    v_mfma_f32_16x16x32_bf16 v[180:183], a[96:99], a[16:19], v[180:183]
    ds_read_b128 a[228:231], v254 offset:11664
    v_mfma_f32_16x16x32_bf16 v[180:183], a[100:103], a[20:23], v[180:183]
    v_mfma_f32_16x16x32_bf16 v[200:203], a[108:111], a[20:23], v[200:203]
    buffer_load_dwordx4 a[192:195], v1, s[20:23], s68 offen offset:2048 sc1
    v_mfma_f32_16x16x32_bf16 v[200:203], a[104:107], a[16:19], v[200:203]
    v_mfma_f32_16x16x32_bf16 v[196:199], a[108:111], a[16:19], v[196:199]
    ds_read_b128 a[232:235], v254 offset:12016
    v_mfma_f32_16x16x32_bf16 v[196:199], a[104:107], a[12:15], v[196:199]
    ds_read_b128 a[236:239], v254 offset:12368
    v_mfma_f32_16x16x32_bf16 v[192:195], a[108:111], a[12:15], v[192:195]
    v_mfma_f32_16x16x32_bf16 v[192:195], a[104:107], a[8:11], v[192:195]
    buffer_load_dwordx4 a[196:199], v1, s[20:23], s68 offen offset:3072 sc1
    v_mfma_f32_16x16x32_bf16 v[188:191], a[108:111], a[8:11], v[188:191]
    s_add_u32 s68, s68, 4096
    v_mfma_f32_16x16x32_bf16 v[188:191], a[104:107], a[4:7], v[188:191]
    v_mfma_f32_16x16x32_bf16 v[184:187], a[108:111], a[4:7], v[184:187]
    v_mfma_f32_16x16x32_bf16 v[184:187], a[104:107], a[0:3], v[184:187]
    buffer_load_dwordx4 a[200:203], v1, s[20:23], s68 offen offset:0 sc1
    v_mfma_f32_16x16x32_bf16 v[204:207], a[112:115], a[0:3], v[204:207]
    buffer_load_dwordx4 a[204:207], v1, s[20:23], s68 offen offset:1024 sc1
    v_mfma_f32_16x16x32_bf16 v[204:207], a[116:119], a[4:7], v[204:207]
    v_mfma_f32_16x16x32_bf16 v[208:211], a[112:115], a[4:7], v[208:211]
    v_mfma_f32_16x16x32_bf16 v[208:211], a[116:119], a[8:11], v[208:211]
    v_mfma_f32_16x16x32_bf16 v[212:215], a[112:115], a[8:11], v[212:215]
    v_mfma_f32_16x16x32_bf16 v[212:215], a[116:119], a[12:15], v[212:215]
    buffer_load_dwordx4 a[208:211], v1, s[20:23], s68 offen offset:2048 sc1
    v_mfma_f32_16x16x32_bf16 a[248:251], a[112:115], a[12:15], a[248:251]
    v_mfma_f32_16x16x32_bf16 a[248:251], a[116:119], a[16:19], a[248:251]
    s_waitcnt lgkmcnt(0)
    v_mfma_f32_16x16x32_bf16 a[252:255], a[112:115], a[16:19], a[252:255]
    s_waitcnt vmcnt(23)
    v_mfma_f32_16x16x32_bf16 a[252:255], a[116:119], a[20:23], a[252:255]
    v_mfma_f32_16x16x32_bf16 v[8:11], a[120:123], a[216:219], v[8:11]
    buffer_load_dwordx4 a[212:215], v1, s[20:23], s68 offen offset:3072 sc1
    v_mfma_f32_16x16x32_bf16 v[8:11], a[124:127], a[220:223], v[8:11]
    s_add_u32 s68, s68, 4096
    v_mfma_f32_16x16x32_bf16 v[12:15], a[120:123], a[220:223], v[12:15]
    ds_read_b128 a[0:3], v254 offset:4288
    v_mfma_f32_16x16x32_bf16 v[12:15], a[124:127], a[224:227], v[12:15]
    ds_read_b128 a[4:7], v254 offset:4640
    v_mfma_f32_16x16x32_bf16 v[160:163], a[120:123], a[224:227], v[160:163]
    v_mfma_f32_16x16x32_bf16 v[160:163], a[124:127], a[228:231], v[160:163]
    buffer_load_dwordx4 a[96:99], v1, s[20:23], s68 offen offset:0 sc1
    v_mfma_f32_16x16x32_bf16 v[164:167], a[120:123], a[228:231], v[164:167]
    v_mfma_f32_16x16x32_bf16 v[164:167], a[124:127], a[232:235], v[164:167]
    ds_read_b128 a[8:11], v254 offset:4992
    v_mfma_f32_16x16x32_bf16 v[168:171], a[120:123], a[232:235], v[168:171]
    ds_read_b128 a[12:15], v254 offset:5344
    v_mfma_f32_16x16x32_bf16 v[168:171], a[124:127], a[236:239], v[168:171]
    v_mfma_f32_16x16x32_bf16 v[28:31], a[132:135], a[236:239], v[28:31]
    buffer_load_dwordx4 a[100:103], v1, s[20:23], s68 offen offset:1024 sc1
    v_mfma_f32_16x16x32_bf16 v[28:31], a[128:131], a[232:235], v[28:31]
    v_mfma_f32_16x16x32_bf16 v[24:27], a[132:135], a[232:235], v[24:27]
    ds_read_b128 a[16:19], v254 offset:5696
    v_mfma_f32_16x16x32_bf16 v[24:27], a[128:131], a[228:231], v[24:27]
    ds_read_b128 a[20:23], v254 offset:6048
    v_mfma_f32_16x16x32_bf16 v[20:23], a[132:135], a[228:231], v[20:23]
    v_mfma_f32_16x16x32_bf16 v[20:23], a[128:131], a[224:227], v[20:23]
    buffer_load_dwordx4 a[104:107], v1, s[20:23], s68 offen offset:2048 sc1
    v_mfma_f32_16x16x32_bf16 v[16:19], a[132:135], a[224:227], v[16:19]
    v_mfma_f32_16x16x32_bf16 v[16:19], a[128:131], a[220:223], v[16:19]
    v_mfma_f32_16x16x32_bf16 v[172:175], a[132:135], a[220:223], v[172:175]
    v_mfma_f32_16x16x32_bf16 v[172:175], a[128:131], a[216:219], v[172:175]
    v_mfma_f32_16x16x32_bf16 v[32:35], a[136:139], a[216:219], v[32:35]
    buffer_load_dwordx4 a[108:111], v1, s[20:23], s68 offen offset:3072 sc1
    v_mfma_f32_16x16x32_bf16 v[32:35], a[140:143], a[220:223], v[32:35]
    s_add_u32 s68, s68, 4096
    v_mfma_f32_16x16x32_bf16 v[36:39], a[136:139], a[220:223], v[36:39]
L_pg6:
    s_cbranch_execz L_warmed
    v_mfma_f32_16x16x32_bf16 v[36:39], a[140:143], a[224:227], v[36:39]
    v_mfma_f32_16x16x32_bf16 v[40:43], a[136:139], a[224:227], v[40:43]
    v_mfma_f32_16x16x32_bf16 v[40:43], a[140:143], a[228:231], v[40:43]
    buffer_load_dwordx4 a[112:115], v1, s[20:23], s68 offen offset:0 sc1
    v_mfma_f32_16x16x32_bf16 v[44:47], a[136:139], a[228:231], v[44:47]
    v_mfma_f32_16x16x32_bf16 v[44:47], a[140:143], a[232:235], v[44:47]
    s_waitcnt lgkmcnt(0)
    v_mfma_f32_16x16x32_bf16 v[48:51], a[136:139], a[232:235], v[48:51]
    s_waitcnt vmcnt(23)
    v_mfma_f32_16x16x32_bf16 v[48:51], a[140:143], a[236:239], v[48:51]
    v_mfma_f32_16x16x32_bf16 v[52:55], a[72:75], a[0:3], v[52:55]
    buffer_load_dwordx4 a[116:119], v1, s[20:23], s68 offen offset:1024 sc1
    v_mfma_f32_16x16x32_bf16 v[52:55], a[76:79], a[4:7], v[52:55]
    v_mfma_f32_16x16x32_bf16 v[56:59], a[72:75], a[4:7], v[56:59]
    ds_read_b128 a[216:219], v254 offset:10624
    v_mfma_f32_16x16x32_bf16 v[56:59], a[76:79], a[8:11], v[56:59]
    ds_read_b128 a[220:223], v254 offset:10976
    v_mfma_f32_16x16x32_bf16 v[60:63], a[72:75], a[8:11], v[60:63]
    buffer_load_dwordx4 a[120:123], v1, s[20:23], s68 offen offset:2048 sc1
    v_mfma_f32_16x16x32_bf16 v[60:63], a[76:79], a[12:15], v[60:63]
    buffer_load_dwordx4 a[124:127], v1, s[20:23], s68 offen offset:3072 sc1
    v_mfma_f32_16x16x32_bf16 v[176:179], a[72:75], a[12:15], v[176:179]
    s_add_u32 s68, s68, 4096
    v_mfma_f32_16x16x32_bf16 v[176:179], a[76:79], a[16:19], v[176:179]
    ds_read_b128 a[224:227], v254 offset:11328
    v_mfma_f32_16x16x32_bf16 v[180:183], a[72:75], a[16:19], v[180:183]
    ds_read_b128 a[228:231], v254 offset:11680
    v_mfma_f32_16x16x32_bf16 v[180:183], a[76:79], a[20:23], v[180:183]
    v_mfma_f32_16x16x32_bf16 v[200:203], a[84:87], a[20:23], v[200:203]
    buffer_load_dwordx4 a[128:131], v1, s[20:23], s68 offen offset:0 sc1
    v_mfma_f32_16x16x32_bf16 v[200:203], a[80:83], a[16:19], v[200:203]
    v_mfma_f32_16x16x32_bf16 v[196:199], a[84:87], a[16:19], v[196:199]
    ds_read_b128 a[232:235], v254 offset:12032
    v_mfma_f32_16x16x32_bf16 v[196:199], a[80:83], a[12:15], v[196:199]
    ds_read_b128 a[236:239], v254 offset:12384
    v_mfma_f32_16x16x32_bf16 v[192:195], a[84:87], a[12:15], v[192:195]
    v_mfma_f32_16x16x32_bf16 v[192:195], a[80:83], a[8:11], v[192:195]
    buffer_load_dwordx4 a[132:135], v1, s[20:23], s68 offen offset:1024 sc1
    v_mfma_f32_16x16x32_bf16 v[188:191], a[84:87], a[8:11], v[188:191]
    v_mfma_f32_16x16x32_bf16 v[188:191], a[80:83], a[4:7], v[188:191]
    v_mfma_f32_16x16x32_bf16 v[184:187], a[84:87], a[4:7], v[184:187]
    v_mfma_f32_16x16x32_bf16 v[184:187], a[80:83], a[0:3], v[184:187]
    v_mfma_f32_16x16x32_bf16 v[204:207], a[88:91], a[0:3], v[204:207]
    buffer_load_dwordx4 a[136:139], v1, s[20:23], s68 offen offset:2048 sc1
    v_mfma_f32_16x16x32_bf16 v[204:207], a[92:95], a[4:7], v[204:207]
    v_mfma_f32_16x16x32_bf16 v[208:211], a[88:91], a[4:7], v[208:211]
    v_mfma_f32_16x16x32_bf16 v[208:211], a[92:95], a[8:11], v[208:211]
    v_mfma_f32_16x16x32_bf16 v[212:215], a[88:91], a[8:11], v[212:215]
    v_mfma_f32_16x16x32_bf16 v[212:215], a[92:95], a[12:15], v[212:215]
    buffer_load_dwordx4 a[140:143], v1, s[20:23], s68 offen offset:3072 sc1
    v_mfma_f32_16x16x32_bf16 a[248:251], a[88:91], a[12:15], a[248:251]
    s_add_u32 s68, s68, 4096
    v_mfma_f32_16x16x32_bf16 a[248:251], a[92:95], a[16:19], a[248:251]
    s_waitcnt lgkmcnt(0)
    v_mfma_f32_16x16x32_bf16 a[252:255], a[88:91], a[16:19], a[252:255]
    s_waitcnt vmcnt(24)
    v_mfma_f32_16x16x32_bf16 a[252:255], a[92:95], a[20:23], a[252:255]
    v_mfma_f32_16x16x32_bf16 v[8:11], a[144:147], a[216:219], v[8:11]
    buffer_load_dwordx4 a[72:75], v1, s[20:23], s68 offen offset:0 sc1
    v_mfma_f32_16x16x32_bf16 v[8:11], a[148:151], a[220:223], v[8:11]
    v_mfma_f32_16x16x32_bf16 v[12:15], a[144:147], a[220:223], v[12:15]
    ds_read_b128 a[0:3], v254 offset:4304
    v_mfma_f32_16x16x32_bf16 v[12:15], a[148:151], a[224:227], v[12:15]
    ds_read_b128 a[4:7], v254 offset:4656
    v_mfma_f32_16x16x32_bf16 v[160:163], a[144:147], a[224:227], v[160:163]
    v_mfma_f32_16x16x32_bf16 v[160:163], a[148:151], a[228:231], v[160:163]
    buffer_load_dwordx4 a[76:79], v1, s[20:23], s68 offen offset:1024 sc1
    v_mfma_f32_16x16x32_bf16 v[164:167], a[144:147], a[228:231], v[164:167]
    v_mfma_f32_16x16x32_bf16 v[164:167], a[148:151], a[232:235], v[164:167]
    ds_read_b128 a[8:11], v254 offset:5008
    v_mfma_f32_16x16x32_bf16 v[168:171], a[144:147], a[232:235], v[168:171]
    ds_read_b128 a[12:15], v254 offset:5360
    v_mfma_f32_16x16x32_bf16 v[168:171], a[148:151], a[236:239], v[168:171]
    v_mfma_f32_16x16x32_bf16 v[28:31], a[156:159], a[236:239], v[28:31]
    buffer_load_dwordx4 a[80:83], v1, s[20:23], s68 offen offset:2048 sc1
    v_mfma_f32_16x16x32_bf16 v[28:31], a[152:155], a[232:235], v[28:31]
    v_mfma_f32_16x16x32_bf16 v[24:27], a[156:159], a[232:235], v[24:27]
    ds_read_b128 a[16:19], v254 offset:5712
    v_mfma_f32_16x16x32_bf16 v[24:27], a[152:155], a[228:231], v[24:27]
    ds_read_b128 a[20:23], v254 offset:6064
    v_mfma_f32_16x16x32_bf16 v[20:23], a[156:159], a[228:231], v[20:23]
    v_mfma_f32_16x16x32_bf16 v[20:23], a[152:155], a[224:227], v[20:23]
    buffer_load_dwordx4 a[84:87], v1, s[20:23], s68 offen offset:3072 sc1
    v_mfma_f32_16x16x32_bf16 v[16:19], a[156:159], a[224:227], v[16:19]
    s_add_u32 s68, s68, 4096
    v_mfma_f32_16x16x32_bf16 v[16:19], a[152:155], a[220:223], v[16:19]
    v_mfma_f32_16x16x32_bf16 v[172:175], a[156:159], a[220:223], v[172:175]
    v_mfma_f32_16x16x32_bf16 v[172:175], a[152:155], a[216:219], v[172:175]
    buffer_load_dwordx4 a[88:91], v1, s[20:23], s68 offen offset:0 sc1
    v_mfma_f32_16x16x32_bf16 v[32:35], a[160:163], a[216:219], v[32:35]
    buffer_load_dwordx4 a[92:95], v1, s[20:23], s68 offen offset:1024 sc1
    v_mfma_f32_16x16x32_bf16 v[32:35], a[164:167], a[220:223], v[32:35]
    v_mfma_f32_16x16x32_bf16 v[36:39], a[160:163], a[220:223], v[36:39]
    v_mfma_f32_16x16x32_bf16 v[36:39], a[164:167], a[224:227], v[36:39]
    v_mfma_f32_16x16x32_bf16 v[40:43], a[160:163], a[224:227], v[40:43]
    v_mfma_f32_16x16x32_bf16 v[40:43], a[164:167], a[228:231], v[40:43]
    buffer_load_dwordx4 a[144:147], v1, s[20:23], s68 offen offset:2048 sc1
    v_mfma_f32_16x16x32_bf16 v[44:47], a[160:163], a[228:231], v[44:47]
    v_mfma_f32_16x16x32_bf16 v[44:47], a[164:167], a[232:235], v[44:47]
    s_waitcnt lgkmcnt(0)
    v_mfma_f32_16x16x32_bf16 v[48:51], a[160:163], a[232:235], v[48:51]
    s_waitcnt vmcnt(25)
    v_mfma_f32_16x16x32_bf16 v[48:51], a[164:167], a[236:239], v[48:51]
    v_mfma_f32_16x16x32_bf16 v[52:55], a[168:171], a[0:3], v[52:55]
    buffer_load_dwordx4 a[148:151], v1, s[20:23], s68 offen offset:3072 sc1
    v_mfma_f32_16x16x32_bf16 v[52:55], a[172:175], a[4:7], v[52:55]
    s_add_u32 s68, s68, 4096
    v_mfma_f32_16x16x32_bf16 v[56:59], a[168:171], a[4:7], v[56:59]
    ds_read_b128 a[216:219], v254 offset:10640
    v_mfma_f32_16x16x32_bf16 v[56:59], a[172:175], a[8:11], v[56:59]
    ds_read_b128 a[220:223], v254 offset:10992
    v_mfma_f32_16x16x32_bf16 v[60:63], a[168:171], a[8:11], v[60:63]
    v_mfma_f32_16x16x32_bf16 v[60:63], a[172:175], a[12:15], v[60:63]
    buffer_load_dwordx4 a[152:155], v1, s[20:23], s68 offen offset:0 sc1
    v_mfma_f32_16x16x32_bf16 v[176:179], a[168:171], a[12:15], v[176:179]
    v_mfma_f32_16x16x32_bf16 v[176:179], a[172:175], a[16:19], v[176:179]
    ds_read_b128 a[224:227], v254 offset:11344
    v_mfma_f32_16x16x32_bf16 v[180:183], a[168:171], a[16:19], v[180:183]
    ds_read_b128 a[228:231], v254 offset:11696
    v_mfma_f32_16x16x32_bf16 v[180:183], a[172:175], a[20:23], v[180:183]
    v_mfma_f32_16x16x32_bf16 v[200:203], a[180:183], a[20:23], v[200:203]
    buffer_load_dwordx4 a[156:159], v1, s[20:23], s68 offen offset:1024 sc1
    v_mfma_f32_16x16x32_bf16 v[200:203], a[176:179], a[16:19], v[200:203]
    v_mfma_f32_16x16x32_bf16 v[196:199], a[180:183], a[16:19], v[196:199]
    ds_read_b128 a[232:235], v254 offset:12048
    v_mfma_f32_16x16x32_bf16 v[196:199], a[176:179], a[12:15], v[196:199]
    ds_read_b128 a[236:239], v254 offset:12400
    v_mfma_f32_16x16x32_bf16 v[192:195], a[180:183], a[12:15], v[192:195]
    v_mfma_f32_16x16x32_bf16 v[192:195], a[176:179], a[8:11], v[192:195]
    buffer_load_dwordx4 a[160:163], v1, s[20:23], s68 offen offset:2048 sc1
    v_mfma_f32_16x16x32_bf16 v[188:191], a[180:183], a[8:11], v[188:191]
    v_mfma_f32_16x16x32_bf16 v[188:191], a[176:179], a[4:7], v[188:191]
    v_mfma_f32_16x16x32_bf16 v[184:187], a[180:183], a[4:7], v[184:187]
    v_mfma_f32_16x16x32_bf16 v[184:187], a[176:179], a[0:3], v[184:187]
    v_mfma_f32_16x16x32_bf16 v[204:207], a[184:187], a[0:3], v[204:207]
    buffer_load_dwordx4 a[164:167], v1, s[20:23], s68 offen offset:3072 sc1
    v_mfma_f32_16x16x32_bf16 v[204:207], a[188:191], a[4:7], v[204:207]
    s_add_u32 s68, s68, 4096
    v_mfma_f32_16x16x32_bf16 v[208:211], a[184:187], a[4:7], v[208:211]
    v_mfma_f32_16x16x32_bf16 v[208:211], a[188:191], a[8:11], v[208:211]
    v_mfma_f32_16x16x32_bf16 v[212:215], a[184:187], a[8:11], v[212:215]
    v_mfma_f32_16x16x32_bf16 v[212:215], a[188:191], a[12:15], v[212:215]
    buffer_load_dwordx4 a[168:171], v1, s[20:23], s68 offen offset:0 sc1
    v_mfma_f32_16x16x32_bf16 a[248:251], a[184:187], a[12:15], a[248:251]
    v_mfma_f32_16x16x32_bf16 a[248:251], a[188:191], a[16:19], a[248:251]
    s_waitcnt lgkmcnt(0)
    v_mfma_f32_16x16x32_bf16 a[252:255], a[184:187], a[16:19], a[252:255]
    s_waitcnt vmcnt(25)
    v_mfma_f32_16x16x32_bf16 a[252:255], a[188:191], a[20:23], a[252:255]
    v_mfma_f32_16x16x32_bf16 v[8:11], a[192:195], a[216:219], v[8:11]
    buffer_load_dwordx4 a[172:175], v1, s[20:23], s68 offen offset:1024 sc1
    v_mfma_f32_16x16x32_bf16 v[8:11], a[196:199], a[220:223], v[8:11]
    v_mfma_f32_16x16x32_bf16 v[12:15], a[192:195], a[220:223], v[12:15]
    ds_read_b128 a[0:3], v254 offset:4320
    v_mfma_f32_16x16x32_bf16 v[12:15], a[196:199], a[224:227], v[12:15]
    ds_read_b128 a[4:7], v254 offset:4672
    v_mfma_f32_16x16x32_bf16 v[160:163], a[192:195], a[224:227], v[160:163]
    buffer_load_dwordx4 a[176:179], v1, s[20:23], s68 offen offset:2048 sc1
    v_mfma_f32_16x16x32_bf16 v[160:163], a[196:199], a[228:231], v[160:163]
    buffer_load_dwordx4 a[180:183], v1, s[20:23], s68 offen offset:3072 sc1
    v_mfma_f32_16x16x32_bf16 v[164:167], a[192:195], a[228:231], v[164:167]
    s_add_u32 s68, s68, 4096
    v_mfma_f32_16x16x32_bf16 v[164:167], a[196:199], a[232:235], v[164:167]
    ds_read_b128 a[8:11], v254 offset:5024
    v_mfma_f32_16x16x32_bf16 v[168:171], a[192:195], a[232:235], v[168:171]
    ds_read_b128 a[12:15], v254 offset:5376
    v_mfma_f32_16x16x32_bf16 v[168:171], a[196:199], a[236:239], v[168:171]
    v_mfma_f32_16x16x32_bf16 v[28:31], a[204:207], a[236:239], v[28:31]
    buffer_load_dwordx4 a[184:187], v1, s[20:23], s68 offen offset:0 sc1
    v_mfma_f32_16x16x32_bf16 v[28:31], a[200:203], a[232:235], v[28:31]
    v_mfma_f32_16x16x32_bf16 v[24:27], a[204:207], a[232:235], v[24:27]
    ds_read_b128 a[16:19], v254 offset:5728
    v_mfma_f32_16x16x32_bf16 v[24:27], a[200:203], a[228:231], v[24:27]
    ds_read_b128 a[20:23], v254 offset:6080
    v_mfma_f32_16x16x32_bf16 v[20:23], a[204:207], a[228:231], v[20:23]
    v_mfma_f32_16x16x32_bf16 v[20:23], a[200:203], a[224:227], v[20:23]
    buffer_load_dwordx4 a[188:191], v1, s[20:23], s68 offen offset:1024 sc1
    v_mfma_f32_16x16x32_bf16 v[16:19], a[204:207], a[224:227], v[16:19]
    v_mfma_f32_16x16x32_bf16 v[16:19], a[200:203], a[220:223], v[16:19]
    v_mfma_f32_16x16x32_bf16 v[172:175], a[204:207], a[220:223], v[172:175]
    v_mfma_f32_16x16x32_bf16 v[172:175], a[200:203], a[216:219], v[172:175]
    v_mfma_f32_16x16x32_bf16 v[32:35], a[208:211], a[216:219], v[32:35]
    buffer_load_dwordx4 a[192:195], v1, s[20:23], s68 offen offset:2048 sc1
    v_mfma_f32_16x16x32_bf16 v[32:35], a[212:215], a[220:223], v[32:35]
    v_mfma_f32_16x16x32_bf16 v[36:39], a[208:211], a[220:223], v[36:39]
    v_mfma_f32_16x16x32_bf16 v[36:39], a[212:215], a[224:227], v[36:39]
    v_mfma_f32_16x16x32_bf16 v[40:43], a[208:211], a[224:227], v[40:43]
    v_mfma_f32_16x16x32_bf16 v[40:43], a[212:215], a[228:231], v[40:43]
    buffer_load_dwordx4 a[196:199], v1, s[20:23], s68 offen offset:3072 sc1
    v_mfma_f32_16x16x32_bf16 v[44:47], a[208:211], a[228:231], v[44:47]
    s_add_u32 s68, s68, 4096
    v_mfma_f32_16x16x32_bf16 v[44:47], a[212:215], a[232:235], v[44:47]
    s_waitcnt lgkmcnt(0)
    v_mfma_f32_16x16x32_bf16 v[48:51], a[208:211], a[232:235], v[48:51]
    s_waitcnt vmcnt(26)
    v_mfma_f32_16x16x32_bf16 v[48:51], a[212:215], a[236:239], v[48:51]
    v_mfma_f32_16x16x32_bf16 v[52:55], a[96:99], a[0:3], v[52:55]
    buffer_load_dwordx4 a[200:203], v1, s[20:23], s68 offen offset:0 sc1
    v_mfma_f32_16x16x32_bf16 v[52:55], a[100:103], a[4:7], v[52:55]
    v_mfma_f32_16x16x32_bf16 v[56:59], a[96:99], a[4:7], v[56:59]
    ds_read_b128 a[216:219], v254 offset:10656
    v_mfma_f32_16x16x32_bf16 v[56:59], a[100:103], a[8:11], v[56:59]
    ds_read_b128 a[220:223], v254 offset:11008
    v_mfma_f32_16x16x32_bf16 v[60:63], a[96:99], a[8:11], v[60:63]
    v_mfma_f32_16x16x32_bf16 v[60:63], a[100:103], a[12:15], v[60:63]
    buffer_load_dwordx4 a[204:207], v1, s[20:23], s68 offen offset:1024 sc1
    v_mfma_f32_16x16x32_bf16 v[176:179], a[96:99], a[12:15], v[176:179]
    v_mfma_f32_16x16x32_bf16 v[176:179], a[100:103], a[16:19], v[176:179]
    ds_read_b128 a[224:227], v254 offset:11360
    v_mfma_f32_16x16x32_bf16 v[180:183], a[96:99], a[16:19], v[180:183]
    ds_read_b128 a[228:231], v254 offset:11712
    v_mfma_f32_16x16x32_bf16 v[180:183], a[100:103], a[20:23], v[180:183]
    v_mfma_f32_16x16x32_bf16 v[200:203], a[108:111], a[20:23], v[200:203]
    buffer_load_dwordx4 a[208:211], v1, s[20:23], s68 offen offset:2048 sc1
    v_mfma_f32_16x16x32_bf16 v[200:203], a[104:107], a[16:19], v[200:203]
    v_mfma_f32_16x16x32_bf16 v[196:199], a[108:111], a[16:19], v[196:199]
    ds_read_b128 a[232:235], v254 offset:12064
    v_mfma_f32_16x16x32_bf16 v[196:199], a[104:107], a[12:15], v[196:199]
    ds_read_b128 a[236:239], v254 offset:12416
    v_mfma_f32_16x16x32_bf16 v[192:195], a[108:111], a[12:15], v[192:195]
    v_mfma_f32_16x16x32_bf16 v[192:195], a[104:107], a[8:11], v[192:195]
    buffer_load_dwordx4 a[212:215], v1, s[20:23], s68 offen offset:3072 sc1
    v_mfma_f32_16x16x32_bf16 v[188:191], a[108:111], a[8:11], v[188:191]
    s_add_u32 s68, s68, 4096
    v_mfma_f32_16x16x32_bf16 v[188:191], a[104:107], a[4:7], v[188:191]
    v_mfma_f32_16x16x32_bf16 v[184:187], a[108:111], a[4:7], v[184:187]
    v_mfma_f32_16x16x32_bf16 v[184:187], a[104:107], a[0:3], v[184:187]
    buffer_load_dwordx4 a[96:99], v1, s[20:23], s68 offen offset:0 sc1
    v_mfma_f32_16x16x32_bf16 v[204:207], a[112:115], a[0:3], v[204:207]
    buffer_load_dwordx4 a[100:103], v1, s[20:23], s68 offen offset:1024 sc1
    v_mfma_f32_16x16x32_bf16 v[204:207], a[116:119], a[4:7], v[204:207]
    v_mfma_f32_16x16x32_bf16 v[208:211], a[112:115], a[4:7], v[208:211]
    v_mfma_f32_16x16x32_bf16 v[208:211], a[116:119], a[8:11], v[208:211]
    v_mfma_f32_16x16x32_bf16 v[212:215], a[112:115], a[8:11], v[212:215]
    v_mfma_f32_16x16x32_bf16 v[212:215], a[116:119], a[12:15], v[212:215]
    buffer_load_dwordx4 a[104:107], v1, s[20:23], s68 offen offset:2048 sc1
    v_mfma_f32_16x16x32_bf16 a[248:251], a[112:115], a[12:15], a[248:251]
    v_mfma_f32_16x16x32_bf16 a[248:251], a[116:119], a[16:19], a[248:251]
    s_waitcnt lgkmcnt(0)
    v_mfma_f32_16x16x32_bf16 a[252:255], a[112:115], a[16:19], a[252:255]
    s_waitcnt vmcnt(27)
    v_mfma_f32_16x16x32_bf16 a[252:255], a[116:119], a[20:23], a[252:255]
    v_mfma_f32_16x16x32_bf16 v[8:11], a[120:123], a[216:219], v[8:11]
    buffer_load_dwordx4 a[108:111], v1, s[20:23], s68 offen offset:3072 sc1
    v_mfma_f32_16x16x32_bf16 v[8:11], a[124:127], a[220:223], v[8:11]
    s_add_u32 s68, s68, 4096
    v_add_u32 v254, s50, v254
    v_mfma_f32_16x16x32_bf16 v[12:15], a[120:123], a[220:223], v[12:15]
    ds_read_b128 a[0:3], v254 offset:0
    v_mfma_f32_16x16x32_bf16 v[12:15], a[124:127], a[224:227], v[12:15]
    ds_read_b128 a[4:7], v254 offset:352
    v_mfma_f32_16x16x32_bf16 v[160:163], a[120:123], a[224:227], v[160:163]
    v_mfma_f32_16x16x32_bf16 v[160:163], a[124:127], a[228:231], v[160:163]
    buffer_load_dwordx4 a[112:115], v1, s[20:23], s68 offen offset:0 sc1
    v_mfma_f32_16x16x32_bf16 v[164:167], a[120:123], a[228:231], v[164:167]
    v_mfma_f32_16x16x32_bf16 v[164:167], a[124:127], a[232:235], v[164:167]
    ds_read_b128 a[8:11], v254 offset:704
    v_mfma_f32_16x16x32_bf16 v[168:171], a[120:123], a[232:235], v[168:171]
    ds_read_b128 a[12:15], v254 offset:1056
    v_mfma_f32_16x16x32_bf16 v[168:171], a[124:127], a[236:239], v[168:171]
    v_accvgpr_read_b32 v148, a248
    v_accvgpr_read_b32 v149, a249
    v_mfma_f32_16x16x32_bf16 v[28:31], a[132:135], a[236:239], v[28:31]
    buffer_load_dwordx4 a[116:119], v1, s[20:23], s68 offen offset:1024 sc1
    v_mfma_f32_16x16x32_bf16 v[28:31], a[128:131], a[232:235], v[28:31]
    v_accvgpr_read_b32 v150, a250
    v_accvgpr_read_b32 v151, a251
    v_mfma_f32_16x16x32_bf16 v[24:27], a[132:135], a[232:235], v[24:27]
    ds_read_b128 a[16:19], v254 offset:1408
    v_accvgpr_read_b32 v240, a252
    v_mfma_f32_16x16x32_bf16 v[24:27], a[128:131], a[228:231], v[24:27]
    ds_read_b128 a[20:23], v254 offset:1760
    v_accvgpr_read_b32 v241, a253
    v_mfma_f32_16x16x32_bf16 v[20:23], a[132:135], a[228:231], v[20:23]
    v_accvgpr_read_b32 v242, a254
    v_accvgpr_read_b32 v243, a255
    v_mfma_f32_16x16x32_bf16 v[20:23], a[128:131], a[224:227], v[20:23]
    buffer_load_dwordx4 a[120:123], v1, s[20:23], s68 offen offset:2048 sc1
    v_mfma_f32_16x16x32_bf16 v[16:19], a[132:135], a[224:227], v[16:19]
    v_mfma_f32_16x16x32_bf16 v[16:19], a[128:131], a[220:223], v[16:19]
    v_mfma_f32_16x16x32_bf16 v[172:175], a[132:135], a[220:223], v[172:175]
    v_mfma_f32_16x16x32_bf16 v[172:175], a[128:131], a[216:219], v[172:175]
    v_mfma_f32_16x16x32_bf16 v[32:35], a[136:139], a[216:219], v[32:35]
    buffer_load_dwordx4 a[124:127], v1, s[20:23], s68 offen offset:3072 sc1
    v_mfma_f32_16x16x32_bf16 v[32:35], a[140:143], a[220:223], v[32:35]
    s_add_u32 s68, s68, 4096
    v_mfma_f32_16x16x32_bf16 v[36:39], a[136:139], a[220:223], v[36:39]
    v_mfma_f32_16x16x32_bf16 v[36:39], a[140:143], a[224:227], v[36:39]
    v_mfma_f32_16x16x32_bf16 v[40:43], a[136:139], a[224:227], v[40:43]
    v_mfma_f32_16x16x32_bf16 v[40:43], a[140:143], a[228:231], v[40:43]
    buffer_load_dwordx4 a[128:131], v1, s[20:23], s68 offen offset:0 sc1
    v_mfma_f32_16x16x32_bf16 v[44:47], a[136:139], a[228:231], v[44:47]
    v_mfma_f32_16x16x32_bf16 v[44:47], a[140:143], a[232:235], v[44:47]
    s_waitcnt lgkmcnt(0)
    v_mfma_f32_16x16x32_bf16 v[48:51], a[136:139], a[232:235], v[48:51]
    s_waitcnt vmcnt(31)
    v_mfma_f32_16x16x32_bf16 v[48:51], a[140:143], a[236:239], v[48:51]
    s_waitcnt vmcnt(27)
    v_mfma_f32_16x16x32_bf16 v[64:67], a[72:75], a[0:3], 0
    buffer_load_dwordx4 a[132:135], v1, s[20:23], s68 offen offset:1024 sc1
    v_mfma_f32_16x16x32_bf16 v[64:67], a[76:79], a[4:7], v[64:67]
    v_add_u32 v247, 57344, v153
    v_mfma_f32_16x16x32_bf16 v[68:71], a[72:75], a[4:7], 0
    ds_read_b128 a[216:219], v254 offset:2112
    v_mfma_f32_16x16x32_bf16 v[68:71], a[76:79], a[8:11], v[68:71]
    ds_read_b128 a[220:223], v254 offset:2464
    v_mfma_f32_16x16x32_bf16 v[72:75], a[72:75], a[8:11], 0
    buffer_load_dwordx4 a[136:139], v1, s[20:23], s68 offen offset:2048 sc1
    v_add_u32 v248, 114432, v153
    s_lshl_b32 m0, s3, 8
    v_mfma_f32_16x16x32_bf16 v[72:75], a[76:79], a[12:15], v[72:75]
    buffer_load_dwordx4 a[140:143], v1, s[20:23], s68 offen offset:3072 sc1
    v_mfma_f32_16x16x32_bf16 v[76:79], a[72:75], a[12:15], 0
    s_add_u32 s68, s68, 4096
    s_barrier
    v_mfma_f32_16x16x32_bf16 v[76:79], a[76:79], a[16:19], v[76:79]
    ds_read_b128 a[224:227], v254 offset:2816
    v_mfma_f32_16x16x32_bf16 v[80:83], a[72:75], a[16:19], 0
    ds_read_b128 a[228:231], v254 offset:3168
    v_sub_f32 v168, v180, v168
    v_mfma_f32_16x16x32_bf16 v[80:83], a[76:79], a[20:23], v[80:83]
    ds_write_addtid_b32 v168 offset:0
    v_sub_f32 v169, v181, v169
    v_mfma_f32_16x16x32_bf16 v[100:103], a[84:87], a[20:23], 0
    buffer_load_dwordx4 a[72:75], v1, s[20:23], s68 offen offset:0 sc1
    v_mfma_f32_16x16x32_bf16 v[100:103], a[80:83], a[16:19], v[100:103]
    ds_write_addtid_b32 v169 offset:1024
    v_sub_f32 v170, v182, v170
    v_mfma_f32_16x16x32_bf16 v[96:99], a[84:87], a[16:19], 0
    ds_read_b128 a[232:235], v254 offset:3520
    v_sub_f32 v171, v183, v171
    v_mfma_f32_16x16x32_bf16 v[96:99], a[80:83], a[12:15], v[96:99]
    ds_read_b128 a[236:239], v254 offset:3872
    v_sub_f32 v28, v200, v28
    v_mfma_f32_16x16x32_bf16 v[92:95], a[84:87], a[12:15], 0
    ds_write_addtid_b32 v170 offset:2048
    v_sub_f32 v29, v201, v29
    v_mfma_f32_16x16x32_bf16 v[92:95], a[80:83], a[8:11], v[92:95]
    buffer_load_dwordx4 a[76:79], v1, s[20:23], s68 offen offset:1024 sc1
    v_mfma_f32_16x16x32_bf16 v[88:91], a[84:87], a[8:11], 0
    ds_write_addtid_b32 v171 offset:3072
    v_sub_f32 v30, v202, v30
    v_mfma_f32_16x16x32_bf16 v[88:91], a[80:83], a[4:7], v[88:91]
    ds_write_addtid_b32 v28 offset:4096
    v_sub_f32 v31, v203, v31
    v_mfma_f32_16x16x32_bf16 v[84:87], a[84:87], a[4:7], 0
    ds_write_addtid_b32 v29 offset:5120
    v_sub_f32 v48, v240, v48
    v_mfma_f32_16x16x32_bf16 v[84:87], a[80:83], a[0:3], v[84:87]
    ds_write_addtid_b32 v30 offset:6144
    v_sub_f32 v49, v241, v49
    v_mfma_f32_16x16x32_bf16 v[104:107], a[88:91], a[0:3], 0
    buffer_load_dwordx4 a[80:83], v1, s[20:23], s68 offen offset:2048 sc1
    v_mfma_f32_16x16x32_bf16 v[104:107], a[92:95], a[4:7], v[104:107]
    ds_write_addtid_b32 v31 offset:7168
    v_sub_f32 v50, v242, v50
    v_mfma_f32_16x16x32_bf16 v[108:111], a[88:91], a[4:7], 0
    ds_write_addtid_b32 v48 offset:8192
    v_sub_f32 v51, v243, v51
    v_mfma_f32_16x16x32_bf16 v[108:111], a[92:95], a[8:11], v[108:111]
    ds_write_addtid_b32 v49 offset:9216
    v_sub_f32 v164, v176, v164
    v_mfma_f32_16x16x32_bf16 v[112:115], a[88:91], a[8:11], 0
    ds_write_addtid_b32 v50 offset:10240
    v_sub_f32 v165, v177, v165
    v_mfma_f32_16x16x32_bf16 v[112:115], a[92:95], a[12:15], v[112:115]
    buffer_load_dwordx4 a[84:87], v1, s[20:23], s68 offen offset:3072 sc1
    v_mfma_f32_16x16x32_bf16 v[116:119], a[88:91], a[12:15], 0
    s_add_u32 s68, s68, 4096
    ds_write_addtid_b32 v51 offset:11264
    v_mfma_f32_16x16x32_bf16 v[116:119], a[92:95], a[16:19], v[116:119]
    ds_write_addtid_b32 v164 offset:19200
    v_sub_f32 v166, v178, v166
    v_mfma_f32_16x16x32_bf16 v[120:123], a[88:91], a[16:19], 0
    ds_write_addtid_b32 v165 offset:20224
    v_sub_f32 v167, v179, v167
    v_mfma_f32_16x16x32_bf16 v[120:123], a[92:95], a[20:23], v[120:123]
    s_waitcnt lgkmcnt(12)
    s_waitcnt vmcnt(28)
    v_mfma_f32_16x16x32_bf16 v[64:67], a[144:147], a[216:219], v[64:67]
    buffer_load_dwordx4 a[88:91], v1, s[20:23], s68 offen offset:0 sc1
    v_mfma_f32_16x16x32_bf16 v[64:67], a[148:151], a[220:223], v[64:67]
    ds_write_addtid_b32 v166 offset:21248
    v_sub_f32 v24, v196, v24
    v_mfma_f32_16x16x32_bf16 v[68:71], a[144:147], a[220:223], v[68:71]
    ds_read_b128 a[0:3], v254 offset:4224
    v_sub_f32 v25, v197, v25
    v_mfma_f32_16x16x32_bf16 v[68:71], a[148:151], a[224:227], v[68:71]
    ds_read_b128 a[4:7], v254 offset:4576
    v_sub_f32 v26, v198, v26
    v_mfma_f32_16x16x32_bf16 v[72:75], a[144:147], a[224:227], v[72:75]
    ds_write_addtid_b32 v167 offset:22272
    v_sub_f32 v27, v199, v27
    v_mfma_f32_16x16x32_bf16 v[72:75], a[148:151], a[228:231], v[72:75]
    buffer_load_dwordx4 a[92:95], v1, s[20:23], s68 offen offset:1024 sc1
    v_mfma_f32_16x16x32_bf16 v[76:79], a[144:147], a[228:231], v[76:79]
    ds_write_addtid_b32 v24 offset:23296
    v_sub_f32 v44, v148, v44
    v_mfma_f32_16x16x32_bf16 v[76:79], a[148:151], a[232:235], v[76:79]
    ds_read_b128 a[8:11], v254 offset:4928
    v_sub_f32 v45, v149, v45
    v_mfma_f32_16x16x32_bf16 v[80:83], a[144:147], a[232:235], v[80:83]
    ds_read_b128 a[12:15], v254 offset:5280
    v_sub_f32 v46, v150, v46
    v_mfma_f32_16x16x32_bf16 v[80:83], a[148:151], a[236:239], v[80:83]
    ds_write_addtid_b32 v25 offset:24320
    v_sub_f32 v47, v151, v47
    v_mfma_f32_16x16x32_bf16 v[100:103], a[156:159], a[236:239], v[100:103]
    buffer_load_dwordx4 a[144:147], v1, s[20:23], s68 offen offset:2048 sc1
    v_mfma_f32_16x16x32_bf16 v[100:103], a[152:155], a[232:235], v[100:103]
    ds_write_addtid_b32 v26 offset:25344
    v_sub_f32 v160, v60, v160
    v_mfma_f32_16x16x32_bf16 v[96:99], a[156:159], a[232:235], v[96:99]
    ds_read_b128 a[16:19], v254 offset:5632
    v_sub_f32 v161, v61, v161
    v_mfma_f32_16x16x32_bf16 v[96:99], a[152:155], a[228:231], v[96:99]
    ds_read_b128 a[20:23], v254 offset:5984
    v_sub_f32 v162, v62, v162
    v_mfma_f32_16x16x32_bf16 v[92:95], a[156:159], a[228:231], v[92:95]
    ds_write_addtid_b32 v27 offset:26368
    v_sub_f32 v163, v63, v163
    v_mfma_f32_16x16x32_bf16 v[92:95], a[152:155], a[224:227], v[92:95]
    buffer_load_dwordx4 a[148:151], v1, s[20:23], s68 offen offset:3072 sc1
    v_mfma_f32_16x16x32_bf16 v[88:91], a[156:159], a[224:227], v[88:91]
    s_add_u32 s68, s68, 4096
    ds_write_addtid_b32 v44 offset:27392
    v_mfma_f32_16x16x32_bf16 v[88:91], a[152:155], a[220:223], v[88:91]
    ds_write_addtid_b32 v45 offset:28416
    v_sub_f32 v20, v192, v20
    v_mfma_f32_16x16x32_bf16 v[84:87], a[156:159], a[220:223], v[84:87]
    ds_write_addtid_b32 v46 offset:29440
    v_sub_f32 v21, v193, v21
    v_mfma_f32_16x16x32_bf16 v[84:87], a[152:155], a[216:219], v[84:87]
    ds_write_addtid_b32 v47 offset:30464
    v_sub_f32 v22, v194, v22
    v_mfma_f32_16x16x32_bf16 v[104:107], a[160:163], a[216:219], v[104:107]
    buffer_load_dwordx4 a[152:155], v1, s[20:23], s68 offen offset:0 sc1
    v_mfma_f32_16x16x32_bf16 v[104:107], a[164:167], a[220:223], v[104:107]
    ds_write_addtid_b32 v160 offset:38144
    v_sub_f32 v23, v195, v23
    v_mfma_f32_16x16x32_bf16 v[108:111], a[160:163], a[220:223], v[108:111]
    ds_write_addtid_b32 v161 offset:39168
    v_sub_f32 v40, v212, v40
    v_mfma_f32_16x16x32_bf16 v[108:111], a[164:167], a[224:227], v[108:111]
    ds_write_addtid_b32 v162 offset:40192
    v_sub_f32 v41, v213, v41
    v_mfma_f32_16x16x32_bf16 v[112:115], a[160:163], a[224:227], v[112:115]
    ds_write_addtid_b32 v163 offset:41216
    v_sub_f32 v42, v214, v42
    v_mfma_f32_16x16x32_bf16 v[112:115], a[164:167], a[228:231], v[112:115]
    buffer_load_dwordx4 a[156:159], v1, s[20:23], s68 offen offset:1024 sc1
    v_mfma_f32_16x16x32_bf16 v[116:119], a[160:163], a[228:231], v[116:119]
    ds_write_addtid_b32 v20 offset:42240
    v_sub_f32 v43, v215, v43
    v_mfma_f32_16x16x32_bf16 v[116:119], a[164:167], a[232:235], v[116:119]
    ds_write_addtid_b32 v21 offset:43264
    v_sub_f32 v12, v56, v12
    v_mfma_f32_16x16x32_bf16 v[120:123], a[160:163], a[232:235], v[120:123]
    ds_write_addtid_b32 v22 offset:44288
    v_sub_f32 v13, v57, v13
    v_mfma_f32_16x16x32_bf16 v[120:123], a[164:167], a[236:239], v[120:123]
    s_waitcnt lgkmcnt(12)
    s_waitcnt vmcnt(28)
    v_mfma_f32_16x16x32_bf16 v[64:67], a[168:171], a[0:3], v[64:67]
    buffer_load_dwordx4 a[160:163], v1, s[20:23], s68 offen offset:2048 sc1
    v_mfma_f32_16x16x32_bf16 v[64:67], a[172:175], a[4:7], v[64:67]
    v_add_u32 v254, s70, v254
    ds_write_addtid_b32 v23 offset:45312
    v_mfma_f32_16x16x32_bf16 v[68:71], a[168:171], a[4:7], v[68:71]
    ds_read_b128 a[216:219], v254 offset:0
    v_sub_f32 v14, v58, v14
    v_mfma_f32_16x16x32_bf16 v[68:71], a[172:175], a[8:11], v[68:71]
    ds_read_b128 a[220:223], v254 offset:352
    v_sub_f32 v15, v59, v15
    v_mfma_f32_16x16x32_bf16 v[72:75], a[168:171], a[8:11], v[72:75]
    ds_write_addtid_b32 v40 offset:46336
    v_fma_f32 v180, 2.0, v180, -v168
    v_mfma_f32_16x16x32_bf16 v[72:75], a[172:175], a[12:15], v[72:75]
    buffer_load_dwordx4 a[164:167], v1, s[20:23], s68 offen offset:3072 sc1
    v_mfma_f32_16x16x32_bf16 v[76:79], a[168:171], a[12:15], v[76:79]
    s_add_u32 s68, s68, 4096
    ds_write_addtid_b32 v41 offset:47360
    v_mfma_f32_16x16x32_bf16 v[76:79], a[172:175], a[16:19], v[76:79]
    ds_read_b128 a[224:227], v254 offset:704
    v_fma_f32 v181, 2.0, v181, -v169
    v_mfma_f32_16x16x32_bf16 v[80:83], a[168:171], a[16:19], v[80:83]
    ds_read_b128 a[228:231], v254 offset:1056
    v_fma_f32 v182, 2.0, v182, -v170
    v_mfma_f32_16x16x32_bf16 v[80:83], a[172:175], a[20:23], v[80:83]
    ds_write_addtid_b32 v42 offset:48384
    v_fma_f32 v183, 2.0, v183, -v171
    v_mfma_f32_16x16x32_bf16 v[100:103], a[180:183], a[20:23], v[100:103]
    buffer_load_dwordx4 a[168:171], v1, s[20:23], s68 offen offset:0 sc1
    v_mfma_f32_16x16x32_bf16 v[100:103], a[176:179], a[16:19], v[100:103]
    ds_write_addtid_b32 v43 offset:49408
    v_fma_f32 v200, 2.0, v200, -v28
    v_mfma_f32_16x16x32_bf16 v[96:99], a[180:183], a[16:19], v[96:99]
    ds_read_b128 a[232:235], v254 offset:1408
    v_fma_f32 v201, 2.0, v201, -v29
    v_mfma_f32_16x16x32_bf16 v[96:99], a[176:179], a[12:15], v[96:99]
    ds_read_b128 a[236:239], v254 offset:1760
    v_fma_f32 v202, 2.0, v202, -v30
    v_mfma_f32_16x16x32_bf16 v[92:95], a[180:183], a[12:15], v[92:95]
    ds_write_addtid_b32 v180 offset:57344
    v_fma_f32 v203, 2.0, v203, -v31
    v_mfma_f32_16x16x32_bf16 v[92:95], a[176:179], a[8:11], v[92:95]
    buffer_load_dwordx4 a[172:175], v1, s[20:23], s68 offen offset:1024 sc1
    v_mfma_f32_16x16x32_bf16 v[88:91], a[180:183], a[8:11], v[88:91]
    ds_write_addtid_b32 v181 offset:58368
    v_fma_f32 v240, 2.0, v240, -v48
    v_mfma_f32_16x16x32_bf16 v[88:91], a[176:179], a[4:7], v[88:91]
    ds_write_addtid_b32 v182 offset:59392
    v_fma_f32 v241, 2.0, v241, -v49
    v_mfma_f32_16x16x32_bf16 v[84:87], a[180:183], a[4:7], v[84:87]
    ds_write_addtid_b32 v183 offset:60416
    v_fma_f32 v242, 2.0, v242, -v50
    v_mfma_f32_16x16x32_bf16 v[84:87], a[176:179], a[0:3], v[84:87]
    ds_write_addtid_b32 v200 offset:61440
    v_fma_f32 v243, 2.0, v243, -v51
    v_mfma_f32_16x16x32_bf16 v[104:107], a[184:187], a[0:3], v[104:107]
    buffer_load_dwordx4 a[176:179], v1, s[20:23], s68 offen offset:2048 sc1
    v_mfma_f32_16x16x32_bf16 v[104:107], a[188:191], a[4:7], v[104:107]
    ds_write_addtid_b32 v201 offset:62464
    v_fma_f32 v176, 2.0, v176, -v164
    v_mfma_f32_16x16x32_bf16 v[108:111], a[184:187], a[4:7], v[108:111]
    ds_write_addtid_b32 v202 offset:63488
    v_fma_f32 v177, 2.0, v177, -v165
    v_mfma_f32_16x16x32_bf16 v[108:111], a[188:191], a[8:11], v[108:111]
    ds_write_addtid_b32 v203 offset:64512
    v_fma_f32 v178, 2.0, v178, -v166
    v_mfma_f32_16x16x32_bf16 v[112:115], a[184:187], a[8:11], v[112:115]
    s_waitcnt lgkmcnt(10)
    s_barrier
    v_mfma_f32_16x16x32_bf16 v[112:115], a[188:191], a[12:15], v[112:115]
    buffer_load_dwordx4 a[180:183], v1, s[20:23], s68 offen offset:3072 sc1
    v_mfma_f32_16x16x32_bf16 v[116:119], a[184:187], a[12:15], v[116:119]
    s_add_u32 s68, s68, 4096
    ds_read2st64_b32 v[124:125], v153 offset0:0 offset1:4
    v_mfma_f32_16x16x32_bf16 v[116:119], a[188:191], a[16:19], v[116:119]
    ds_read2st64_b32 v[126:127], v153 offset0:8 offset1:12
    s_add_u32 m0, m0, 64512
    v_mfma_f32_16x16x32_bf16 v[120:123], a[184:187], a[16:19], v[120:123]
    ds_write_addtid_b32 v240 offset:1024
    v_fma_f32 v179, 2.0, v179, -v167
L_pg7:
    s_cbranch_execz L_warmed
    v_mfma_f32_16x16x32_bf16 v[120:123], a[188:191], a[20:23], v[120:123]
    s_waitcnt lgkmcnt(11)
    s_waitcnt vmcnt(28)
    v_mfma_f32_16x16x32_bf16 v[64:67], a[192:195], a[216:219], v[64:67]
    buffer_load_dwordx4 a[184:187], v1, s[20:23], s68 offen offset:0 sc1
    v_mfma_f32_16x16x32_bf16 v[64:67], a[196:199], a[220:223], v[64:67]
    ds_write_addtid_b32 v241 offset:2048
    v_fma_f32 v196, 2.0, v196, -v24
    v_mfma_f32_16x16x32_bf16 v[68:71], a[192:195], a[220:223], v[68:71]
    ds_read_b128 a[0:3], v254 offset:2112
    v_fma_f32 v197, 2.0, v197, -v25
    v_mfma_f32_16x16x32_bf16 v[68:71], a[196:199], a[224:227], v[68:71]
    ds_read_b128 a[4:7], v254 offset:2464
    v_fma_f32 v198, 2.0, v198, -v26
    v_mfma_f32_16x16x32_bf16 v[72:75], a[192:195], a[224:227], v[72:75]
    ds_write_addtid_b32 v242 offset:3072
    v_fma_f32 v199, 2.0, v199, -v27
    v_mfma_f32_16x16x32_bf16 v[72:75], a[196:199], a[228:231], v[72:75]
    buffer_load_dwordx4 a[188:191], v1, s[20:23], s68 offen offset:1024 sc1
    v_mfma_f32_16x16x32_bf16 v[76:79], a[192:195], a[228:231], v[76:79]
    ds_write_addtid_b32 v243 offset:4096
    v_fma_f32 v148, 2.0, v148, -v44
    v_mfma_f32_16x16x32_bf16 v[76:79], a[196:199], a[232:235], v[76:79]
    ds_read_b128 a[8:11], v254 offset:2816
    v_fma_f32 v149, 2.0, v149, -v45
    v_mfma_f32_16x16x32_bf16 v[80:83], a[192:195], a[232:235], v[80:83]
    ds_read_b128 a[12:15], v254 offset:3168
    v_fma_f32 v150, 2.0, v150, -v46
    v_mfma_f32_16x16x32_bf16 v[80:83], a[196:199], a[236:239], v[80:83]
    ds_write_addtid_b32 v176 offset:11776
    v_fma_f32 v151, 2.0, v151, -v47
    v_mfma_f32_16x16x32_bf16 v[100:103], a[204:207], a[236:239], v[100:103]
    buffer_load_dwordx4 a[192:195], v1, s[20:23], s68 offen offset:2048 sc1
    v_mfma_f32_16x16x32_bf16 v[100:103], a[200:203], a[232:235], v[100:103]
    ds_write_addtid_b32 v177 offset:12800
    v_fma_f32 v60, 2.0, v60, -v160
    v_mfma_f32_16x16x32_bf16 v[96:99], a[204:207], a[232:235], v[96:99]
    ds_read_b128 a[16:19], v254 offset:3520
    v_fma_f32 v61, 2.0, v61, -v161
    v_mfma_f32_16x16x32_bf16 v[96:99], a[200:203], a[228:231], v[96:99]
    ds_read_b128 a[20:23], v254 offset:3872
    v_fma_f32 v62, 2.0, v62, -v162
    v_mfma_f32_16x16x32_bf16 v[92:95], a[204:207], a[228:231], v[92:95]
    ds_write_addtid_b32 v178 offset:13824
    v_fma_f32 v63, 2.0, v63, -v163
    v_mfma_f32_16x16x32_bf16 v[92:95], a[200:203], a[224:227], v[92:95]
    buffer_load_dwordx4 a[196:199], v1, s[20:23], s68 offen offset:3072 sc1
    v_mfma_f32_16x16x32_bf16 v[88:91], a[204:207], a[224:227], v[88:91]
    s_add_u32 s68, s68, 4096
    ds_write_addtid_b32 v179 offset:14848
    v_mfma_f32_16x16x32_bf16 v[88:91], a[200:203], a[220:223], v[88:91]
    ds_write_addtid_b32 v196 offset:15872
    v_fma_f32 v192, 2.0, v192, -v20
    v_mfma_f32_16x16x32_bf16 v[84:87], a[204:207], a[220:223], v[84:87]
    ds_write_addtid_b32 v197 offset:16896
    v_fma_f32 v193, 2.0, v193, -v21
    v_mfma_f32_16x16x32_bf16 v[84:87], a[200:203], a[216:219], v[84:87]
    ds_write_addtid_b32 v198 offset:17920
    v_fma_f32 v194, 2.0, v194, -v22
    v_mfma_f32_16x16x32_bf16 v[104:107], a[208:211], a[216:219], v[104:107]
    buffer_load_dwordx4 a[200:203], v1, s[20:23], s68 offen offset:0 sc1
    v_mfma_f32_16x16x32_bf16 v[104:107], a[212:215], a[220:223], v[104:107]
    ds_write_addtid_b32 v199 offset:18944
    v_fma_f32 v195, 2.0, v195, -v23
    v_mfma_f32_16x16x32_bf16 v[108:111], a[208:211], a[220:223], v[108:111]
    ds_write_addtid_b32 v148 offset:19968
    v_fma_f32 v212, 2.0, v212, -v40
    v_mfma_f32_16x16x32_bf16 v[108:111], a[212:215], a[224:227], v[108:111]
    ds_write_addtid_b32 v149 offset:20992
    v_fma_f32 v213, 2.0, v213, -v41
    v_mfma_f32_16x16x32_bf16 v[112:115], a[208:211], a[224:227], v[112:115]
    ds_write_addtid_b32 v150 offset:22016
    v_fma_f32 v214, 2.0, v214, -v42
    v_mfma_f32_16x16x32_bf16 v[112:115], a[212:215], a[228:231], v[112:115]
    buffer_load_dwordx4 a[204:207], v1, s[20:23], s68 offen offset:1024 sc1
    v_mfma_f32_16x16x32_bf16 v[116:119], a[208:211], a[228:231], v[116:119]
    ds_write_addtid_b32 v151 offset:23040
    v_fma_f32 v215, 2.0, v215, -v43
    v_mfma_f32_16x16x32_bf16 v[116:119], a[212:215], a[232:235], v[116:119]
    ds_write_addtid_b32 v60 offset:30976
    v_sub_f32 v16, v188, v16
    v_mfma_f32_16x16x32_bf16 v[120:123], a[208:211], a[232:235], v[120:123]
    ds_write_addtid_b32 v61 offset:32000
    v_sub_f32 v17, v189, v17
    v_mfma_f32_16x16x32_bf16 v[120:123], a[212:215], a[236:239], v[120:123]
    s_waitcnt lgkmcnt(12)
    s_waitcnt vmcnt(28)
    v_mfma_f32_16x16x32_bf16 v[64:67], a[96:99], a[0:3], v[64:67]
    buffer_load_dwordx4 a[208:211], v1, s[20:23], s68 offen offset:2048 sc1
    v_mfma_f32_16x16x32_bf16 v[64:67], a[100:103], a[4:7], v[64:67]
    ds_write_addtid_b32 v62 offset:33024
    v_sub_f32 v18, v190, v18
    v_mfma_f32_16x16x32_bf16 v[68:71], a[96:99], a[4:7], v[68:71]
    ds_read_b128 a[216:219], v254 offset:4224
    v_sub_f32 v19, v191, v19
    v_mfma_f32_16x16x32_bf16 v[68:71], a[100:103], a[8:11], v[68:71]
    ds_read_b128 a[220:223], v254 offset:4576
    v_sub_f32 v36, v208, v36
    v_mfma_f32_16x16x32_bf16 v[72:75], a[96:99], a[8:11], v[72:75]
    ds_write_addtid_b32 v63 offset:34048
    v_sub_f32 v37, v209, v37
    v_mfma_f32_16x16x32_bf16 v[72:75], a[100:103], a[12:15], v[72:75]
    buffer_load_dwordx4 a[212:215], v1, s[20:23], s68 offen offset:3072 sc1
    v_mfma_f32_16x16x32_bf16 v[76:79], a[96:99], a[12:15], v[76:79]
    s_add_u32 s68, s68, 4096
    ds_write_addtid_b32 v192 offset:35072
    v_mfma_f32_16x16x32_bf16 v[76:79], a[100:103], a[16:19], v[76:79]
    ds_read_b128 a[224:227], v254 offset:4928
    v_sub_f32 v38, v210, v38
    v_mfma_f32_16x16x32_bf16 v[80:83], a[96:99], a[16:19], v[80:83]
    ds_read_b128 a[228:231], v254 offset:5280
    v_sub_f32 v39, v211, v39
    v_mfma_f32_16x16x32_bf16 v[80:83], a[100:103], a[20:23], v[80:83]
    ds_write_addtid_b32 v193 offset:36096
    v_sub_f32 v8, v52, v8
    v_mfma_f32_16x16x32_bf16 v[100:103], a[108:111], a[20:23], v[100:103]
    buffer_load_dwordx4 a[96:99], v1, s[20:23], s68 offen offset:0 sc1
    v_mfma_f32_16x16x32_bf16 v[100:103], a[104:107], a[16:19], v[100:103]
    ds_write_addtid_b32 v194 offset:37120
    v_sub_f32 v9, v53, v9
    v_mfma_f32_16x16x32_bf16 v[96:99], a[108:111], a[16:19], v[96:99]
    ds_read_b128 a[232:235], v254 offset:5632
    v_sub_f32 v10, v54, v10
    v_mfma_f32_16x16x32_bf16 v[96:99], a[104:107], a[12:15], v[96:99]
    ds_read_b128 a[236:239], v254 offset:5984
    v_sub_f32 v11, v55, v11
    v_mfma_f32_16x16x32_bf16 v[92:95], a[108:111], a[12:15], v[92:95]
    ds_write_addtid_b32 v195 offset:38144
    v_sub_f32 v172, v184, v172
    v_mfma_f32_16x16x32_bf16 v[92:95], a[104:107], a[8:11], v[92:95]
    buffer_load_dwordx4 a[100:103], v1, s[20:23], s68 offen offset:1024 sc1
    v_mfma_f32_16x16x32_bf16 v[88:91], a[108:111], a[8:11], v[88:91]
    ds_write_addtid_b32 v212 offset:39168
    v_sub_f32 v173, v185, v173
    v_mfma_f32_16x16x32_bf16 v[88:91], a[104:107], a[4:7], v[88:91]
    ds_write_addtid_b32 v213 offset:40192
    v_sub_f32 v174, v186, v174
    v_mfma_f32_16x16x32_bf16 v[84:87], a[108:111], a[4:7], v[84:87]
    ds_write_addtid_b32 v214 offset:41216
    v_sub_f32 v175, v187, v175
    v_mfma_f32_16x16x32_bf16 v[84:87], a[104:107], a[0:3], v[84:87]
    ds_write_addtid_b32 v215 offset:42240
    v_sub_f32 v32, v204, v32
    v_mfma_f32_16x16x32_bf16 v[104:107], a[112:115], a[0:3], v[104:107]
    buffer_load_dwordx4 a[104:107], v1, s[20:23], s68 offen offset:2048 sc1
    v_mfma_f32_16x16x32_bf16 v[104:107], a[116:119], a[4:7], v[104:107]
    ds_read2st64_b32 v[128:129], v153 offset0:16 offset1:20
    v_sub_f32 v33, v205, v33
    v_mfma_f32_16x16x32_bf16 v[108:111], a[112:115], a[4:7], v[108:111]
    ds_read2st64_b32 v[130:131], v153 offset0:24 offset1:28
    v_sub_f32 v34, v206, v34
    v_mfma_f32_16x16x32_bf16 v[108:111], a[116:119], a[8:11], v[108:111]
    ds_read2st64_b32 v[132:133], v153 offset0:32 offset1:36
    v_sub_f32 v35, v207, v35
    v_mfma_f32_16x16x32_bf16 v[112:115], a[112:115], a[8:11], v[112:115]
    ds_read2st64_b32 v[134:135], v153 offset0:40 offset1:44
    v_fma_f32 v56, 2.0, v56, -v12
    v_mfma_f32_16x16x32_bf16 v[112:115], a[116:119], a[12:15], v[112:115]
    buffer_load_dwordx4 a[108:111], v1, s[20:23], s68 offen offset:3072 sc1
    v_mfma_f32_16x16x32_bf16 v[116:119], a[112:115], a[12:15], v[116:119]
    s_add_u32 s68, s68, 4096
    ds_write_addtid_b32 v56 offset:49920
    v_mfma_f32_16x16x32_bf16 v[116:119], a[116:119], a[16:19], v[116:119]
    ds_read2st64_b32 v[136:137], v153 offset0:75 offset1:79
    v_fma_f32 v57, 2.0, v57, -v13
    v_mfma_f32_16x16x32_bf16 v[120:123], a[112:115], a[16:19], v[120:123]
    ds_write_addtid_b32 v57 offset:50944
    v_fma_f32 v58, 2.0, v58, -v14
    v_mfma_f32_16x16x32_bf16 v[120:123], a[116:119], a[20:23], v[120:123]
    s_waitcnt lgkmcnt(12)
    s_waitcnt vmcnt(28)
    v_mfma_f32_16x16x32_bf16 v[64:67], a[120:123], a[216:219], v[64:67]
    buffer_load_dwordx4 a[112:115], v1, s[20:23], s68 offen offset:0 sc1
    v_mfma_f32_16x16x32_bf16 v[64:67], a[124:127], a[220:223], v[64:67]
    v_add_u32 v254, s70, v254
    ds_write_addtid_b32 v58 offset:51968
    v_mfma_f32_16x16x32_bf16 v[68:71], a[120:123], a[220:223], v[68:71]
    ds_read_b128 a[0:3], v254 offset:0
    v_fma_f32 v59, 2.0, v59, -v15
    v_mfma_f32_16x16x32_bf16 v[68:71], a[124:127], a[224:227], v[68:71]
    ds_read_b128 a[4:7], v254 offset:352
    v_fma_f32 v188, 2.0, v188, -v16
    v_mfma_f32_16x16x32_bf16 v[72:75], a[120:123], a[224:227], v[72:75]
    ds_write_addtid_b32 v59 offset:52992
    v_fma_f32 v189, 2.0, v189, -v17
    v_mfma_f32_16x16x32_bf16 v[72:75], a[124:127], a[228:231], v[72:75]
    buffer_load_dwordx4 a[116:119], v1, s[20:23], s68 offen offset:1024 sc1
    v_mfma_f32_16x16x32_bf16 v[76:79], a[120:123], a[228:231], v[76:79]
    ds_write_addtid_b32 v188 offset:54016
    v_fma_f32 v190, 2.0, v190, -v18
    v_mfma_f32_16x16x32_bf16 v[76:79], a[124:127], a[232:235], v[76:79]
    ds_read_b128 a[8:11], v254 offset:704
    v_fma_f32 v191, 2.0, v191, -v19
    v_mfma_f32_16x16x32_bf16 v[80:83], a[120:123], a[232:235], v[80:83]
    ds_read_b128 a[12:15], v254 offset:1056
    v_fma_f32 v208, 2.0, v208, -v36
    v_mfma_f32_16x16x32_bf16 v[80:83], a[124:127], a[236:239], v[80:83]
    ds_write_addtid_b32 v189 offset:55040
    v_fma_f32 v209, 2.0, v209, -v37
    v_mfma_f32_16x16x32_bf16 v[100:103], a[132:135], a[236:239], v[100:103]
    buffer_load_dwordx4 a[120:123], v1, s[20:23], s68 offen offset:2048 sc1
    v_mfma_f32_16x16x32_bf16 v[100:103], a[128:131], a[232:235], v[100:103]
    ds_write_addtid_b32 v190 offset:56064
    v_fma_f32 v210, 2.0, v210, -v38
    v_mfma_f32_16x16x32_bf16 v[96:99], a[132:135], a[232:235], v[96:99]
    ds_read_b128 a[16:19], v254 offset:1408
    v_fma_f32 v211, 2.0, v211, -v39
    v_mfma_f32_16x16x32_bf16 v[96:99], a[128:131], a[228:231], v[96:99]
    ds_read_b128 a[20:23], v254 offset:1760
    v_fma_f32 v52, 2.0, v52, -v8
    v_mfma_f32_16x16x32_bf16 v[92:95], a[132:135], a[228:231], v[92:95]
    ds_write_addtid_b32 v191 offset:57088
    v_fma_f32 v53, 2.0, v53, -v9
    v_mfma_f32_16x16x32_bf16 v[92:95], a[128:131], a[224:227], v[92:95]
    buffer_load_dwordx4 a[124:127], v1, s[20:23], s68 offen offset:3072 sc1
    v_mfma_f32_16x16x32_bf16 v[88:91], a[132:135], a[224:227], v[88:91]
    s_add_u32 s68, s68, 4096
    ds_write_addtid_b32 v208 offset:58112
    v_mfma_f32_16x16x32_bf16 v[88:91], a[128:131], a[220:223], v[88:91]
    ds_write_addtid_b32 v209 offset:59136
    v_fma_f32 v54, 2.0, v54, -v10
    v_mfma_f32_16x16x32_bf16 v[84:87], a[132:135], a[220:223], v[84:87]
    ds_write_addtid_b32 v210 offset:60160
    v_fma_f32 v55, 2.0, v55, -v11
    v_mfma_f32_16x16x32_bf16 v[84:87], a[128:131], a[216:219], v[84:87]
    ds_write_addtid_b32 v211 offset:61184
    v_fma_f32 v184, 2.0, v184, -v172
    v_mfma_f32_16x16x32_bf16 v[104:107], a[136:139], a[216:219], v[104:107]
    buffer_load_dwordx4 a[128:131], v1, s[20:23], s68 offen offset:0 sc1
    v_mfma_f32_16x16x32_bf16 v[104:107], a[140:143], a[220:223], v[104:107]
    ds_write_b32 v152, v52 offset:0
    v_mfma_f32_16x16x32_bf16 v[108:111], a[136:139], a[220:223], v[108:111]
    ds_write_b32 v152, v53 offset:1024
    v_mfma_f32_16x16x32_bf16 v[108:111], a[140:143], a[224:227], v[108:111]
    ds_write_b32 v152, v54 offset:2048
    v_mfma_f32_16x16x32_bf16 v[112:115], a[136:139], a[224:227], v[112:115]
    ds_write_b32 v152, v55 offset:3072
    v_mfma_f32_16x16x32_bf16 v[112:115], a[140:143], a[228:231], v[112:115]
    buffer_load_dwordx4 a[132:135], v1, s[20:23], s68 offen offset:1024 sc1
    v_mfma_f32_16x16x32_bf16 v[116:119], a[136:139], a[228:231], v[116:119]
    ds_write_b32 v152, v184 offset:4096
    v_mfma_f32_16x16x32_bf16 v[116:119], a[140:143], a[232:235], v[116:119]
    ds_read2st64_b32 v[138:139], v153 offset0:83 offset1:87
    v_fma_f32 v185, 2.0, v185, -v173
    v_mfma_f32_16x16x32_bf16 v[120:123], a[136:139], a[232:235], v[120:123]
    ds_write_b32 v152, v185 offset:5120
    v_mfma_f32_16x16x32_bf16 v[120:123], a[140:143], a[236:239], v[120:123]
    s_waitcnt lgkmcnt(12)
    s_waitcnt vmcnt(28)
    v_mfma_f32_16x16x32_bf16 v[64:67], a[72:75], a[0:3], v[64:67]
    buffer_load_dwordx4 a[136:139], v1, s[20:23], s68 offen offset:2048 sc1
    v_mfma_f32_16x16x32_bf16 v[64:67], a[76:79], a[4:7], v[64:67]
    ds_read2st64_b32 v[140:141], v153 offset0:91 offset1:95
    v_fma_f32 v186, 2.0, v186, -v174
    v_mfma_f32_16x16x32_bf16 v[68:71], a[72:75], a[4:7], v[68:71]
    ds_read_b128 a[216:219], v254 offset:2112
    v_fma_f32 v187, 2.0, v187, -v175
    v_mfma_f32_16x16x32_bf16 v[68:71], a[76:79], a[8:11], v[68:71]
    ds_read_b128 a[220:223], v254 offset:2464
    v_fma_f32 v204, 2.0, v204, -v32
    v_mfma_f32_16x16x32_bf16 v[72:75], a[72:75], a[8:11], v[72:75]
    ds_write_b32 v152, v186 offset:6144
    v_mfma_f32_16x16x32_bf16 v[72:75], a[76:79], a[12:15], v[72:75]
    buffer_load_dwordx4 a[140:143], v1, s[20:23], s68 offen offset:3072 sc1
    v_mfma_f32_16x16x32_bf16 v[76:79], a[72:75], a[12:15], v[76:79]
    s_add_u32 s68, s68, 4096
    ds_read2st64_b32 v[142:143], v153 offset0:99 offset1:103
    v_mfma_f32_16x16x32_bf16 v[76:79], a[76:79], a[16:19], v[76:79]
    ds_read_b128 a[224:227], v254 offset:2816
    v_fma_f32 v205, 2.0, v205, -v33
    v_mfma_f32_16x16x32_bf16 v[80:83], a[72:75], a[16:19], v[80:83]
    ds_read_b128 a[228:231], v254 offset:3168
    v_fma_f32 v206, 2.0, v206, -v34
    v_mfma_f32_16x16x32_bf16 v[80:83], a[76:79], a[20:23], v[80:83]
    ds_write_b32 v152, v187 offset:7168
    v_mfma_f32_16x16x32_bf16 v[100:103], a[84:87], a[20:23], v[100:103]
    buffer_load_dwordx4 a[72:75], v1, s[20:23], s68 offen offset:0 sc1
    v_mfma_f32_16x16x32_bf16 v[100:103], a[80:83], a[16:19], v[100:103]
    ds_write_b32 v152, v204 offset:8192
    v_mfma_f32_16x16x32_bf16 v[96:99], a[84:87], a[16:19], v[96:99]
    ds_read_b128 a[232:235], v254 offset:3520
    v_fma_f32 v207, 2.0, v207, -v35
    v_mfma_f32_16x16x32_bf16 v[96:99], a[80:83], a[12:15], v[96:99]
    ds_read_b128 a[236:239], v254 offset:3872
    v_add_f32 v8, v8, v124
    v_mfma_f32_16x16x32_bf16 v[92:95], a[84:87], a[12:15], v[92:95]
    ds_write_b32 v152, v205 offset:9216
    v_mfma_f32_16x16x32_bf16 v[92:95], a[80:83], a[8:11], v[92:95]
    buffer_load_dwordx4 a[76:79], v1, s[20:23], s68 offen offset:1024 sc1
    v_mfma_f32_16x16x32_bf16 v[88:91], a[84:87], a[8:11], v[88:91]
    ds_write_b32 v152, v206 offset:10240
    v_mfma_f32_16x16x32_bf16 v[88:91], a[80:83], a[4:7], v[88:91]
    ds_write_b32 v152, v207 offset:11264
    v_mfma_f32_16x16x32_bf16 v[84:87], a[84:87], a[4:7], v[84:87]
    ds_read2st64_b32 v[144:145], v153 offset0:107 offset1:111
    v_add_f32 v9, v9, v125
    v_mfma_f32_16x16x32_bf16 v[84:87], a[80:83], a[0:3], v[84:87]
    ds_read2st64_b32 v[146:147], v153 offset0:115 offset1:119
    v_add_f32 v10, v10, v126
    v_mfma_f32_16x16x32_bf16 v[104:107], a[88:91], a[0:3], v[104:107]
    buffer_load_dwordx4 a[80:83], v1, s[20:23], s68 offen offset:2048 sc1
    v_mfma_f32_16x16x32_bf16 v[104:107], a[92:95], a[4:7], v[104:107]
    ds_read2st64_b32 v[216:217], v153 offset0:149 offset1:153
    v_add_f32 v11, v11, v127
    v_mfma_f32_16x16x32_bf16 v[108:111], a[88:91], a[4:7], v[108:111]
    ds_read2st64_b32 v[218:219], v153 offset0:157 offset1:161
    v_cvt_pk_bf16_f32 v8, v8, v9
    v_mfma_f32_16x16x32_bf16 v[108:111], a[92:95], a[8:11], v[108:111]
    ds_bpermute_b32 v168, v156, v8
    v_mfma_f32_16x16x32_bf16 v[112:115], a[88:91], a[8:11], v[112:115]
    s_waitcnt lgkmcnt(5)
    s_barrier
    v_mfma_f32_16x16x32_bf16 v[112:115], a[92:95], a[12:15], v[112:115]
    buffer_load_dwordx4 a[84:87], v1, s[20:23], s68 offen offset:3072 sc1
    v_mfma_f32_16x16x32_bf16 v[116:119], a[88:91], a[12:15], v[116:119]
    s_add_u32 s68, s68, 4096
    ds_read2st64_b32 v[220:221], v153 offset0:165 offset1:169
    v_mfma_f32_16x16x32_bf16 v[116:119], a[92:95], a[16:19], v[116:119]
    ds_read2st64_b32 v[222:223], v153 offset0:173 offset1:177
    v_cvt_pk_bf16_f32 v9, v10, v11
    v_mfma_f32_16x16x32_bf16 v[120:123], a[88:91], a[16:19], v[120:123]
    ds_bpermute_b32 v169, v156, v9
    v_mfma_f32_16x16x32_bf16 v[120:123], a[92:95], a[20:23], v[120:123]
    s_waitcnt vmcnt(28)
    v_mfma_f32_16x16x32_bf16 v[64:67], a[144:147], a[216:219], v[64:67]
    buffer_load_dwordx4 a[88:91], v1, s[20:23], s68 offen offset:0 sc1
    v_mfma_f32_16x16x32_bf16 v[64:67], a[148:151], a[220:223], v[64:67]
    ds_read2st64_b32 v[224:225], v153 offset0:181 offset1:185
    v_add_f32 v172, v172, v128
    v_mfma_f32_16x16x32_bf16 v[68:71], a[144:147], a[220:223], v[68:71]
    ds_read_b128 a[0:3], v254 offset:4224
    v_add_f32 v173, v173, v129
    v_mfma_f32_16x16x32_bf16 v[68:71], a[148:151], a[224:227], v[68:71]
    ds_read_b128 a[4:7], v254 offset:4576
    v_add_f32 v174, v174, v130
    v_mfma_f32_16x16x32_bf16 v[72:75], a[144:147], a[224:227], v[72:75]
    ds_read2st64_b32 v[226:227], v153 offset0:189 offset1:193
    v_add_f32 v175, v175, v131
    v_mfma_f32_16x16x32_bf16 v[72:75], a[148:151], a[228:231], v[72:75]
    buffer_load_dwordx4 a[92:95], v1, s[20:23], s68 offen offset:1024 sc1
    v_mfma_f32_16x16x32_bf16 v[76:79], a[144:147], a[228:231], v[76:79]
    ds_read2st64_b32 v[228:229], v247 offset0:0 offset1:4
    v_cvt_pk_bf16_f32 v172, v172, v173
    v_mfma_f32_16x16x32_bf16 v[76:79], a[148:151], a[232:235], v[76:79]
    ds_read_b128 a[8:11], v254 offset:4928
    v_cvt_pk_bf16_f32 v173, v174, v175
    v_mfma_f32_16x16x32_bf16 v[80:83], a[144:147], a[232:235], v[80:83]
    ds_read_b128 a[12:15], v254 offset:5280
    v_add_f32 v32, v32, v132
    v_mfma_f32_16x16x32_bf16 v[80:83], a[148:151], a[236:239], v[80:83]
    ds_bpermute_b32 v170, v156, v172
    v_mfma_f32_16x16x32_bf16 v[100:103], a[156:159], a[236:239], v[100:103]
    buffer_load_dwordx4 a[144:147], v1, s[20:23], s68 offen offset:2048 sc1
    v_mfma_f32_16x16x32_bf16 v[100:103], a[152:155], a[232:235], v[100:103]
    ds_bpermute_b32 v171, v156, v173
    v_mfma_f32_16x16x32_bf16 v[96:99], a[156:159], a[232:235], v[96:99]
    ds_read_b128 a[16:19], v254 offset:5632
    v_add_f32 v33, v33, v133
    v_mfma_f32_16x16x32_bf16 v[96:99], a[152:155], a[228:231], v[96:99]
    ds_read_b128 a[20:23], v254 offset:5984
    v_add_f32 v34, v34, v134
    v_mfma_f32_16x16x32_bf16 v[92:95], a[156:159], a[228:231], v[92:95]
    ds_read2st64_b32 v[230:231], v247 offset0:8 offset1:12
    v_add_f32 v35, v35, v135
    v_mfma_f32_16x16x32_bf16 v[92:95], a[152:155], a[224:227], v[92:95]
    buffer_load_dwordx4 a[148:151], v1, s[20:23], s68 offen offset:3072 sc1
    v_mfma_f32_16x16x32_bf16 v[88:91], a[156:159], a[224:227], v[88:91]
    s_add_u32 s68, s68, 4096
    ds_read2st64_b32 v[232:233], v247 offset0:16 offset1:20
    v_mfma_f32_16x16x32_bf16 v[88:91], a[152:155], a[220:223], v[88:91]
    ds_read2st64_b32 v[234:235], v247 offset0:24 offset1:28
    v_cvt_pk_bf16_f32 v32, v32, v33
    v_mfma_f32_16x16x32_bf16 v[84:87], a[156:159], a[220:223], v[84:87]
    ds_bpermute_b32 v28, v156, v32
    v_mfma_f32_16x16x32_bf16 v[84:87], a[152:155], a[216:219], v[84:87]
    ds_read2st64_b32 v[236:237], v247 offset0:32 offset1:36
    v_cvt_pk_bf16_f32 v33, v34, v35
    v_mfma_f32_16x16x32_bf16 v[104:107], a[160:163], a[216:219], v[104:107]
    buffer_load_dwordx4 a[152:155], v1, s[20:23], s68 offen offset:0 sc1
    v_mfma_f32_16x16x32_bf16 v[104:107], a[164:167], a[220:223], v[104:107]
    ds_bpermute_b32 v29, v156, v33
    v_mfma_f32_16x16x32_bf16 v[108:111], a[160:163], a[220:223], v[108:111]
    ds_read2st64_b32 v[238:239], v247 offset0:40 offset1:44
    s_waitcnt lgkmcnt(15)
    v_add_f32 v12, v12, v136
    v_mfma_f32_16x16x32_bf16 v[108:111], a[164:167], a[224:227], v[108:111]
    ds_read2st64_b32 v[124:125], v247 offset0:74 offset1:78
    v_add_f32 v13, v13, v137
    v_mfma_f32_16x16x32_bf16 v[112:115], a[160:163], a[224:227], v[112:115]
    ds_read2st64_b32 v[126:127], v247 offset0:82 offset1:86
    v_add_f32 v14, v14, v138
    v_mfma_f32_16x16x32_bf16 v[112:115], a[164:167], a[228:231], v[112:115]
    buffer_load_dwordx4 a[156:159], v1, s[20:23], s68 offen offset:1024 sc1
    v_mfma_f32_16x16x32_bf16 v[116:119], a[160:163], a[228:231], v[116:119]
    ds_read2st64_b32 v[128:129], v247 offset0:90 offset1:94
    v_add_f32 v15, v15, v139
    v_mfma_f32_16x16x32_bf16 v[116:119], a[164:167], a[232:235], v[116:119]
    ds_read2st64_b32 v[130:131], v247 offset0:98 offset1:102
    v_cvt_pk_bf16_f32 v12, v12, v13
    v_mfma_f32_16x16x32_bf16 v[120:123], a[160:163], a[232:235], v[120:123]
    ds_bpermute_b32 v48, v156, v12
    v_mfma_f32_16x16x32_bf16 v[120:123], a[164:167], a[236:239], v[120:123]
    s_waitcnt lgkmcnt(12)
    s_waitcnt vmcnt(28)
    v_mfma_f32_16x16x32_bf16 v[64:67], a[168:171], a[0:3], v[64:67]
    buffer_load_dwordx4 a[160:163], v1, s[20:23], s68 offen offset:2048 sc1
    v_mfma_f32_16x16x32_bf16 v[64:67], a[172:175], a[4:7], v[64:67]
    v_add_u32 v254, s70, v254
    ds_read2st64_b32 v[132:133], v247 offset0:106 offset1:110
    v_mfma_f32_16x16x32_bf16 v[68:71], a[168:171], a[4:7], v[68:71]
    v_add_u32 v244, s51, v254
    ds_read_b128 a[216:219], v244 offset:0
    v_mfma_f32_16x16x32_bf16 v[68:71], a[172:175], a[8:11], v[68:71]
    ds_read_b128 a[220:223], v244 offset:352
    v_cvt_pk_bf16_f32 v13, v14, v15
    v_mfma_f32_16x16x32_bf16 v[72:75], a[168:171], a[8:11], v[72:75]
    ds_bpermute_b32 v49, v156, v13
    v_mfma_f32_16x16x32_bf16 v[72:75], a[172:175], a[12:15], v[72:75]
    buffer_load_dwordx4 a[164:167], v1, s[20:23], s68 offen offset:3072 sc1
    v_mfma_f32_16x16x32_bf16 v[76:79], a[168:171], a[12:15], v[76:79]
    s_add_u32 s68, s68, 4096
    ds_read2st64_b32 v[134:135], v247 offset0:114 offset1:118
    v_mfma_f32_16x16x32_bf16 v[76:79], a[172:175], a[16:19], v[76:79]
    ds_read_b128 a[224:227], v244 offset:704
    v_add_f32 v16, v16, v140
    v_mfma_f32_16x16x32_bf16 v[80:83], a[168:171], a[16:19], v[80:83]
    ds_read_b128 a[228:231], v244 offset:1056
    v_add_f32 v17, v17, v141
    v_mfma_f32_16x16x32_bf16 v[80:83], a[172:175], a[20:23], v[80:83]
    v_add_f32 v18, v18, v142
    v_add_f32 v19, v19, v143
    v_mfma_f32_16x16x32_bf16 v[100:103], a[180:183], a[20:23], v[100:103]
    buffer_load_dwordx4 a[168:171], v1, s[20:23], s68 offen offset:0 sc1
    v_mfma_f32_16x16x32_bf16 v[100:103], a[176:179], a[16:19], v[100:103]
    v_cvt_pk_bf16_f32 v16, v16, v17
    v_cvt_pk_bf16_f32 v17, v18, v19
    v_mfma_f32_16x16x32_bf16 v[96:99], a[180:183], a[16:19], v[96:99]
    ds_read_b128 a[232:235], v244 offset:1408
    v_add_f32 v36, v36, v144
    v_mfma_f32_16x16x32_bf16 v[96:99], a[176:179], a[12:15], v[96:99]
    ds_read_b128 a[236:239], v244 offset:1760
    v_add_f32 v37, v37, v145
    v_mfma_f32_16x16x32_bf16 v[92:95], a[180:183], a[12:15], v[92:95]
    ds_bpermute_b32 v50, v156, v16
    v_mfma_f32_16x16x32_bf16 v[92:95], a[176:179], a[8:11], v[92:95]
    buffer_load_dwordx4 a[172:175], v1, s[20:23], s68 offen offset:1024 sc1
    v_mfma_f32_16x16x32_bf16 v[88:91], a[180:183], a[8:11], v[88:91]
    v_add_u32 v245, 2112, v254
    v_add_f32 v38, v38, v146
    v_mfma_f32_16x16x32_bf16 v[88:91], a[176:179], a[4:7], v[88:91]
    v_add_u32 v246, s52, v254
    v_add_f32 v39, v39, v147
    v_mfma_f32_16x16x32_bf16 v[84:87], a[180:183], a[4:7], v[84:87]
    ds_bpermute_b32 v51, v156, v17
    v_mfma_f32_16x16x32_bf16 v[84:87], a[176:179], a[0:3], v[84:87]
    ds_read2st64_b32 v[136:137], v247 offset0:149 offset1:153
    v_cvt_pk_bf16_f32 v36, v36, v37
    v_mfma_f32_16x16x32_bf16 v[104:107], a[184:187], a[0:3], v[104:107]
    buffer_load_dwordx4 a[176:179], v1, s[20:23], s68 offen offset:2048 sc1
    v_mfma_f32_16x16x32_bf16 v[104:107], a[188:191], a[4:7], v[104:107]
    ds_bpermute_b32 v164, v156, v36
    v_mfma_f32_16x16x32_bf16 v[108:111], a[184:187], a[4:7], v[108:111]
    ds_read2st64_b32 v[138:139], v247 offset0:157 offset1:161
    v_cvt_pk_bf16_f32 v37, v38, v39
    v_mfma_f32_16x16x32_bf16 v[108:111], a[188:191], a[8:11], v[108:111]
    ds_bpermute_b32 v165, v156, v37
    v_mfma_f32_16x16x32_bf16 v[112:115], a[184:187], a[8:11], v[112:115]
    ds_read2st64_b32 v[140:141], v247 offset0:165 offset1:169
    v_add_f32 v160, v160, v216
    v_mfma_f32_16x16x32_bf16 v[112:115], a[188:191], a[12:15], v[112:115]
    buffer_load_dwordx4 a[180:183], v1, s[20:23], s68 offen offset:3072 sc1
    v_mfma_f32_16x16x32_bf16 v[116:119], a[184:187], a[12:15], v[116:119]
    s_add_u32 s68, s68, 4096
    ds_read2st64_b32 v[142:143], v247 offset0:173 offset1:177
    v_mfma_f32_16x16x32_bf16 v[116:119], a[188:191], a[16:19], v[116:119]
    ds_read2st64_b32 v[144:145], v247 offset0:181 offset1:185
    v_add_f32 v161, v161, v217
    v_mfma_f32_16x16x32_bf16 v[120:123], a[184:187], a[16:19], v[120:123]
    ds_read2st64_b32 v[146:147], v247 offset0:189 offset1:193
    v_add_f32 v162, v162, v218
    v_mfma_f32_16x16x32_bf16 v[120:123], a[188:191], a[20:23], v[120:123]
    s_waitcnt lgkmcnt(10)
    s_waitcnt vmcnt(28)
    v_mfma_f32_16x16x32_bf16 v[64:67], a[192:195], a[216:219], v[64:67]
    buffer_load_dwordx4 a[184:187], v1, s[20:23], s68 offen offset:0 sc1
    v_mfma_f32_16x16x32_bf16 v[64:67], a[196:199], a[220:223], v[64:67]
    v_add_f32 v163, v163, v219
    v_cvt_pk_bf16_f32 v160, v160, v161
    v_mfma_f32_16x16x32_bf16 v[68:71], a[192:195], a[220:223], v[68:71]
    ds_read_b128 a[0:3], v245 offset:0
    v_cvt_pk_bf16_f32 v161, v162, v163
    v_mfma_f32_16x16x32_bf16 v[68:71], a[196:199], a[224:227], v[68:71]
    ds_read_b128 a[4:7], v245 offset:352
    v_add_f32 v20, v20, v220
    v_mfma_f32_16x16x32_bf16 v[72:75], a[192:195], a[224:227], v[72:75]
    ds_bpermute_b32 v24, v156, v160
    v_mfma_f32_16x16x32_bf16 v[72:75], a[196:199], a[228:231], v[72:75]
    buffer_load_dwordx4 a[188:191], v1, s[20:23], s68 offen offset:1024 sc1
    v_mfma_f32_16x16x32_bf16 v[76:79], a[192:195], a[228:231], v[76:79]
    ds_bpermute_b32 v25, v156, v161
    v_mfma_f32_16x16x32_bf16 v[76:79], a[196:199], a[232:235], v[76:79]
    ds_read_b128 a[8:11], v245 offset:704
    v_add_f32 v21, v21, v221
    v_mfma_f32_16x16x32_bf16 v[80:83], a[192:195], a[232:235], v[80:83]
    ds_read_b128 a[12:15], v245 offset:1056
    v_add_f32 v22, v22, v222
    v_mfma_f32_16x16x32_bf16 v[80:83], a[196:199], a[236:239], v[80:83]
    v_add_f32 v23, v23, v223
    v_cvt_pk_bf16_f32 v20, v20, v21
    v_mfma_f32_16x16x32_bf16 v[100:103], a[204:207], a[236:239], v[100:103]
    buffer_load_dwordx4 a[192:195], v1, s[20:23], s68 offen offset:2048 sc1
    v_mfma_f32_16x16x32_bf16 v[100:103], a[200:203], a[232:235], v[100:103]
    ds_bpermute_b32 v26, v156, v20
    v_mfma_f32_16x16x32_bf16 v[96:99], a[204:207], a[232:235], v[96:99]
    ds_read_b128 a[16:19], v245 offset:1408
    v_cvt_pk_bf16_f32 v21, v22, v23
    v_mfma_f32_16x16x32_bf16 v[96:99], a[200:203], a[228:231], v[96:99]
    ds_read_b128 a[20:23], v245 offset:1760
    v_add_f32 v40, v40, v224
    v_mfma_f32_16x16x32_bf16 v[92:95], a[204:207], a[228:231], v[92:95]
    ds_bpermute_b32 v27, v156, v21
    v_mfma_f32_16x16x32_bf16 v[92:95], a[200:203], a[224:227], v[92:95]
    buffer_load_dwordx4 a[196:199], v1, s[20:23], s68 offen offset:3072 sc1
    v_mfma_f32_16x16x32_bf16 v[88:91], a[204:207], a[224:227], v[88:91]
    s_add_u32 s68, s68, 4096
    v_add_f32 v41, v41, v225
    v_mfma_f32_16x16x32_bf16 v[88:91], a[200:203], a[220:223], v[88:91]
    v_add_f32 v42, v42, v226
    v_add_f32 v43, v43, v227
    v_mfma_f32_16x16x32_bf16 v[84:87], a[204:207], a[220:223], v[84:87]
    ds_read2st64_b32 v[216:217], v248 offset0:0 offset1:4
    v_cvt_pk_bf16_f32 v40, v40, v41
    v_mfma_f32_16x16x32_bf16 v[84:87], a[200:203], a[216:219], v[84:87]
    ds_bpermute_b32 v44, v156, v40
    v_mfma_f32_16x16x32_bf16 v[104:107], a[208:211], a[216:219], v[104:107]
    buffer_load_dwordx4 a[200:203], v1, s[20:23], s68 offen offset:0 sc1
    v_mfma_f32_16x16x32_bf16 v[104:107], a[212:215], a[220:223], v[104:107]
    ds_read2st64_b32 v[218:219], v248 offset0:8 offset1:12
    v_cvt_pk_bf16_f32 v41, v42, v43
    v_mfma_f32_16x16x32_bf16 v[108:111], a[208:211], a[220:223], v[108:111]
    ds_bpermute_b32 v45, v156, v41
    v_mfma_f32_16x16x32_bf16 v[108:111], a[212:215], a[224:227], v[108:111]
    ds_read2st64_b32 v[220:221], v248 offset0:16 offset1:20
    v_fmac_f32 v52, s62, v228
    v_mfma_f32_16x16x32_bf16 v[112:115], a[208:211], a[224:227], v[112:115]
    ds_read2st64_b32 v[222:223], v248 offset0:24 offset1:28
    v_fmac_f32 v53, s62, v229
    v_mfma_f32_16x16x32_bf16 v[112:115], a[212:215], a[228:231], v[112:115]
    buffer_load_dwordx4 a[204:207], v1, s[20:23], s68 offen offset:1024 sc1
    v_mfma_f32_16x16x32_bf16 v[116:119], a[208:211], a[228:231], v[116:119]
    ds_read2st64_b32 v[224:225], v248 offset0:32 offset1:36
    v_fmac_f32 v54, s62, v230
L_pg8:
    s_cbranch_execz L_warmed
    v_mfma_f32_16x16x32_bf16 v[116:119], a[212:215], a[232:235], v[116:119]
    ds_read2st64_b32 v[226:227], v248 offset0:40 offset1:44
    v_fmac_f32 v55, s62, v231
    v_mfma_f32_16x16x32_bf16 v[120:123], a[208:211], a[232:235], v[120:123]
    v_fmac_f32 v184, s62, v232
    v_fmac_f32 v185, s62, v233
    v_mfma_f32_16x16x32_bf16 v[120:123], a[212:215], a[236:239], v[120:123]
    s_waitcnt lgkmcnt(9)
    s_waitcnt vmcnt(28)
    v_mfma_f32_16x16x32_bf16 v[64:67], a[96:99], a[0:3], v[64:67]
    buffer_load_dwordx4 a[208:211], v1, s[20:23], s68 offen offset:2048 sc1
    v_mfma_f32_16x16x32_bf16 v[64:67], a[100:103], a[4:7], v[64:67]
    v_add_u32 v249, s70, v254
    v_add_u32 v244, s70, v249
    v_mfma_f32_16x16x32_bf16 v[68:71], a[96:99], a[4:7], v[68:71]
    v_add_u32 v245, s70, v244
    v_fmac_f32 v186, s62, v234
    v_mfma_f32_16x16x32_bf16 v[68:71], a[100:103], a[8:11], v[68:71]
    ds_read_b128 a[216:219], v246 offset:0
    v_fmac_f32 v187, s62, v235
    v_mfma_f32_16x16x32_bf16 v[72:75], a[96:99], a[8:11], v[72:75]
    buffer_store_dwordx4 v[168:171], v154, s[24:27], s72 offen nt
    v_mfma_f32_16x16x32_bf16 v[72:75], a[100:103], a[12:15], v[72:75]
    buffer_load_dwordx4 a[212:215], v1, s[20:23], s68 offen offset:3072 sc1
    ds_read_b128 a[220:223], v249 offset:0
    v_mfma_f32_16x16x32_bf16 v[76:79], a[96:99], a[12:15], v[76:79]
    s_add_u32 s68, s68, 4096
    v_fmac_f32 v204, s62, v236
    v_mfma_f32_16x16x32_bf16 v[76:79], a[100:103], a[16:19], v[76:79]
    ds_read_b128 a[224:227], v249 offset:2112
    v_fmac_f32 v205, s62, v237
    v_mfma_f32_16x16x32_bf16 v[80:83], a[96:99], a[16:19], v[80:83]
    v_fmac_f32 v206, s62, v238
    v_fmac_f32 v207, s62, v239
    v_mfma_f32_16x16x32_bf16 v[80:83], a[100:103], a[20:23], v[80:83]
    ds_read_b128 a[228:231], v249 offset:4224
    v_fmac_f32 v56, s62, v124
    v_mfma_f32_16x16x32_bf16 v[100:103], a[108:111], a[20:23], v[100:103]
    ds_read2st64_b32 v[228:229], v248 offset0:75 offset1:79
    v_fmac_f32 v57, s62, v125
    v_mfma_f32_16x16x32_bf16 v[100:103], a[104:107], a[16:19], v[100:103]
    ds_read_b128 a[232:235], v244 offset:0
    v_fmac_f32 v58, s62, v126
    v_mfma_f32_16x16x32_bf16 v[96:99], a[108:111], a[16:19], v[96:99]
    buffer_store_dwordx2 v[28:29], v155, s[24:27], s72 offen nt
    v_mfma_f32_16x16x32_bf16 v[96:99], a[104:107], a[12:15], v[96:99]
    ds_read_b128 a[236:239], v244 offset:2112
    s_add_u32 s72, s72, s73
    v_mfma_f32_16x16x32_bf16 v[92:95], a[108:111], a[12:15], v[92:95]
    ds_read2st64_b32 v[230:231], v248 offset0:83 offset1:87
    v_fmac_f32 v59, s62, v127
    v_mfma_f32_16x16x32_bf16 v[92:95], a[104:107], a[8:11], v[92:95]
    ds_read_b128 a[240:243], v244 offset:4224
    v_fmac_f32 v188, s62, v128
    v_mfma_f32_16x16x32_bf16 v[88:91], a[108:111], a[8:11], v[88:91]
    ds_read2st64_b32 v[232:233], v248 offset0:91 offset1:95
    v_fmac_f32 v189, s62, v129
    v_mfma_f32_16x16x32_bf16 v[88:91], a[104:107], a[4:7], v[88:91]
    ds_read_b128 a[244:247], v245 offset:0
    v_fmac_f32 v190, s62, v130
    v_mfma_f32_16x16x32_bf16 v[84:87], a[108:111], a[4:7], v[84:87]
    ds_read2st64_b32 v[234:235], v248 offset0:99 offset1:103
    v_fmac_f32 v191, s62, v131
    v_mfma_f32_16x16x32_bf16 v[84:87], a[104:107], a[0:3], v[84:87]
    ds_read_b128 a[248:251], v245 offset:2112
    v_fmac_f32 v208, s62, v132
    v_mfma_f32_16x16x32_bf16 v[104:107], a[112:115], a[0:3], v[104:107]
    buffer_store_dwordx4 v[48:51], v154, s[24:27], s72 offen nt
    v_mfma_f32_16x16x32_bf16 v[104:107], a[116:119], a[4:7], v[104:107]
    ds_read_b128 a[252:255], v245 offset:4224
    v_fmac_f32 v209, s62, v133
    v_mfma_f32_16x16x32_bf16 v[108:111], a[112:115], a[4:7], v[108:111]
    ds_read2st64_b32 v[236:237], v248 offset0:107 offset1:111
    v_fmac_f32 v210, s62, v134
    v_mfma_f32_16x16x32_bf16 v[108:111], a[116:119], a[8:11], v[108:111]
    ds_read2st64_b32 v[238:239], v248 offset0:115 offset1:119
    v_fmac_f32 v211, s62, v135
    v_mfma_f32_16x16x32_bf16 v[112:115], a[112:115], a[8:11], v[112:115]
    v_fmac_f32 v60, s62, v136
    v_fmac_f32 v61, s62, v137
    v_mfma_f32_16x16x32_bf16 v[112:115], a[116:119], a[12:15], v[112:115]
    v_fmac_f32 v62, s62, v138
    v_fmac_f32 v63, s62, v139
    v_mfma_f32_16x16x32_bf16 v[116:119], a[112:115], a[12:15], v[116:119]
    v_fmac_f32 v192, s62, v140
    v_fmac_f32 v193, s62, v141
    v_mfma_f32_16x16x32_bf16 v[116:119], a[116:119], a[16:19], v[116:119]
    v_fmac_f32 v194, s62, v142
    v_fmac_f32 v195, s62, v143
    v_mfma_f32_16x16x32_bf16 v[120:123], a[112:115], a[16:19], v[120:123]
    buffer_store_dwordx2 v[164:165], v155, s[24:27], s72 offen nt
    v_mfma_f32_16x16x32_bf16 v[120:123], a[116:119], a[20:23], v[120:123]
    s_add_u32 s72, s72, s73
    s_waitcnt lgkmcnt(2)
    s_waitcnt vmcnt(21)
    v_mfma_f32_16x16x32_bf16 v[64:67], a[120:123], a[216:219], v[64:67]
    s_cmp_eq_u32 s32, 0
    s_cselect_b32 s72, s72, 1073741824
    v_mfma_f32_16x16x32_bf16 v[64:67], a[132:135], a[220:223], v[64:67]
    ds_read_b128 a[0:3], v246 offset:352
    v_fmac_f32 v212, s62, v144
    v_mfma_f32_16x16x32_bf16 v[64:67], a[72:75], a[224:227], v[64:67]
    v_fmac_f32 v213, s62, v145
    v_fmac_f32 v214, s62, v146
    v_mfma_f32_16x16x32_bf16 v[64:67], a[84:87], a[228:231], v[64:67]
    ds_read_b128 a[4:7], v249 offset:352
    v_fmac_f32 v215, s62, v147
    v_mfma_f32_16x16x32_bf16 v[64:67], a[144:147], a[232:235], v[64:67]
    v_fmac_f32 v176, s62, v216
    s_waitcnt vmcnt(9)
    v_mfma_f32_16x16x32_bf16 v[64:67], a[156:159], a[236:239], v[64:67]
    ds_read_b128 a[8:11], v249 offset:2464
    v_fmac_f32 v177, s62, v217
    v_mfma_f32_16x16x32_bf16 v[64:67], a[168:171], a[240:243], v[64:67]
    buffer_store_dwordx4 v[24:27], v154, s[24:27], s72 offen nt
    v_mfma_f32_16x16x32_bf16 v[64:67], a[180:183], a[244:247], v[64:67]
    ds_read_b128 a[12:15], v249 offset:4576
    v_fmac_f32 v178, s62, v218
    v_mfma_f32_16x16x32_bf16 v[64:67], a[192:195], a[248:251], v[64:67]
    v_fmac_f32 v72, s64, v60
    s_waitcnt vmcnt(4)
    v_mfma_f32_16x16x32_bf16 v[64:67], a[204:207], a[252:255], v[64:67]
    ds_read_b128 a[16:19], v244 offset:352
    v_fmac_f32 v73, s64, v61
    v_mfma_f32_16x16x32_bf16 v[84:87], a[208:211], a[252:255], v[84:87]
    v_fmac_f32 v74, s64, v62
    v_fmac_f32 v75, s64, v63
    v_mfma_f32_16x16x32_bf16 v[84:87], a[196:199], a[248:251], v[84:87]
    ds_read_b128 a[20:23], v244 offset:2464
    v_fmac_f32 v92, s64, v192
    v_mfma_f32_16x16x32_bf16 v[84:87], a[184:187], a[244:247], v[84:87]
    v_fmac_f32 v93, s64, v193
    v_fmac_f32 v94, s64, v194
    v_mfma_f32_16x16x32_bf16 v[84:87], a[172:175], a[240:243], v[84:87]
    ds_read_b128 a[24:27], v244 offset:4576
    v_fmac_f32 v95, s64, v195
    v_mfma_f32_16x16x32_bf16 v[84:87], a[160:163], a[236:239], v[84:87]
    buffer_store_dwordx2 v[44:45], v155, s[24:27], s72 offen nt
    v_mfma_f32_16x16x32_bf16 v[84:87], a[148:151], a[232:235], v[84:87]
    ds_read_b128 a[28:31], v245 offset:352
    v_fmac_f32 v112, s64, v212
    v_mfma_f32_16x16x32_bf16 v[84:87], a[88:91], a[228:231], v[84:87]
    v_fmac_f32 v113, s64, v213
    v_fmac_f32 v114, s64, v214
    v_mfma_f32_16x16x32_bf16 v[84:87], a[76:79], a[224:227], v[84:87]
    ds_read_b128 a[32:35], v245 offset:2464
    v_fmac_f32 v64, s64, v52
    v_mfma_f32_16x16x32_bf16 v[84:87], a[136:139], a[220:223], v[84:87]
    v_fmac_f32 v65, s64, v53
    v_fmac_f32 v66, s64, v54
    v_mfma_f32_16x16x32_bf16 v[84:87], a[124:127], a[216:219], v[84:87]
    ds_read_b128 a[36:39], v245 offset:4576
    v_fmac_f32 v67, s64, v55
    v_mfma_f32_16x16x32_bf16 v[104:107], a[128:131], a[216:219], v[104:107]
    v_cvt_pk_bf16_f32 v64, v64, v65
    v_cvt_pk_bf16_f32 v65, v66, v67
    v_mfma_f32_16x16x32_bf16 v[104:107], a[140:143], a[220:223], v[104:107]
    ds_bpermute_b32 v250, v156, v64
    v_mfma_f32_16x16x32_bf16 v[104:107], a[80:83], a[224:227], v[104:107]
    ds_bpermute_b32 v251, v156, v65
    v_mfma_f32_16x16x32_bf16 v[104:107], a[92:95], a[228:231], v[104:107]
    v_fmac_f32 v115, s64, v215
    v_fmac_f32 v76, s64, v176
    v_mfma_f32_16x16x32_bf16 v[104:107], a[152:155], a[232:235], v[104:107]
    v_fmac_f32 v77, s64, v177
    v_fmac_f32 v78, s64, v178
    v_mfma_f32_16x16x32_bf16 v[104:107], a[164:167], a[236:239], v[104:107]
    v_fmac_f32 v179, s62, v219
    v_fmac_f32 v79, s64, v179
    v_mfma_f32_16x16x32_bf16 v[104:107], a[176:179], a[240:243], v[104:107]
    v_fmac_f32 v196, s62, v220
    v_fmac_f32 v96, s64, v196
    v_mfma_f32_16x16x32_bf16 v[104:107], a[188:191], a[244:247], v[104:107]
    v_fmac_f32 v84, s64, v184
    v_fmac_f32 v85, s64, v185
    v_mfma_f32_16x16x32_bf16 v[104:107], a[200:203], a[248:251], v[104:107]
    v_fmac_f32 v86, s64, v186
    v_fmac_f32 v87, s64, v187
    v_mfma_f32_16x16x32_bf16 v[104:107], a[212:215], a[252:255], v[104:107]
    v_cvt_pk_bf16_f32 v84, v84, v85
    s_waitcnt lgkmcnt(2)
    v_mfma_f32_16x16x32_bf16 v[68:71], a[120:123], a[0:3], v[68:71]
    ds_bpermute_b32 v252, v156, v84
    v_mfma_f32_16x16x32_bf16 v[68:71], a[132:135], a[4:7], v[68:71]
    ds_read_b128 a[216:219], v246 offset:704
    v_cvt_pk_bf16_f32 v85, v86, v87
    v_mfma_f32_16x16x32_bf16 v[68:71], a[72:75], a[8:11], v[68:71]
    ds_bpermute_b32 v253, v156, v85
    v_mfma_f32_16x16x32_bf16 v[68:71], a[84:87], a[12:15], v[68:71]
    ds_read_b128 a[220:223], v249 offset:704
    v_fmac_f32 v197, s62, v221
    v_mfma_f32_16x16x32_bf16 v[68:71], a[144:147], a[16:19], v[68:71]
    v_fmac_f32 v97, s64, v197
    v_fmac_f32 v198, s62, v222
    v_mfma_f32_16x16x32_bf16 v[68:71], a[156:159], a[20:23], v[68:71]
    ds_read_b128 a[224:227], v249 offset:2816
    v_fmac_f32 v98, s64, v198
    v_mfma_f32_16x16x32_bf16 v[68:71], a[168:171], a[24:27], v[68:71]
    v_fmac_f32 v199, s62, v223
    v_fmac_f32 v99, s64, v199
    v_mfma_f32_16x16x32_bf16 v[68:71], a[180:183], a[28:31], v[68:71]
    ds_read_b128 a[228:231], v249 offset:4928
    v_fmac_f32 v104, s64, v204
    v_mfma_f32_16x16x32_bf16 v[68:71], a[192:195], a[32:35], v[68:71]
    v_fmac_f32 v105, s64, v205
    v_fmac_f32 v106, s64, v206
    v_mfma_f32_16x16x32_bf16 v[68:71], a[204:207], a[36:39], v[68:71]
    ds_read_b128 a[232:235], v244 offset:704
    v_fmac_f32 v107, s64, v207
    v_mfma_f32_16x16x32_bf16 v[88:91], a[208:211], a[36:39], v[88:91]
    s_waitcnt lgkmcnt(4)
    buffer_store_dwordx4 v[250:253], v154, s[24:27], s71 offen nt
    v_mfma_f32_16x16x32_bf16 v[88:91], a[196:199], a[32:35], v[88:91]
    ds_read_b128 a[236:239], v244 offset:2816
    v_cvt_pk_bf16_f32 v104, v104, v105
    v_mfma_f32_16x16x32_bf16 v[88:91], a[184:187], a[28:31], v[88:91]
    ds_bpermute_b32 v254, v156, v104
    v_mfma_f32_16x16x32_bf16 v[88:91], a[172:175], a[24:27], v[88:91]
    ds_read_b128 a[240:243], v244 offset:4928
    v_cvt_pk_bf16_f32 v105, v106, v107
    v_mfma_f32_16x16x32_bf16 v[88:91], a[160:163], a[20:23], v[88:91]
    ds_bpermute_b32 v255, v156, v105
    v_mfma_f32_16x16x32_bf16 v[88:91], a[148:151], a[16:19], v[88:91]
    ds_read_b128 a[244:247], v245 offset:704
    v_fmac_f32 v148, s62, v224
    v_mfma_f32_16x16x32_bf16 v[88:91], a[88:91], a[12:15], v[88:91]
    v_fmac_f32 v116, s64, v148
    v_fmac_f32 v149, s62, v225
    v_mfma_f32_16x16x32_bf16 v[88:91], a[76:79], a[8:11], v[88:91]
    ds_read_b128 a[248:251], v245 offset:2816
    v_fmac_f32 v68, s64, v56
    v_mfma_f32_16x16x32_bf16 v[88:91], a[136:139], a[4:7], v[88:91]
    v_fmac_f32 v69, s64, v57
    v_fmac_f32 v70, s64, v58
    v_mfma_f32_16x16x32_bf16 v[88:91], a[124:127], a[0:3], v[88:91]
    ds_read_b128 a[252:255], v245 offset:4928
    v_fmac_f32 v71, s64, v59
    v_mfma_f32_16x16x32_bf16 v[108:111], a[128:131], a[0:3], v[108:111]
    v_cvt_pk_bf16_f32 v68, v68, v69
    v_cvt_pk_bf16_f32 v69, v70, v71
    v_mfma_f32_16x16x32_bf16 v[108:111], a[140:143], a[4:7], v[108:111]
    s_waitcnt lgkmcnt(3)
    buffer_store_dwordx2 v[254:255], v155, s[24:27], s71 offen nt
    v_mfma_f32_16x16x32_bf16 v[108:111], a[80:83], a[8:11], v[108:111]
    ds_bpermute_b32 v2, v156, v68
    v_mfma_f32_16x16x32_bf16 v[108:111], a[92:95], a[12:15], v[108:111]
    ds_bpermute_b32 v3, v156, v69
    v_mfma_f32_16x16x32_bf16 v[108:111], a[152:155], a[16:19], v[108:111]
    s_add_u32 s71, s71, s73
    v_fmac_f32 v117, s64, v149
    v_mfma_f32_16x16x32_bf16 v[108:111], a[164:167], a[20:23], v[108:111]
    v_fmac_f32 v150, s62, v226
    v_fmac_f32 v118, s64, v150
    v_mfma_f32_16x16x32_bf16 v[108:111], a[176:179], a[24:27], v[108:111]
    v_fmac_f32 v151, s62, v227
    v_fmac_f32 v119, s64, v151
    v_mfma_f32_16x16x32_bf16 v[108:111], a[188:191], a[28:31], v[108:111]
    v_fmac_f32 v88, s64, v188
    v_fmac_f32 v89, s64, v189
    v_mfma_f32_16x16x32_bf16 v[108:111], a[200:203], a[32:35], v[108:111]
    v_fmac_f32 v90, s64, v190
    v_fmac_f32 v91, s64, v191
    v_mfma_f32_16x16x32_bf16 v[108:111], a[212:215], a[36:39], v[108:111]
    v_cvt_pk_bf16_f32 v88, v88, v89
    s_waitcnt lgkmcnt(2)
    v_mfma_f32_16x16x32_bf16 v[72:75], a[120:123], a[216:219], v[72:75]
    ds_bpermute_b32 v4, v156, v88
    v_mfma_f32_16x16x32_bf16 v[72:75], a[132:135], a[220:223], v[72:75]
    ds_read_b128 a[0:3], v246 offset:1056
    v_cvt_pk_bf16_f32 v89, v90, v91
    v_mfma_f32_16x16x32_bf16 v[72:75], a[72:75], a[224:227], v[72:75]
    ds_bpermute_b32 v5, v156, v89
    v_mfma_f32_16x16x32_bf16 v[72:75], a[84:87], a[228:231], v[72:75]
    ds_read_b128 a[4:7], v249 offset:1056
    v_fmac_f32 v180, s62, v228
    v_mfma_f32_16x16x32_bf16 v[72:75], a[144:147], a[232:235], v[72:75]
    v_fmac_f32 v80, s64, v180
    v_fmac_f32 v181, s62, v229
    v_mfma_f32_16x16x32_bf16 v[72:75], a[156:159], a[236:239], v[72:75]
    ds_read_b128 a[8:11], v249 offset:3168
    v_fmac_f32 v81, s64, v181
    v_mfma_f32_16x16x32_bf16 v[72:75], a[168:171], a[240:243], v[72:75]
    v_fmac_f32 v182, s62, v230
    v_fmac_f32 v82, s64, v182
    v_mfma_f32_16x16x32_bf16 v[72:75], a[180:183], a[244:247], v[72:75]
    ds_read_b128 a[12:15], v249 offset:5280
    v_fmac_f32 v108, s64, v208
    v_mfma_f32_16x16x32_bf16 v[72:75], a[192:195], a[248:251], v[72:75]
    v_fmac_f32 v109, s64, v209
    v_fmac_f32 v110, s64, v210
    v_mfma_f32_16x16x32_bf16 v[72:75], a[204:207], a[252:255], v[72:75]
    ds_read_b128 a[16:19], v244 offset:1056
    v_fmac_f32 v111, s64, v211
    v_mfma_f32_16x16x32_bf16 v[92:95], a[208:211], a[252:255], v[92:95]
    s_waitcnt lgkmcnt(4)
    buffer_store_dwordx4 v[2:5], v154, s[24:27], s71 offen nt
    v_mfma_f32_16x16x32_bf16 v[92:95], a[196:199], a[248:251], v[92:95]
    ds_read_b128 a[20:23], v244 offset:3168
    v_cvt_pk_bf16_f32 v108, v108, v109
    v_mfma_f32_16x16x32_bf16 v[92:95], a[184:187], a[244:247], v[92:95]
    ds_bpermute_b32 v6, v156, v108
    v_mfma_f32_16x16x32_bf16 v[92:95], a[172:175], a[240:243], v[92:95]
    ds_read_b128 a[24:27], v244 offset:5280
    v_cvt_pk_bf16_f32 v109, v110, v111
    v_mfma_f32_16x16x32_bf16 v[92:95], a[160:163], a[236:239], v[92:95]
    ds_bpermute_b32 v7, v156, v109
    v_mfma_f32_16x16x32_bf16 v[92:95], a[148:151], a[232:235], v[92:95]
    ds_read_b128 a[28:31], v245 offset:1056
    v_fmac_f32 v183, s62, v231
    v_mfma_f32_16x16x32_bf16 v[92:95], a[88:91], a[228:231], v[92:95]
    v_fmac_f32 v83, s64, v183
    v_fmac_f32 v200, s62, v232
    v_mfma_f32_16x16x32_bf16 v[92:95], a[76:79], a[224:227], v[92:95]
    ds_read_b128 a[32:35], v245 offset:3168
    v_cvt_pk_bf16_f32 v72, v72, v73
    v_mfma_f32_16x16x32_bf16 v[92:95], a[136:139], a[220:223], v[92:95]
    ds_bpermute_b32 v250, v156, v72
    v_mfma_f32_16x16x32_bf16 v[92:95], a[124:127], a[216:219], v[92:95]
    ds_read_b128 a[36:39], v245 offset:5280
    v_cvt_pk_bf16_f32 v73, v74, v75
    v_mfma_f32_16x16x32_bf16 v[112:115], a[128:131], a[216:219], v[112:115]
    ds_bpermute_b32 v251, v156, v73
    v_mfma_f32_16x16x32_bf16 v[112:115], a[140:143], a[220:223], v[112:115]
    s_waitcnt lgkmcnt(5)
    buffer_store_dwordx2 v[6:7], v155, s[24:27], s71 offen nt
    v_mfma_f32_16x16x32_bf16 v[112:115], a[80:83], a[224:227], v[112:115]
    s_add_u32 s71, s71, s73
    v_fmac_f32 v100, s64, v200
    v_mfma_f32_16x16x32_bf16 v[112:115], a[92:95], a[228:231], v[112:115]
    v_fmac_f32 v201, s62, v233
    v_fmac_f32 v101, s64, v201
    v_mfma_f32_16x16x32_bf16 v[112:115], a[152:155], a[232:235], v[112:115]
    v_fmac_f32 v202, s62, v234
    v_fmac_f32 v102, s64, v202
    v_mfma_f32_16x16x32_bf16 v[112:115], a[164:167], a[236:239], v[112:115]
    v_fmac_f32 v203, s62, v235
    v_fmac_f32 v103, s64, v203
    v_mfma_f32_16x16x32_bf16 v[112:115], a[176:179], a[240:243], v[112:115]
    v_fmac_f32 v240, s62, v236
    v_fmac_f32 v120, s64, v240
    v_mfma_f32_16x16x32_bf16 v[112:115], a[188:191], a[244:247], v[112:115]
    v_cvt_pk_bf16_f32 v92, v92, v93
    v_cvt_pk_bf16_f32 v93, v94, v95
    v_mfma_f32_16x16x32_bf16 v[112:115], a[200:203], a[248:251], v[112:115]
    ds_bpermute_b32 v252, v156, v92
    v_mfma_f32_16x16x32_bf16 v[112:115], a[212:215], a[252:255], v[112:115]
    v_fmac_f32 v241, s62, v237
    s_waitcnt lgkmcnt(2)
    v_mfma_f32_16x16x32_bf16 v[76:79], a[120:123], a[0:3], v[76:79]
    ds_bpermute_b32 v253, v156, v93
    v_mfma_f32_16x16x32_bf16 v[76:79], a[132:135], a[4:7], v[76:79]
    ds_read_b128 a[216:219], v246 offset:1408
    v_fmac_f32 v121, s64, v241
    v_mfma_f32_16x16x32_bf16 v[76:79], a[72:75], a[8:11], v[76:79]
    v_fmac_f32 v242, s62, v238
    v_fmac_f32 v122, s64, v242
    v_mfma_f32_16x16x32_bf16 v[76:79], a[84:87], a[12:15], v[76:79]
    ds_read_b128 a[220:223], v249 offset:1408
    v_fmac_f32 v243, s62, v239
    v_mfma_f32_16x16x32_bf16 v[76:79], a[144:147], a[16:19], v[76:79]
    v_fmac_f32 v123, s64, v243
    v_mfma_f32_16x16x32_bf16 v[76:79], a[156:159], a[20:23], v[76:79]
    ds_read_b128 a[224:227], v249 offset:3520
    v_mfma_f32_16x16x32_bf16 v[76:79], a[168:171], a[24:27], v[76:79]
    v_mfma_f32_16x16x32_bf16 v[76:79], a[180:183], a[28:31], v[76:79]
    ds_read_b128 a[228:231], v249 offset:5632
    v_cvt_pk_bf16_f32 v112, v112, v113
    v_mfma_f32_16x16x32_bf16 v[76:79], a[192:195], a[32:35], v[76:79]
    s_waitcnt lgkmcnt(4)
    buffer_store_dwordx4 v[250:253], v154, s[24:27], s71 offen nt
    v_mfma_f32_16x16x32_bf16 v[76:79], a[204:207], a[36:39], v[76:79]
    ds_read_b128 a[232:235], v244 offset:1408
    v_cvt_pk_bf16_f32 v113, v114, v115
    v_mfma_f32_16x16x32_bf16 v[96:99], a[208:211], a[36:39], v[96:99]
    ds_bpermute_b32 v254, v156, v112
    v_mfma_f32_16x16x32_bf16 v[96:99], a[196:199], a[32:35], v[96:99]
    ds_read_b128 a[236:239], v244 offset:3520
    v_mfma_f32_16x16x32_bf16 v[96:99], a[184:187], a[28:31], v[96:99]
    ds_bpermute_b32 v255, v156, v113
    v_mfma_f32_16x16x32_bf16 v[96:99], a[172:175], a[24:27], v[96:99]
    ds_read_b128 a[240:243], v244 offset:5632
    v_mfma_f32_16x16x32_bf16 v[96:99], a[160:163], a[20:23], v[96:99]
    v_mfma_f32_16x16x32_bf16 v[96:99], a[148:151], a[16:19], v[96:99]
    ds_read_b128 a[244:247], v245 offset:1408
    v_mfma_f32_16x16x32_bf16 v[96:99], a[88:91], a[12:15], v[96:99]
    v_mfma_f32_16x16x32_bf16 v[96:99], a[76:79], a[8:11], v[96:99]
    ds_read_b128 a[248:251], v245 offset:3520
    v_cvt_pk_bf16_f32 v76, v76, v77
    v_mfma_f32_16x16x32_bf16 v[96:99], a[136:139], a[4:7], v[96:99]
    ds_bpermute_b32 v2, v156, v76
    v_mfma_f32_16x16x32_bf16 v[96:99], a[124:127], a[0:3], v[96:99]
    ds_read_b128 a[252:255], v245 offset:5632
    v_cvt_pk_bf16_f32 v77, v78, v79
    v_mfma_f32_16x16x32_bf16 v[116:119], a[128:131], a[0:3], v[116:119]
    s_waitcnt lgkmcnt(5)
    buffer_store_dwordx2 v[254:255], v155, s[24:27], s71 offen nt
    v_mfma_f32_16x16x32_bf16 v[116:119], a[140:143], a[4:7], v[116:119]
    ds_bpermute_b32 v3, v156, v77
    v_mfma_f32_16x16x32_bf16 v[116:119], a[80:83], a[8:11], v[116:119]
    s_add_u32 s71, s71, s73
    v_mfma_f32_16x16x32_bf16 v[116:119], a[92:95], a[12:15], v[116:119]
    v_mfma_f32_16x16x32_bf16 v[116:119], a[152:155], a[16:19], v[116:119]
    v_mfma_f32_16x16x32_bf16 v[116:119], a[164:167], a[20:23], v[116:119]
    v_mfma_f32_16x16x32_bf16 v[116:119], a[176:179], a[24:27], v[116:119]
    v_mfma_f32_16x16x32_bf16 v[116:119], a[188:191], a[28:31], v[116:119]
    v_cvt_pk_bf16_f32 v96, v96, v97
    v_cvt_pk_bf16_f32 v97, v98, v99
    v_mfma_f32_16x16x32_bf16 v[116:119], a[200:203], a[32:35], v[116:119]
    ds_bpermute_b32 v4, v156, v96
    v_mfma_f32_16x16x32_bf16 v[116:119], a[212:215], a[36:39], v[116:119]
    s_waitcnt lgkmcnt(2)
    v_mfma_f32_16x16x32_bf16 v[80:83], a[120:123], a[216:219], v[80:83]
    ds_bpermute_b32 v5, v156, v97
    v_mfma_f32_16x16x32_bf16 v[80:83], a[132:135], a[220:223], v[80:83]
    v_mfma_f32_16x16x32_bf16 v[80:83], a[72:75], a[224:227], v[80:83]
    v_mfma_f32_16x16x32_bf16 v[80:83], a[84:87], a[228:231], v[80:83]
    v_mfma_f32_16x16x32_bf16 v[80:83], a[144:147], a[232:235], v[80:83]
    v_mfma_f32_16x16x32_bf16 v[80:83], a[156:159], a[236:239], v[80:83]
    v_mfma_f32_16x16x32_bf16 v[80:83], a[168:171], a[240:243], v[80:83]
    v_mfma_f32_16x16x32_bf16 v[80:83], a[180:183], a[244:247], v[80:83]
    s_waitcnt lgkmcnt(0)
    buffer_store_dwordx4 v[2:5], v154, s[24:27], s71 offen nt
    v_mfma_f32_16x16x32_bf16 v[80:83], a[192:195], a[248:251], v[80:83]
    v_cvt_pk_bf16_f32 v116, v116, v117
    v_cvt_pk_bf16_f32 v117, v118, v119
    v_mfma_f32_16x16x32_bf16 v[80:83], a[204:207], a[252:255], v[80:83]
    ds_bpermute_b32 v6, v156, v116
    v_mfma_f32_16x16x32_bf16 v[100:103], a[208:211], a[252:255], v[100:103]
    ds_bpermute_b32 v7, v156, v117
    v_mfma_f32_16x16x32_bf16 v[100:103], a[196:199], a[248:251], v[100:103]
    v_mfma_f32_16x16x32_bf16 v[100:103], a[184:187], a[244:247], v[100:103]
    v_mfma_f32_16x16x32_bf16 v[100:103], a[172:175], a[240:243], v[100:103]
    v_mfma_f32_16x16x32_bf16 v[100:103], a[160:163], a[236:239], v[100:103]
    v_mfma_f32_16x16x32_bf16 v[100:103], a[148:151], a[232:235], v[100:103]
    v_mfma_f32_16x16x32_bf16 v[100:103], a[88:91], a[228:231], v[100:103]
    v_mfma_f32_16x16x32_bf16 v[100:103], a[76:79], a[224:227], v[100:103]
    s_waitcnt lgkmcnt(0)
    buffer_store_dwordx2 v[6:7], v155, s[24:27], s71 offen nt
    v_mfma_f32_16x16x32_bf16 v[100:103], a[136:139], a[220:223], v[100:103]
    s_add_u32 s71, s71, s73
    v_cvt_pk_bf16_f32 v80, v80, v81
    v_mfma_f32_16x16x32_bf16 v[100:103], a[124:127], a[216:219], v[100:103]
    ds_bpermute_b32 v250, v156, v80
    v_mfma_f32_16x16x32_bf16 v[120:123], a[128:131], a[216:219], v[120:123]
    v_cvt_pk_bf16_f32 v81, v82, v83
    v_mfma_f32_16x16x32_bf16 v[120:123], a[140:143], a[220:223], v[120:123]
    ds_bpermute_b32 v251, v156, v81
    v_mfma_f32_16x16x32_bf16 v[120:123], a[80:83], a[224:227], v[120:123]
    v_mfma_f32_16x16x32_bf16 v[120:123], a[92:95], a[228:231], v[120:123]
    v_mfma_f32_16x16x32_bf16 v[120:123], a[152:155], a[232:235], v[120:123]
    v_mfma_f32_16x16x32_bf16 v[120:123], a[164:167], a[236:239], v[120:123]
    v_mfma_f32_16x16x32_bf16 v[120:123], a[176:179], a[240:243], v[120:123]
    v_mfma_f32_16x16x32_bf16 v[120:123], a[188:191], a[244:247], v[120:123]
    v_cvt_pk_bf16_f32 v100, v100, v101
    v_cvt_pk_bf16_f32 v101, v102, v103
    v_mfma_f32_16x16x32_bf16 v[120:123], a[200:203], a[248:251], v[120:123]
    ds_bpermute_b32 v252, v156, v100
    v_mfma_f32_16x16x32_bf16 v[120:123], a[212:215], a[252:255], v[120:123]
    ds_bpermute_b32 v253, v156, v101
    s_nop 5
    s_waitcnt lgkmcnt(0)
    buffer_store_dwordx4 v[250:253], v154, s[24:27], s71 offen nt
    s_nop 0
    v_cvt_pk_bf16_f32 v120, v120, v121
    ds_bpermute_b32 v254, v156, v120
    v_cvt_pk_bf16_f32 v121, v122, v123
    ds_bpermute_b32 v255, v156, v121
    s_waitcnt lgkmcnt(0)
    buffer_store_dwordx2 v[254:255], v155, s[24:27], s71 offen nt
    s_endpgm
L_codeend:
.section .rodata,"a"
.p2align 6
.amdhsa_kernel standalone__detection_seg_fpn_lateral__vision_kernel
  .amdhsa_next_free_vgpr 512
  .amdhsa_next_free_sgpr 102
  .amdhsa_accum_offset 256
  .amdhsa_group_segment_fixed_size 0
  .amdhsa_kernarg_size 56
  .amdhsa_user_sgpr_count 2
  .amdhsa_user_sgpr_kernarg_segment_ptr 1
  .amdhsa_system_sgpr_workgroup_id_x 1
  .amdhsa_float_denorm_mode_32 3
.end_amdhsa_kernel
```
